```python
import torch

def _softmax(x, axis=-1):
    return torch.softmax(x, dim=axis)
def _gelu(x):
    return torch.nn.functional.gelu(x, approximate="tanh")
def _silu(x):
    return torch.nn.functional.silu(x)
def _sigmoid(x):
    return torch.sigmoid(x)
def _layernorm(x, axis=-1, eps=1e-5):
    m = x.mean(dim=axis, keepdim=True)
    v = x.var(dim=axis, keepdim=True, unbiased=False)
    return (x - m) / torch.sqrt(v + eps)
def _scatter_add(tgt, idx, src, axis=0):
    return tgt.clone().index_add_(axis, idx, src)
def _segment_sum(src, seg, n):
    out = torch.zeros((n,) + src.shape[1:], dtype=src.dtype)
    return out.index_add_(0, seg, src)
def _pad(x, pw):
    flat = tuple(v for pair in reversed(pw) for v in pair)
    return torch.nn.functional.pad(x, flat)

kernel_name = 'parallel_sum__ssm_conv_s4d__dense_activation_relu__prompt'

def setup_inputs():

    _w = (lambda a: (lambda t: t.to(torch.bfloat16) if t.is_floating_point() else t)(torch.as_tensor(a)))
    def _A_setup():
        Bsz, L, D, N = 1, 2048, 640, 128
        return {
            "u": _w((lambda *s: torch.randn(*s, dtype=torch.bfloat16) * 0.05)(Bsz, L, D)),
            "log_A_real": _w((lambda *s: torch.randn(*s, dtype=torch.bfloat16) * 6.4)(D, N) * 0.5),
            "A_imag": _w((lambda *s: torch.randn(*s, dtype=torch.bfloat16) * 0.2)(D, N) * 3.14),
            "C_real": _w((lambda *s: torch.randn(*s, dtype=torch.bfloat16) * 0.8)(D, N) / N ** 0.5),
            "C_imag": _w((lambda *s: torch.randn(*s, dtype=torch.bfloat16) * 0.8)(D, N) / N ** 0.5),
            "log_dt": _w((lambda *s: torch.randn(*s, dtype=torch.bfloat16) * 0.2)(D) * 0.5 - 4.0),
            "D_skip": _w((lambda *s: torch.randn(*s, dtype=torch.bfloat16) * 0.2)(D)),
        }
    _A_in = _A_setup()

    def _B_setup():
        B, S, D, Dff = 1, 2048, 640, 1728
        return {
            "x": _w((lambda *s: torch.randn(*s, dtype=torch.bfloat16) * 0.05)(B, S, D)),
            "w1": _w((lambda *s: torch.randn(*s, dtype=torch.bfloat16) * 0.05)(D, Dff)),
            "w2": _w((lambda *s: torch.randn(*s, dtype=torch.bfloat16) * 0.05)(Dff, D)),
        }
    _B_in = _B_setup()

    return {
        "A_u": _A_in["u"],
        "A_log_A_real": _A_in["log_A_real"],
        "A_A_imag": _A_in["A_imag"],
        "A_C_real": _A_in["C_real"],
        "A_C_imag": _A_in["C_imag"],
        "A_log_dt": _A_in["log_dt"],
        "A_D_skip": _A_in["D_skip"],
        "B_x": _B_in["x"],
        "B_w1": _B_in["w1"],
        "B_w2": _B_in["w2"],
    }

def reference(A_u, A_log_A_real, A_A_imag, A_C_real, A_C_imag, A_log_dt, A_D_skip, B_x, B_w1, B_w2):
    def _A_ref(u, log_A_real, A_imag, C_real, C_imag, log_dt, D_skip):
        L = u.shape[1]
        dt = torch.exp(log_dt)
        A = -torch.exp(log_A_real) + 1j * A_imag
        C = (C_real + 1j * C_imag) * dt[:, None]
        pos = (lambda x, dt: x.to(dt))(torch.arange(L), log_dt.dtype)
        P = torch.exp((A * dt[:, None])[:, :, None] * pos[None, None, :])
        K = 2.0 * torch.einsum("dn,dnl->dl", C, P).real
        L2 = 2 * L
        u_t = (lambda x, *d: x.permute(*d))(u, 0, 2, 1)
        Kf = (lambda x, *a, **k: torch.fft.rfft(x.float(), *a, **k))(K, L2)
        Uf = (lambda x, *a, **k: torch.fft.rfft(x.float(), *a, **k))(u_t, L2)
        y = (lambda x, *a, **k: torch.fft.irfft(x, *a, **k).to(torch.bfloat16))(Uf * Kf[None, :, :], L2)[:, :, :L]
        y = (lambda x, *d: x.permute(*d))(y, 0, 2, 1)
        return y + u * D_skip[None, None, :]

    def _B_ref(x, w1, w2):
        h = torch.einsum("bsd,df->bsf", x, w1)
        zero = torch.zeros_like(h)
        h = torch.maximum(h, zero)
        return torch.einsum("bsf,fd->bsd", h, w2)

    x = A_u
    xn = _layernorm(x, axis=-1)
    return x + _A_ref(xn, A_log_A_real, A_A_imag, A_C_real, A_C_imag, A_log_dt, A_D_skip) + _B_ref(xn, B_w1, B_w2)
```

```asm
; @launch grid=(256,1,1) block=(256,1,1) lds=163840
.amdgcn_target "amdgcn-amd-amdhsa--gfx950"
.text
.globl parallel_sum__ssm_conv_s4d__dense_activation_relu__prompt_kernel
.p2align 8
.type parallel_sum__ssm_conv_s4d__dense_activation_relu__prompt_kernel,@function
parallel_sum__ssm_conv_s4d__dense_activation_relu__prompt_kernel:
    s_cmp_ge_u32 s2, 256
    s_cbranch_scc1 L_end
    s_load_dwordx16 s[4:19], s[0:1], 0
    s_load_dwordx8 s[20:27], s[0:1], 64
    s_load_dwordx2 s[28:29], s[0:1], 96
    s_getpc_b64 s[30:31]
L_pc:
    s_and_b32 s60, s2, 7
    s_lshr_b32 s61, s2, 3
    s_lshl_b32 s62, s61, 11
    v_lshlrev_b32 v2, 3, v0
    v_add_u32_e64 v2, s62, v2
    v_min_u32 v2, L_code_end-L_pc-4, v2
    global_load_dword v255, v2, s[30:31]
    v_lshrrev_b32 v3, 6, v0
    v_and_b32 v1, 63, v0
    v_readfirstlane_b32 s52, v3
    s_lshr_b32 s62, s60, 1
    s_lshl_b32 s64, s62, 2
    s_lshr_b32 s63, s61, 3
    s_add_u32 s53, s64, s63
    s_and_b32 s65, s60, 1
    s_lshl_b32 s64, s65, 3
    s_and_b32 s56, s61, 7
    s_add_u32 s54, s64, s56
    s_lshl_b32 s64, s60, 2
    s_add_u32 s55, s64, s63
    s_lshl_b32 s59, s53, 4
    s_add_u32 s59, s59, s54
    s_add_u32 s73, s56, 1
    s_bfe_u32 s73, s73, 0x10001
    s_xor_b32 s73, s73, 1
    s_lshl_b32 s63, s63, 2
    s_lshr_b32 s64, s56, 1
    s_add_u32 s63, s63, s64
    s_lshl_b32 s3, s63, 3
    s_add_u32 s3, s3, s60
    s_mul_i32 s57, s60, 80
    s_lshr_b32 s62, s63, 1
    s_lshl_b32 s62, s62, 3
    s_and_b32 s64, s63, 1
    s_mul_i32 s64, s64, 3
    s_add_u32 s62, s62, s64
    s_lshl_b32 s64, s63, 3
    s_add_u32 s64, s64, 6
    s_lshl_b32 s66, s63, 1
    s_add_u32 s66, s66, 48
    s_cmp_lt_u32 s63, 8
    s_cselect_b32 s64, s64, s66
    s_cmp_eq_u32 s73, 0
    s_cselect_b32 s62, s62, s64
    s_add_u32 s57, s57, s62
    s_min_u32 s62, s52, 2
    s_add_u32 s57, s57, s62
    s_mul_i32 s72, s62, 8704
    s_add_u32 s72, s72, 122880
    s_add_u32 s62, s52, s73
    s_cmp_ge_u32 s52, 2
    s_cselect_b32 s62, s62, 0
    s_cmp_lt_u32 s62, 3
    s_cselect_b64 s[76:77], -1, 0
    s_mul_i32 s74, s52, 5120
    s_lshr_b32 s62, s52, 1
    s_mul_i32 s62, s62, 20480
    s_add_u32 s75, s74, s62
    s_add_u32 s75, s75, 20480
    s_lshl_b32 s62, s53, 7
    s_lshl_b32 s63, s52, 5
    s_add_u32 s62, s62, s63
    v_lshrrev_b32 v2, 3, v1
    v_add_u32 v2, s62, v2
    v_mul_u32_u24 v2, 1280, v2
    v_and_b32 v3, 7, v1
    v_lshrrev_b32 v4, 4, v1
    v_xor_b32 v5, v3, v4
    v_lshl_add_u32 v7, v5, 4, v2
    v_add_u32 v240, 0, v7
    v_xor_b32_e64 v6, 4, v5
    v_lshl_add_u32 v7, v6, 4, v2
    v_add_u32 v241, 9216, v7
    v_lshl_add_u32 v7, v5, 4, v2
    v_add_u32 v242, 18432, v7
    v_lshl_add_u32 v7, v6, 4, v2
    v_add_u32 v243, 27648, v7
    s_mul_i32 s62, s52, 224
    s_mul_i32 s63, s54, 224
    s_and_b32 s64, s54, 1
    s_lshl_b32 s64, s64, 1
    v_add_u32 v2, s62, v1
    v_mul_u32_u24 v3, 4682, v2
    v_lshrrev_b32 v3, 16, v3
    v_mul_u32_u24 v4, 14, v3
    v_sub_u32 v2, v2, v4
    v_add_u32 v2, s64, v2
    v_subrev_u32 v4, 14, v2
    v_min_u32 v2, v2, v4
    v_and_b32 v4, 35, v3
    v_bfe_u32 v5, v3, 2, 2
    v_lshl_add_u32 v4, v5, 3, v4
    v_bfe_u32 v5, v3, 4, 1
    v_lshl_add_u32 v4, v5, 2, v4
    v_mul_u32_u24 v4, 3456, v4
    v_lshl_add_u32 v4, v2, 4, v4
    v_add_u32 v4, s63, v4
    v_mov_b32 v244, v4
    v_add_u32 v2, s62, v1
    v_add_u32 v2, 64, v2
    v_mul_u32_u24 v3, 4682, v2
    v_lshrrev_b32 v3, 16, v3
    v_mul_u32_u24 v4, 14, v3
    v_sub_u32 v2, v2, v4
    v_add_u32 v2, s64, v2
    v_subrev_u32 v4, 14, v2
    v_min_u32 v2, v2, v4
    v_and_b32_e64 v4, 35, v3
    v_bfe_u32 v5, v3, 2, 2
    v_lshl_add_u32 v4, v5, 3, v4
    v_bfe_u32 v5, v3, 4, 1
    v_lshl_add_u32 v4, v5, 2, v4
    v_mul_u32_u24 v4, 3456, v4
    v_lshl_add_u32 v4, v2, 4, v4
    v_add_u32 v4, s63, v4
    v_subrev_u32 v245, 1024, v4
    v_add_u32 v2, s62, v1
    v_add_u32 v2, 128, v2
    v_mul_u32_u24 v3, 4682, v2
    v_lshrrev_b32 v3, 16, v3
    v_mul_u32_u24 v4, 14, v3
    v_sub_u32 v2, v2, v4
    v_add_u32 v2, s64, v2
    v_subrev_u32 v4, 14, v2
    v_min_u32 v2, v2, v4
    v_and_b32_e64 v4, 35, v3
    v_bfe_u32 v5, v3, 2, 2
    v_lshl_add_u32 v4, v5, 3, v4
    v_bfe_u32 v5, v3, 4, 1
    v_lshl_add_u32 v4, v5, 2, v4
    v_mul_u32_u24 v4, 3456, v4
    v_lshl_add_u32 v4, v2, 4, v4
    v_add_u32 v4, s63, v4
    v_subrev_u32 v246, 2048, v4
    v_add_u32 v2, s62, v1
    v_add_u32 v2, 192, v2
    v_mul_u32_u24 v3, 4682, v2
    v_lshrrev_b32 v3, 16, v3
    v_mul_u32_u24 v4, 14, v3
    v_sub_u32 v2, v2, v4
    v_add_u32 v2, s64, v2
    v_subrev_u32 v4, 14, v2
    v_min_u32 v2, v2, v4
    v_and_b32_e64 v4, 35, v3
    v_bfe_u32 v5, v3, 2, 2
    v_lshl_add_u32 v4, v5, 3, v4
    v_bfe_u32 v5, v3, 4, 1
    v_lshl_add_u32 v4, v5, 2, v4
    v_mul_u32_u24 v4, 3456, v4
    v_lshl_add_u32 v4, v2, 4, v4
    v_add_u32 v4, s63, v4
    v_subrev_u32 v247, 3072, v4
    s_mul_i32 s71, s52, 3584
    s_lshl_b32 s70, s52, 12
    s_add_u32 s70, s70, 14336
    s_lshr_b32 s62, s61, 3
    s_mul_i32 s62, s62, 5
    s_add_u32 s62, s62, 1
    s_lshr_b32 s62, s62, 1
    s_add_u32 s62, s62, s56
    s_cmp_ge_u32 s62, 10
    s_cselect_b32 s63, 10, 0
    s_sub_u32 s62, s62, s63
    s_lshl_b32 s68, s62, 7
    s_mul_i32 s69, s62, 221184
    v_lshrrev_b32 v2, 2, v1
    v_mul_u32_u24 v2, 224, v2
    v_and_b32_e64 v3, 3, v1
    v_lshl_add_u32 v248, v3, 3, v2
    v_add_u32 v249, 61440, v248
    v_and_b32 v2, 15, v1
    v_lshrrev_b32 v3, 4, v1
    v_lshrrev_b32 v4, 1, v2
    v_xor_b32 v3, v3, v4
    v_lshlrev_b32 v2, 7, v2
    v_add_u32 v2, s70, v2
    v_lshl_add_u32 v250, v3, 4, v2
    v_xor_b32_e64 v3, 4, v3
    v_lshl_add_u32 v251, v3, 4, v2
    v_add_u32 v252, 61440, v250
    v_add_u32 v253, 61440, v251
    s_lshl_b32 s62, s57, 8
    v_lshlrev_b32 v100, 2, v1
    v_add_u32 v100, s62, v100
    s_lshl_b32 s62, s57, 1
    v_mov_b32 v101, s62
    v_lshrrev_b32 v2, 3, v1
    s_lshl_b32 s62, s59, 3
    v_add_u32 v2, s62, v2
    v_mul_u32_u24 v2, 1280, v2
    v_and_b32_e64 v3, 7, v1
    v_lshl_add_u32 v102, v3, 4, v2
    s_waitcnt lgkmcnt(0)
    s_mov_b32 s32, s4
    s_and_b32 s33, s5, 0xffff
    s_mov_b32 s34, 2621440
    s_mov_b32 s35, 0x00020000
    s_mov_b32 s36, s20
    s_and_b32 s37, s21, 0xffff
    s_mov_b32 s38, 2211840
    s_mov_b32 s39, 0x00020000
    s_cmp_eq_u32 s52, 3
    s_cbranch_scc1 L_ld_ln
    s_cmp_eq_u32 s76, 0
    s_cbranch_scc1 L_ld_rp
    global_load_ushort v12, v101, s[14:15]
    global_load_dword v8, v100, s[6:7]
    global_load_dword v9, v100, s[8:9]
    global_load_dword v10, v100, s[10:11]
    global_load_dword v11, v100, s[12:13]
    global_load_ushort v13, v101, s[16:17]
    s_branch L_ld_done
L_ld_rp:
    s_mov_b32 s40, s22
    s_and_b32 s41, s23, 0xffff
    s_mov_b32 s42, 2211840
    s_mov_b32 s43, 0x00020000
    s_lshr_b32 s62, s3, 1
    s_mul_i32 s60, s62, 40960
    s_and_b32 s61, s3, 1
    s_mul_i32 s61, s61, 640
    s_add_u32 s60, s60, s61
    v_add_u32 v2, 0, v1
    v_mul_u32_u24 v3, 1639, v2
    v_lshrrev_b32 v3, 16, v3
    v_mul_u32_u24 v3, 640, v3
    s_mov_b32 m0, 92160
    v_lshl_add_u32 v30, v2, 4, v3
    buffer_load_dwordx4 v30, s[40:43], s60 offen lds
    v_add_u32 v2, 64, v1
    v_mul_u32_u24 v3, 1639, v2
    v_lshrrev_b32 v3, 16, v3
    v_mul_u32_u24 v3, 640, v3
    s_mov_b32 m0, 93184
    v_lshl_add_u32 v31, v2, 4, v3
    buffer_load_dwordx4 v31, s[40:43], s60 offen lds
    v_add_u32 v2, 128, v1
    v_mul_u32_u24 v3, 1639, v2
    v_lshrrev_b32_e64 v3, 16, v3
    v_mul_u32_u24 v3, 640, v3
    s_mov_b32 m0, 94208
    v_lshl_add_u32 v32, v2, 4, v3
    buffer_load_dwordx4 v32, s[40:43], s60 offen lds
    v_add_u32 v2, 192, v1
    v_mul_u32_u24 v3, 1639, v2
    v_lshrrev_b32_e64 v3, 16, v3
    v_mul_u32_u24 v3, 640, v3
    s_mov_b32 m0, 95232
    v_lshl_add_u32 v33, v2, 4, v3
    buffer_load_dwordx4 v33, s[40:43], s60 offen lds
    v_add_u32 v2, 256, v1
    v_mul_u32_u24 v3, 1639, v2
    v_lshrrev_b32_e64 v3, 16, v3
    v_mul_u32_u24 v3, 640, v3
    s_mov_b32 m0, 96256
    v_lshl_add_u32 v34, v2, 4, v3
    buffer_load_dwordx4 v34, s[40:43], s60 offen lds
    s_add_u32 s60, s60, 10240
    s_mov_b32 m0, 97280
    s_nop 0
    buffer_load_dwordx4 v30, s[40:43], s60 offen lds
    s_mov_b32 m0, 98304
    s_nop 0
    buffer_load_dwordx4 v31, s[40:43], s60 offen lds
    s_mov_b32 m0, 99328
    s_nop 0
    buffer_load_dwordx4 v32, s[40:43], s60 offen lds
    s_mov_b32 m0, 100352
    s_nop 0
    buffer_load_dwordx4 v33, s[40:43], s60 offen lds
    s_mov_b32 m0, 101376
    s_nop 0
    buffer_load_dwordx4 v34, s[40:43], s60 offen lds
    s_add_u32 s60, s60, 10240
    s_mov_b32 m0, 140288
    s_nop 0
    buffer_load_dwordx4 v30, s[40:43], s60 offen lds
    s_mov_b32 m0, 141312
    s_nop 0
    buffer_load_dwordx4 v31, s[40:43], s60 offen lds
    s_mov_b32 m0, 142336
    s_nop 0
    buffer_load_dwordx4 v32, s[40:43], s60 offen lds
    s_mov_b32 m0, 143360
    s_nop 0
    buffer_load_dwordx4 v33, s[40:43], s60 offen lds
    s_mov_b32 m0, 144384
    s_nop 0
    buffer_load_dwordx4 v34, s[40:43], s60 offen lds
    s_add_u32 s60, s60, 10240
    s_mov_b32 m0, 145408
    s_nop 0
    buffer_load_dwordx4 v30, s[40:43], s60 offen lds
    s_mov_b32 m0, 146432
    s_nop 0
    buffer_load_dwordx4 v31, s[40:43], s60 offen lds
    s_mov_b32 m0, 147456
    s_nop 0
    buffer_load_dwordx4 v32, s[40:43], s60 offen lds
    s_mov_b32 m0, 148480
    s_nop 0
    buffer_load_dwordx4 v33, s[40:43], s60 offen lds
    s_mov_b32 m0, 149504
    s_nop 0
    buffer_load_dwordx4 v34, s[40:43], s60 offen lds
    s_branch L_ld_done
L_ld_ln:
    buffer_load_dwordx4 v[16:19], v102, s[32:35], 0 offen offset:0
    buffer_load_dwordx4 v[20:23], v102, s[32:35], 0 offen offset:128
    buffer_load_dwordx4 v[24:27], v102, s[32:35], 0 offen offset:256
    buffer_load_dwordx4 v[28:31], v102, s[32:35], 0 offen offset:384
    buffer_load_dwordx4 v[32:35], v102, s[32:35], 0 offen offset:512
    buffer_load_dwordx4 v[36:39], v102, s[32:35], 0 offen offset:640
    buffer_load_dwordx4 v[40:43], v102, s[32:35], 0 offen offset:768
    buffer_load_dwordx4 v[44:47], v102, s[32:35], 0 offen offset:896
    buffer_load_dwordx4 v[48:51], v102, s[32:35], 0 offen offset:1024
    buffer_load_dwordx4 v[52:55], v102, s[32:35], 0 offen offset:1152
L_ld_done:
    s_load_dword s58, s[28:29], 0
    s_add_u32 m0, s71, 0
    s_nop 0
    buffer_load_dwordx4 v244, s[36:39], s69 offen offset:0 lds
    buffer_load_dwordx4 v245, s[36:39], s69 offen offset:1024 lds
    buffer_load_dwordx4 v246, s[36:39], s69 offen offset:2048 lds
    s_mov_b64 exec, 0xffffffff
    buffer_load_dwordx4 v247, s[36:39], s69 offen offset:3072 lds
    s_mov_b64 exec, -1
    s_add_u32 s69, s69, 221184
    s_cmp_eq_u32 s69, 2211840
    s_cselect_b32 s69, 0, s69
    s_add_u32 m0, s70, 0
    s_nop 0
    buffer_load_dwordx4 v240, s[32:35], s68 offen offset:0 lds
    buffer_load_dwordx4 v241, s[32:35], s68 offen offset:1024 lds
    buffer_load_dwordx4 v242, s[32:35], s68 offen offset:2048 lds
    buffer_load_dwordx4 v243, s[32:35], s68 offen offset:3072 lds
    s_add_u32 s68, s68, 128
    s_cmp_eq_u32 s68, 1280
    s_cselect_b32 s68, 0, s68
    s_mov_b32 s44, s28
    s_and_b32 s45, s29, 0xffff
    s_mov_b32 s46, 8388608
    s_mov_b32 s47, 0x00020000
    s_mov_b32 s48, s24
    s_and_b32 s49, s25, 0xffff
    s_mov_b32 s50, 2621440
    s_mov_b32 s51, 0x00020000
    s_add_u32 s12, s28, 8388608
    s_addc_u32 s13, s29, 0
    s_and_b32 s13, s13, 0xffff
    s_mov_b32 s14, 7077888
    s_mov_b32 s15, 0x00020000
    s_add_u32 s16, s28, 16777216
    s_addc_u32 s17, s29, 0
    s_and_b32 s17, s17, 0xffff
    s_mov_b32 s18, 2211840
    s_mov_b32 s19, 0x00020000
    v_add_u32 v2, 0, v1
    v_mul_u32_u24 v3, 6554, v2
    v_lshrrev_b32_e64 v3, 16, v3
    v_mul_u32_u24 v3, 1120, v3
    v_lshl_add_u32 v216, v2, 4, v3
    v_add_u32 v2, 64, v1
    v_mul_u32_u24 v3, 6554, v2
    v_lshrrev_b32 v3, 16, v3
    v_mul_u32_u24 v3, 1120, v3
    v_lshl_add_u32 v217, v2, 4, v3
    v_add_u32 v2, 128, v1
    v_mul_u32_u24 v3, 6554, v2
    v_lshrrev_b32 v3, 16, v3
    v_mul_u32_u24 v3, 1120, v3
    v_lshl_add_u32 v218, v2, 4, v3
    v_lshlrev_b32 v223, 4, v1
    v_add_u32 v236, 4096, v223
    v_add_u32 v224, s74, v223
    v_add_u32 v226, s75, v223
    v_add_u32 v225, 61440, v224
    v_add_u32 v221, 61440, v226
    v_min_u32 v238, 26, v1
    v_lshlrev_b32 v238, 7, v238
    s_lshr_b32 s60, s56, 2
    s_lshl_b32 s60, s60, 12
    s_add_u32 s60, s60, 147456
    v_add_u32 v238, s60, v238
    v_lshlrev_b32 v215, 7, v1
    v_add_u32 v215, 131072, v215
    v_and_b32 v239, 15, v1
    v_lshlrev_b32 v239, 3, v239
    s_mul_i32 s60, s52, 384
    s_add_u32 s60, s60, 148992
    v_add_u32 v211, s60, v223
    s_min_u32 s62, s52, 2
    s_sub_u32 s61, s57, s62
    s_lshl_b32 s61, s61, 4
    s_add_u32 s61, s61, 1048576
    s_mul_i32 s60, s52, 192
    s_sub_u32 s63, 3, s73
    s_mov_b32 s64, 1073741824
    v_add_u32 v2, s60, v1
    v_mul_u32_u24 v3, 43691, v2
    v_lshrrev_b32 v3, 17, v3
    v_mul_u32_u24 v4, 3, v3
    v_sub_u32 v2, v2, v4
    v_mul_u32_u24 v3, 10240, v3
    v_lshl_add_u32 v3, v2, 4, v3
    v_add_u32 v3, s61, v3
    v_cmp_gt_u32 vcc, s63, v2
    v_mov_b32 v4, s64
    v_cndmask_b32 v237, v4, v3, vcc
    v_add_u32 v2, s60, v1
    v_add_u32 v2, 64, v2
    v_mul_u32_u24 v3, 43691, v2
    v_lshrrev_b32 v3, 17, v3
    v_mul_u32_u24 v4, 3, v3
    v_sub_u32_e64 v2, v2, v4
    v_mul_u32_u24 v3, 10240, v3
    v_lshl_add_u32 v3, v2, 4, v3
    v_add_u32 v3, s61, v3
    v_cmp_gt_u32 vcc, s63, v2
    v_mov_b32 v4, s64
    v_cndmask_b32 v212, v4, v3, vcc
    v_add_u32_e64 v2, s60, v1
    v_add_u32 v2, 128, v2
    v_mul_u32_u24 v3, 43691, v2
    v_lshrrev_b32 v3, 17, v3
    v_mul_u32_u24 v4, 3, v3
    v_sub_u32_e64 v2, v2, v4
    v_mul_u32_u24 v3, 10240, v3
    v_lshl_add_u32 v3, v2, 4, v3
    v_add_u32 v3, s61, v3
    v_cmp_gt_u32 vcc, s63, v2
    v_mov_b32 v4, s64
    v_cndmask_b32 v213, v4, v3, vcc
    v_and_b32 v2, 15, v1
    v_lshrrev_b32 v3, 4, v1
    v_and_b32 v4, 1, v2
    v_mul_u32_u24 v5, 4162, v4
    v_lshl_add_u32 v5, v2, 1, v5
    v_lshlrev_b32 v6, 4, v3
    v_sub_u32 v5, v6, v5
    v_add_u32 v5, s72, v5
    v_add_u32 v227, 4192, v5
    v_add_u32 v228, 5216, v5
    v_add_u32 v229, 6240, v5
    v_add_u32 v230, 7264, v5
    s_lshl_b32 s62, s62, 4
    s_add_u32 s62, s62, 148992
    v_lshl_add_u32 v5, v2, 1, v3
    v_mul_u32_u24 v5, 48, v5
    v_add_u32 v231, s62, v5
    v_and_b32 v4, 1, v3
    v_lshlrev_b32 v4, 10, v4
    v_lshrrev_b32 v5, 1, v3
    v_lshl_add_u32 v4, v5, 8, v4
    v_lshl_add_u32 v214, v2, 4, v4
    v_add_u32 v222, 162720, v6
    s_lshl_b32 s60, s52, 7
    v_add_u32 v210, s60, v222
    s_lshl_b32 s60, s52, 6
    v_add_u32 v208, s60, v248
    v_add_u32 v209, s60, v249
    s_lshl_b32 s4, s53, 10
    s_lshl_b32 s60, s52, 8
    s_add_u32 s4, s4, s60
    s_add_u32 s4, s4, 16384
    s_and_b32 s62, s54, 1
    s_lshl_b32 s60, s53, 13
    s_lshl_b32 s61, s52, 11
    s_add_u32 s60, s60, s61
    s_mul_i32 s61, s54, 7
    s_add_u32 s7, s61, s62
    s_lshl_b32 s7, s7, 16
    s_add_u32 s7, s7, s60
    s_cmp_eq_u32 s62, 0
    s_cselect_b32 s8, 6, -1
    s_add_u32 s8, s8, s61
    s_lshl_b32 s8, s8, 16
    s_lshl_b32 s62, s62, 9
    s_add_u32 s8, s8, s62
    s_add_u32 s8, s8, s60
    s_lshl_b32 s9, s53, 1
    s_lshr_b32 s60, s52, 1
    s_add_u32 s9, s9, s60
    s_lshl_b32 s9, s9, 4
    s_add_u32 s9, s9, s54
    s_lshl_b32 s9, s9, 7
    s_and_b32 s60, s52, 1
    s_lshl_b32 s60, s60, 2
    s_add_u32 s9, s9, s60
    s_add_u32 s9, s9, 196608
    s_lshl_b32 s11, s57, 12
    s_add_u32 s11, s11, 4194304
    s_lshr_b32 s10, s57, 1
    s_lshl_b32 s10, s10, 7
    s_and_b32 s60, s57, 1
    s_lshl_b32 s60, s60, 2
    s_add_u32 s10, s10, s60
    s_add_u32 s10, s10, 262144
    s_cmp_eq_u32 s76, 0
    s_cselect_b32 s10, 1073741824, s10
    s_cselect_b32 s11, 1073741824, s11
    s_add_u32 s61, s52, 0
    s_and_b32 s61, s61, 3
    s_lshl_b32 s61, s61, 10
    v_add_u32 v232, s61, v223
    s_add_u32 s61, s52, 1
    s_and_b32 s61, s61, 3
    s_lshl_b32 s61, s61, 10
    v_add_u32 v233, s61, v223
    s_add_u32 s61, s52, 2
    s_and_b32 s61, s61, 3
    s_lshl_b32 s61, s61, 10
    v_add_u32 v234, s61, v223
    s_add_u32 s61, s52, 3
    s_and_b32 s61, s61, 3
    s_lshl_b32 s61, s61, 10
    v_add_u32 v235, s61, v223
    s_mul_i32 s60, s56, 7
    s_lshr_b32 s60, s60, 2
    s_and_b32 s61, s55, 3
    s_mul_i32 s61, s61, 7
    s_add_u32 s61, s61, 1
    s_lshr_b32 s61, s61, 1
    s_add_u32 s60, s60, s61
    s_cmp_ge_u32 s60, 14
    s_cselect_b32 s61, 14, 0
    s_sub_u32 s60, s60, s61
    s_mul_i32 s0, s52, 1835008
    s_lshl_b32 s61, s55, 12
    s_add_u32 s0, s0, s61
    s_add_u32 s25, s0, 1835008
    s_lshl_b32 s24, s60, 17
    s_add_u32 s24, s24, s0
    s_mul_i32 s1, s52, 573440
    s_mul_i32 s61, s56, 5120
    s_add_u32 s1, s1, s61
    s_add_u32 s29, s1, 573440
    s_mul_i32 s28, s60, 40960
    s_add_u32 s28, s28, s1
    s_lshl_b32 s60, s55, 6
    s_lshl_b32 s61, s52, 4
    s_add_u32 s60, s60, s61
    s_lshl_b32 s20, s60, 3
    s_add_u32 s20, s20, 16388
    s_mul_i32 s60, s60, 1280
    s_mul_i32 s61, s56, 160
    s_add_u32 s79, s60, s61
    s_lshl_b32 s21, s55, 11
    s_add_u32 s21, s21, 196608
    s_mul_i32 s22, s56, 5120
    s_add_u32 s22, s22, 262144
    s_mul_i32 s60, s56, 327680
    s_lshl_b32 s61, s55, 7
    s_add_u32 s60, s60, s61
    s_add_u32 s23, s60, 4194304
    s_cmp_eq_u32 s52, 3
    s_cbranch_scc1 L_ln
    s_cmp_eq_u32 s76, 0
    s_cbranch_scc1 L_cs
    v_lshlrev_b32 v16, 3, v1
    v_add_u32 v16, s72, v16
    v_and_b32 v2, 15, v1
    v_mul_u32_u24 v2, 544, v2
    v_lshrrev_b32 v3, 4, v1
    v_lshl_add_u32 v2, v3, 4, v2
    v_add_u32 v17, s72, v2
    v_add_u32_e64 v96, 0, v16
    v_add_u32 v97, 2176, v16
    v_add_u32 v98, 4352, v16
    v_add_u32 v99, 6528, v16
    s_mov_b32 s60, 1069066811
    s_mov_b32 s61, 1042479491
    s_waitcnt vmcnt(8)
    v_lshlrev_b32 v12, 16, v12
    v_lshlrev_b32 v254, 16, v13
    v_mul_f32 v12, s60, v12
    v_exp_f32 v12, v12
    v_lshlrev_b32_e64 v18, 16, v8
    v_and_b32 v19, 0xffff0000, v8
    v_cvt_pk_bf16_f32 v12, v12, v12
    v_lshlrev_b32 v12, 16, v12
    v_lshlrev_b32 v20, 16, v9
    v_and_b32 v21, 0xffff0000, v9
    v_mul_f32 v18, s60, v18
    v_mul_f32 v19, s60, v19
    v_exp_f32 v18, v18
    v_exp_f32 v19, v19
    v_lshlrev_b32 v36, 16, v10
    v_lshlrev_b32 v37, 16, v11
    v_and_b32 v38, 0xffff0000, v10
    v_and_b32 v39, 0xffff0000, v11
    v_cvt_pk_bf16_f32 v18, v18, v18
    v_lshlrev_b32 v18, 16, v18
    v_cvt_pk_bf16_f32 v19, v19, v19
    v_lshlrev_b32 v19, 16, v19
    v_mul_f32 v18, v18, v12
    v_mul_f32 v20, v20, v12
    v_mul_f32 v19, v19, v12
    v_mul_f32 v21, v21, v12
    v_mul_f32 v18, s60, v18
    v_mul_f32 v20, s61, v20
    v_mul_f32 v19, s60, v19
    v_mul_f32 v21, s61, v21
    v_add_f32_e64 v14, v12, v12
    v_mul_f32 v40, 0xc3800000, v18
    v_mul_f32 v42, 0x43800000, v20
    v_mul_f32 v41, 0xc3800000, v19
    v_mul_f32 v43, 0x43800000, v21
    v_exp_f32 v40, v40
    v_fract_f32 v42, v42
    v_exp_f32 v41, v41
    v_fract_f32 v43, v43
    v_cos_f32 v32, v42
    v_sin_f32 v33, v42
    v_cos_f32 v34, v43
    v_sin_f32 v35, v43
    v_mul_f32 v56, 0xbf800000, v18
    v_mul_f32 v58, 0x3f800000, v20
    v_mul_f32 v57, 0xbf800000, v19
    v_mul_f32 v59, 0x3f800000, v21
    v_exp_f32 v56, v56
    v_fract_f32 v58, v58
    v_exp_f32 v57, v57
    v_fract_f32 v59, v59
    v_cos_f32 v24, v58
    v_sin_f32 v25, v58
    v_cos_f32 v26, v59
    v_sin_f32 v27, v59
    v_mul_f32 v60, 0xc1000000, v18
    v_mul_f32 v62, 0x41000000, v20
    v_mul_f32 v61, 0xc1000000, v19
    v_mul_f32 v63, 0x41000000, v21
    v_exp_f32 v60, v60
    v_fract_f32 v62, v62
    v_exp_f32 v61, v61
    v_fract_f32 v63, v63
    v_cos_f32 v28, v62
    v_sin_f32 v29, v62
    v_cos_f32 v30, v63
    v_sin_f32 v31, v63
    v_pk_mul_f32 v[32:33], v[32:33], v[40:41] op_sel:[0,0] op_sel_hi:[1,0]
    v_pk_mul_f32 v[34:35], v[34:35], v[40:41] op_sel:[0,1] op_sel_hi:[1,1]
    v_pk_mul_f32 v[24:25], v[24:25], v[56:57] op_sel:[0,0] op_sel_hi:[1,0]
    v_pk_mul_f32 v[26:27], v[26:27], v[56:57] op_sel:[0,1] op_sel_hi:[1,1]
    v_pk_mul_f32 v[28:29], v[28:29], v[60:61] op_sel:[0,0] op_sel_hi:[1,0]
    v_pk_mul_f32 v[30:31], v[30:31], v[60:61] op_sel:[0,1] op_sel_hi:[1,1]
    v_pk_mul_f32 v[40:41], v[36:37], v[32:33] op_sel:[0,0] op_sel_hi:[1,0]
    v_pk_mul_f32 v[42:43], v[38:39], v[34:35] op_sel:[0,0] op_sel_hi:[1,0]
    v_pk_fma_f32 v[52:53], v[36:37], v[32:33], v[40:41] op_sel:[1,1,0] op_sel_hi:[0,1,1] neg_lo:[1,0,0]
    v_pk_fma_f32 v[54:55], v[38:39], v[34:35], v[42:43] op_sel:[1,1,0] op_sel_hi:[0,1,1] neg_lo:[1,0,0]
    v_pk_mul_f32 v[68:69], v[36:37], v[24:25] op_sel:[0,0] op_sel_hi:[1,0]
    v_pk_mul_f32 v[70:71], v[38:39], v[26:27] op_sel:[0,0] op_sel_hi:[1,0]
    v_pk_fma_f32 v[72:73], v[36:37], v[24:25], v[68:69] op_sel:[1,1,0] op_sel_hi:[0,1,1] neg_lo:[1,0,0]
    v_pk_fma_f32 v[74:75], v[38:39], v[26:27], v[70:71] op_sel:[1,1,0] op_sel_hi:[0,1,1] neg_lo:[1,0,0]
    v_cvt_pk_bf16_f32 v100, v36, -v37
    v_cvt_pk_bf16_f32 v101, v38, -v39
    v_cvt_pk_bf16_f32 v102, v52, -v53
    v_cvt_pk_bf16_f32 v103, v54, -v55
    ds_write2_b64 v96, v[100:101], v[102:103] offset0:0 offset1:68
    v_cvt_pk_bf16_f32 v104, v72, -v73
    v_cvt_pk_bf16_f32 v105, v74, -v75
    ds_write_b64 v16, v[104:105] offset:4896
    v_pk_mul_f32 v[40:41], v[52:53], v[32:33] op_sel:[0,0] op_sel_hi:[1,0]
    v_pk_mul_f32 v[42:43], v[54:55], v[34:35] op_sel:[0,0] op_sel_hi:[1,0]
    v_pk_fma_f32 v[48:49], v[52:53], v[32:33], v[40:41] op_sel:[1,1,0] op_sel_hi:[0,1,1] neg_lo:[1,0,0]
    v_pk_fma_f32 v[50:51], v[54:55], v[34:35], v[42:43] op_sel:[1,1,0] op_sel_hi:[0,1,1] neg_lo:[1,0,0]
    v_pk_mul_f32 v[68:69], v[72:73], v[24:25] op_sel:[0,0] op_sel_hi:[1,0]
    v_pk_mul_f32 v[70:71], v[74:75], v[26:27] op_sel:[0,0] op_sel_hi:[1,0]
    v_pk_fma_f32 v[56:57], v[72:73], v[24:25], v[68:69] op_sel:[1,1,0] op_sel_hi:[0,1,1] neg_lo:[1,0,0]
    v_pk_fma_f32 v[58:59], v[74:75], v[26:27], v[70:71] op_sel:[1,1,0] op_sel_hi:[0,1,1] neg_lo:[1,0,0]
    v_pk_mul_f32 v[40:41], v[48:49], v[32:33] op_sel:[0,0] op_sel_hi:[1,0]
    v_pk_mul_f32 v[42:43], v[50:51], v[34:35] op_sel:[0,0] op_sel_hi:[1,0]
    v_pk_fma_f32 v[52:53], v[48:49], v[32:33], v[40:41] op_sel:[1,1,0] op_sel_hi:[0,1,1] neg_lo:[1,0,0]
    v_pk_fma_f32 v[54:55], v[50:51], v[34:35], v[42:43] op_sel:[1,1,0] op_sel_hi:[0,1,1] neg_lo:[1,0,0]
    v_pk_mul_f32 v[68:69], v[56:57], v[24:25] op_sel:[0,0] op_sel_hi:[1,0]
    v_pk_mul_f32 v[70:71], v[58:59], v[26:27] op_sel:[0,0] op_sel_hi:[1,0]
    v_pk_fma_f32 v[72:73], v[56:57], v[24:25], v[68:69] op_sel:[1,1,0] op_sel_hi:[0,1,1] neg_lo:[1,0,0]
    v_pk_fma_f32 v[74:75], v[58:59], v[26:27], v[70:71] op_sel:[1,1,0] op_sel_hi:[0,1,1] neg_lo:[1,0,0]
    v_cvt_pk_bf16_f32 v100, v48, -v49
    v_cvt_pk_bf16_f32 v101, v50, -v51
    v_cvt_pk_bf16_f32 v102, v52, -v53
    v_cvt_pk_bf16_f32 v103, v54, -v55
    ds_write2_b64 v96, v[100:101], v[102:103] offset0:136 offset1:204
    v_cvt_pk_bf16_f32 v104, v56, -v57
    v_cvt_pk_bf16_f32 v105, v58, -v59
    v_cvt_pk_bf16_f32 v106, v72, -v73
    v_cvt_pk_bf16_f32 v107, v74, -v75
    ds_write2_b64 v98, v[104:105], v[106:107] offset0:136 offset1:204
    v_pk_mul_f32 v[40:41], v[52:53], v[32:33] op_sel:[0,0] op_sel_hi:[1,0]
    v_pk_mul_f32 v[42:43], v[54:55], v[34:35] op_sel:[0,0] op_sel_hi:[1,0]
    v_pk_fma_f32 v[48:49], v[52:53], v[32:33], v[40:41] op_sel:[1,1,0] op_sel_hi:[0,1,1] neg_lo:[1,0,0]
    v_pk_fma_f32 v[50:51], v[54:55], v[34:35], v[42:43] op_sel:[1,1,0] op_sel_hi:[0,1,1] neg_lo:[1,0,0]
    v_pk_mul_f32 v[68:69], v[72:73], v[24:25] op_sel:[0,0] op_sel_hi:[1,0]
    v_pk_mul_f32 v[70:71], v[74:75], v[26:27] op_sel:[0,0] op_sel_hi:[1,0]
    v_pk_fma_f32 v[60:61], v[72:73], v[24:25], v[68:69] op_sel:[1,1,0] op_sel_hi:[0,1,1] neg_lo:[1,0,0]
    v_pk_fma_f32 v[62:63], v[74:75], v[26:27], v[70:71] op_sel:[1,1,0] op_sel_hi:[0,1,1] neg_lo:[1,0,0]
    v_pk_mul_f32 v[40:41], v[48:49], v[32:33] op_sel:[0,0] op_sel_hi:[1,0]
    v_pk_mul_f32 v[42:43], v[50:51], v[34:35] op_sel:[0,0] op_sel_hi:[1,0]
    v_pk_fma_f32 v[52:53], v[48:49], v[32:33], v[40:41] op_sel:[1,1,0] op_sel_hi:[0,1,1] neg_lo:[1,0,0]
    v_pk_fma_f32 v[54:55], v[50:51], v[34:35], v[42:43] op_sel:[1,1,0] op_sel_hi:[0,1,1] neg_lo:[1,0,0]
    v_pk_mul_f32 v[68:69], v[60:61], v[24:25] op_sel:[0,0] op_sel_hi:[1,0]
    v_pk_mul_f32 v[70:71], v[62:63], v[26:27] op_sel:[0,0] op_sel_hi:[1,0]
    v_pk_fma_f32 v[72:73], v[60:61], v[24:25], v[68:69] op_sel:[1,1,0] op_sel_hi:[0,1,1] neg_lo:[1,0,0]
    v_pk_fma_f32 v[74:75], v[62:63], v[26:27], v[70:71] op_sel:[1,1,0] op_sel_hi:[0,1,1] neg_lo:[1,0,0]
    v_cvt_pk_bf16_f32 v100, v48, -v49
    v_cvt_pk_bf16_f32 v101, v50, -v51
    v_cvt_pk_bf16_f32 v102, v52, -v53
    v_cvt_pk_bf16_f32 v103, v54, -v55
    ds_write2_b64 v97, v[100:101], v[102:103] offset0:0 offset1:68
    v_cvt_pk_bf16_f32 v104, v60, -v61
    v_cvt_pk_bf16_f32 v105, v62, -v63
    v_cvt_pk_bf16_f32 v106, v72, -v73
    v_cvt_pk_bf16_f32 v107, v74, -v75
    ds_write2_b64 v99, v[104:105], v[106:107] offset0:0 offset1:68
    v_pk_mul_f32 v[40:41], v[52:53], v[32:33] op_sel:[0,0] op_sel_hi:[1,0]
    v_pk_mul_f32 v[42:43], v[54:55], v[34:35] op_sel:[0,0] op_sel_hi:[1,0]
    v_pk_fma_f32 v[48:49], v[52:53], v[32:33], v[40:41] op_sel:[1,1,0] op_sel_hi:[0,1,1] neg_lo:[1,0,0]
    v_pk_fma_f32 v[50:51], v[54:55], v[34:35], v[42:43] op_sel:[1,1,0] op_sel_hi:[0,1,1] neg_lo:[1,0,0]
    v_pk_mul_f32 v[68:69], v[72:73], v[24:25] op_sel:[0,0] op_sel_hi:[1,0]
    v_pk_mul_f32 v[70:71], v[74:75], v[26:27] op_sel:[0,0] op_sel_hi:[1,0]
    v_pk_fma_f32 v[64:65], v[72:73], v[24:25], v[68:69] op_sel:[1,1,0] op_sel_hi:[0,1,1] neg_lo:[1,0,0]
    v_pk_fma_f32 v[66:67], v[74:75], v[26:27], v[70:71] op_sel:[1,1,0] op_sel_hi:[0,1,1] neg_lo:[1,0,0]
    v_pk_mul_f32 v[40:41], v[48:49], v[32:33] op_sel:[0,0] op_sel_hi:[1,0]
    v_pk_mul_f32 v[42:43], v[50:51], v[34:35] op_sel:[0,0] op_sel_hi:[1,0]
    v_pk_fma_f32 v[52:53], v[48:49], v[32:33], v[40:41] op_sel:[1,1,0] op_sel_hi:[0,1,1] neg_lo:[1,0,0]
    v_pk_fma_f32 v[54:55], v[50:51], v[34:35], v[42:43] op_sel:[1,1,0] op_sel_hi:[0,1,1] neg_lo:[1,0,0]
    v_pk_mul_f32 v[68:69], v[64:65], v[24:25] op_sel:[0,0] op_sel_hi:[1,0]
    v_pk_mul_f32 v[70:71], v[66:67], v[26:27] op_sel:[0,0] op_sel_hi:[1,0]
    v_pk_fma_f32 v[72:73], v[64:65], v[24:25], v[68:69] op_sel:[1,1,0] op_sel_hi:[0,1,1] neg_lo:[1,0,0]
    v_pk_fma_f32 v[74:75], v[66:67], v[26:27], v[70:71] op_sel:[1,1,0] op_sel_hi:[0,1,1] neg_lo:[1,0,0]
    v_cvt_pk_bf16_f32 v100, v48, -v49
    v_cvt_pk_bf16_f32 v101, v50, -v51
    v_cvt_pk_bf16_f32 v102, v52, -v53
    v_cvt_pk_bf16_f32 v103, v54, -v55
    ds_write2_b64 v97, v[100:101], v[102:103] offset0:136 offset1:204
    v_cvt_pk_bf16_f32 v104, v64, -v65
    v_cvt_pk_bf16_f32 v105, v66, -v67
    v_cvt_pk_bf16_f32 v106, v72, -v73
    v_cvt_pk_bf16_f32 v107, v74, -v75
    ds_write2_b64 v99, v[104:105], v[106:107] offset0:136 offset1:204
    v_pk_mul_f32 v[40:41], v[52:53], v[32:33] op_sel:[0,0] op_sel_hi:[1,0]
    v_pk_mul_f32 v[42:43], v[54:55], v[34:35] op_sel:[0,0] op_sel_hi:[1,0]
    v_pk_fma_f32 v[48:49], v[52:53], v[32:33], v[40:41] op_sel:[1,1,0] op_sel_hi:[0,1,1] neg_lo:[1,0,0]
    v_pk_fma_f32 v[50:51], v[54:55], v[34:35], v[42:43] op_sel:[1,1,0] op_sel_hi:[0,1,1] neg_lo:[1,0,0]
    v_cvt_pk_bf16_f32 v100, v48, -v49
    v_cvt_pk_bf16_f32 v101, v50, -v51
    ds_write_b64 v16, v[100:101] offset:4352
    ds_read_b128 a[64:67], v17 offset:0
    ds_read_b128 a[68:71], v17 offset:64
    ds_read_b128 a[72:75], v17 offset:128
    ds_read_b128 a[76:79], v17 offset:192
    ds_read_b128 a[80:83], v17 offset:256
    ds_read_b128 a[84:87], v17 offset:320
    ds_read_b128 a[88:91], v17 offset:384
    ds_read_b128 a[92:95], v17 offset:448
    v_pk_mul_f32 v[40:41], v[56:57], v[32:33] op_sel:[0,0] op_sel_hi:[1,0]
    v_pk_mul_f32 v[42:43], v[58:59], v[34:35] op_sel:[0,0] op_sel_hi:[1,0]
    v_pk_fma_f32 v[56:57], v[56:57], v[32:33], v[40:41] op_sel:[1,1,0] op_sel_hi:[0,1,1] neg_lo:[1,0,0]
    v_pk_fma_f32 v[58:59], v[58:59], v[34:35], v[42:43] op_sel:[1,1,0] op_sel_hi:[0,1,1] neg_lo:[1,0,0]
    v_pk_mul_f32 v[68:69], v[60:61], v[32:33] op_sel:[0,0] op_sel_hi:[1,0]
    v_pk_mul_f32 v[70:71], v[62:63], v[34:35] op_sel:[0,0] op_sel_hi:[1,0]
    v_pk_fma_f32 v[60:61], v[60:61], v[32:33], v[68:69] op_sel:[1,1,0] op_sel_hi:[0,1,1] neg_lo:[1,0,0]
    v_pk_fma_f32 v[62:63], v[62:63], v[34:35], v[70:71] op_sel:[1,1,0] op_sel_hi:[0,1,1] neg_lo:[1,0,0]
    v_pk_mul_f32 v[40:41], v[64:65], v[32:33] op_sel:[0,0] op_sel_hi:[1,0]
    v_pk_mul_f32 v[42:43], v[66:67], v[34:35] op_sel:[0,0] op_sel_hi:[1,0]
    v_pk_fma_f32 v[64:65], v[64:65], v[32:33], v[40:41] op_sel:[1,1,0] op_sel_hi:[0,1,1] neg_lo:[1,0,0]
    v_pk_fma_f32 v[66:67], v[66:67], v[34:35], v[42:43] op_sel:[1,1,0] op_sel_hi:[0,1,1] neg_lo:[1,0,0]
    v_pk_mul_f32 v[68:69], v[60:61], v[32:33] op_sel:[0,0] op_sel_hi:[1,0]
    v_pk_mul_f32 v[70:71], v[62:63], v[34:35] op_sel:[0,0] op_sel_hi:[1,0]
    v_pk_fma_f32 v[48:49], v[60:61], v[32:33], v[68:69] op_sel:[1,1,0] op_sel_hi:[0,1,1] neg_lo:[1,0,0]
    v_pk_fma_f32 v[50:51], v[62:63], v[34:35], v[70:71] op_sel:[1,1,0] op_sel_hi:[0,1,1] neg_lo:[1,0,0]
    v_pk_mul_f32 v[40:41], v[48:49], v[32:33] op_sel:[0,0] op_sel_hi:[1,0]
    v_pk_mul_f32 v[42:43], v[50:51], v[34:35] op_sel:[0,0] op_sel_hi:[1,0]
    v_pk_fma_f32 v[52:53], v[48:49], v[32:33], v[40:41] op_sel:[1,1,0] op_sel_hi:[0,1,1] neg_lo:[1,0,0]
    v_pk_fma_f32 v[54:55], v[50:51], v[34:35], v[42:43] op_sel:[1,1,0] op_sel_hi:[0,1,1] neg_lo:[1,0,0]
    v_cvt_pk_bf16_f32 v104, v56, -v57
    v_cvt_pk_bf16_f32 v105, v58, -v59
    v_cvt_pk_bf16_f32 v106, v60, -v61
    v_cvt_pk_bf16_f32 v107, v62, -v63
    ds_write2_b64 v96, v[104:105], v[106:107] offset0:0 offset1:68
    v_cvt_pk_bf16_f32 v100, v64, -v65
    v_cvt_pk_bf16_f32 v101, v66, -v67
    v_cvt_pk_bf16_f32 v102, v48, -v49
    v_cvt_pk_bf16_f32 v103, v50, -v51
    ds_write2_b64 v96, v[100:101], v[102:103] offset0:136 offset1:204
    v_cvt_pk_bf16_f32 v104, v52, -v53
    v_cvt_pk_bf16_f32 v105, v54, -v55
    ds_write_b64 v16, v[104:105] offset:2176
    ds_read_b128 a[96:99], v17 offset:0
    ds_read_b128 a[100:103], v17 offset:64
    ds_read_b128 a[104:107], v17 offset:128
    ds_read_b128 a[108:111], v17 offset:192
    ds_read_b128 a[112:115], v17 offset:256
    ds_read_b128 a[116:119], v17 offset:320
    ds_read_b128 a[120:123], v17 offset:384
    ds_read_b128 a[124:127], v17 offset:448
    v_pk_mul_f32 v[40:41], v[28:29], v[28:29] op_sel:[0,0] op_sel_hi:[1,0]
    v_pk_mul_f32 v[42:43], v[30:31], v[30:31] op_sel:[0,0] op_sel_hi:[1,0]
    v_pk_fma_f32 v[56:57], v[28:29], v[28:29], v[40:41] op_sel:[1,1,0] op_sel_hi:[0,1,1] neg_lo:[1,0,0]
    v_pk_fma_f32 v[58:59], v[30:31], v[30:31], v[42:43] op_sel:[1,1,0] op_sel_hi:[0,1,1] neg_lo:[1,0,0]
    v_mov_b32 v48, 1.0
    v_mov_b32 v49, 0
    v_mov_b32 v50, 1.0
    v_mov_b32 v51, 0
    v_cvt_pk_bf16_f32 v100, v48, v49
    v_cvt_pk_bf16_f32 v101, v50, v51
    v_cvt_pk_bf16_f32 v102, v28, v29
    v_cvt_pk_bf16_f32 v103, v30, v31
    ds_write2_b64 v96, v[100:101], v[102:103] offset0:0 offset1:68
    v_pk_mul_f32 v[68:69], v[28:29], v[56:57] op_sel:[0,0] op_sel_hi:[1,0]
    v_pk_mul_f32 v[70:71], v[30:31], v[58:59] op_sel:[0,0] op_sel_hi:[1,0]
    v_pk_fma_f32 v[60:61], v[28:29], v[56:57], v[68:69] op_sel:[1,1,0] op_sel_hi:[0,1,1] neg_lo:[1,0,0]
    v_pk_fma_f32 v[62:63], v[30:31], v[58:59], v[70:71] op_sel:[1,1,0] op_sel_hi:[0,1,1] neg_lo:[1,0,0]
    v_cvt_pk_bf16_f32 v104, v56, v57
    v_cvt_pk_bf16_f32 v105, v58, v59
    v_cvt_pk_bf16_f32 v106, v60, v61
    v_cvt_pk_bf16_f32 v107, v62, v63
    ds_write2_b64 v96, v[104:105], v[106:107] offset0:136 offset1:204
    v_pk_mul_f32 v[40:41], v[56:57], v[56:57] op_sel:[0,0] op_sel_hi:[1,0]
    v_pk_mul_f32 v[42:43], v[58:59], v[58:59] op_sel:[0,0] op_sel_hi:[1,0]
    v_pk_fma_f32 v[48:49], v[56:57], v[56:57], v[40:41] op_sel:[1,1,0] op_sel_hi:[0,1,1] neg_lo:[1,0,0]
    v_pk_fma_f32 v[50:51], v[58:59], v[58:59], v[42:43] op_sel:[1,1,0] op_sel_hi:[0,1,1] neg_lo:[1,0,0]
    v_pk_mul_f32 v[68:69], v[60:61], v[56:57] op_sel:[0,0] op_sel_hi:[1,0]
    v_pk_mul_f32 v[70:71], v[62:63], v[58:59] op_sel:[0,0] op_sel_hi:[1,0]
    v_pk_fma_f32 v[64:65], v[60:61], v[56:57], v[68:69] op_sel:[1,1,0] op_sel_hi:[0,1,1] neg_lo:[1,0,0]
    v_pk_fma_f32 v[66:67], v[62:63], v[58:59], v[70:71] op_sel:[1,1,0] op_sel_hi:[0,1,1] neg_lo:[1,0,0]
    v_cvt_pk_bf16_f32 v100, v48, v49
    v_cvt_pk_bf16_f32 v101, v50, v51
    v_cvt_pk_bf16_f32 v102, v64, v65
    v_cvt_pk_bf16_f32 v103, v66, v67
    ds_write2_b64 v97, v[100:101], v[102:103] offset0:0 offset1:68
    v_pk_mul_f32 v[40:41], v[48:49], v[56:57] op_sel:[0,0] op_sel_hi:[1,0]
    v_pk_mul_f32 v[42:43], v[50:51], v[58:59] op_sel:[0,0] op_sel_hi:[1,0]
    v_pk_fma_f32 v[52:53], v[48:49], v[56:57], v[40:41] op_sel:[1,1,0] op_sel_hi:[0,1,1] neg_lo:[1,0,0]
    v_pk_fma_f32 v[54:55], v[50:51], v[58:59], v[42:43] op_sel:[1,1,0] op_sel_hi:[0,1,1] neg_lo:[1,0,0]
    v_pk_mul_f32 v[68:69], v[64:65], v[56:57] op_sel:[0,0] op_sel_hi:[1,0]
    v_pk_mul_f32 v[70:71], v[66:67], v[58:59] op_sel:[0,0] op_sel_hi:[1,0]
    v_pk_fma_f32 v[60:61], v[64:65], v[56:57], v[68:69] op_sel:[1,1,0] op_sel_hi:[0,1,1] neg_lo:[1,0,0]
    v_pk_fma_f32 v[62:63], v[66:67], v[58:59], v[70:71] op_sel:[1,1,0] op_sel_hi:[0,1,1] neg_lo:[1,0,0]
    v_cvt_pk_bf16_f32 v104, v52, v53
    v_cvt_pk_bf16_f32 v105, v54, v55
    v_cvt_pk_bf16_f32 v106, v60, v61
    v_cvt_pk_bf16_f32 v107, v62, v63
    ds_write2_b64 v97, v[104:105], v[106:107] offset0:136 offset1:204
    v_pk_mul_f32 v[40:41], v[52:53], v[56:57] op_sel:[0,0] op_sel_hi:[1,0]
    v_pk_mul_f32 v[42:43], v[54:55], v[58:59] op_sel:[0,0] op_sel_hi:[1,0]
    v_pk_fma_f32 v[48:49], v[52:53], v[56:57], v[40:41] op_sel:[1,1,0] op_sel_hi:[0,1,1] neg_lo:[1,0,0]
    v_pk_fma_f32 v[50:51], v[54:55], v[58:59], v[42:43] op_sel:[1,1,0] op_sel_hi:[0,1,1] neg_lo:[1,0,0]
    v_pk_mul_f32 v[68:69], v[60:61], v[56:57] op_sel:[0,0] op_sel_hi:[1,0]
    v_pk_mul_f32 v[70:71], v[62:63], v[58:59] op_sel:[0,0] op_sel_hi:[1,0]
    v_pk_fma_f32 v[64:65], v[60:61], v[56:57], v[68:69] op_sel:[1,1,0] op_sel_hi:[0,1,1] neg_lo:[1,0,0]
    v_pk_fma_f32 v[66:67], v[62:63], v[58:59], v[70:71] op_sel:[1,1,0] op_sel_hi:[0,1,1] neg_lo:[1,0,0]
    v_cvt_pk_bf16_f32 v100, v48, v49
    v_cvt_pk_bf16_f32 v101, v50, v51
    v_cvt_pk_bf16_f32 v102, v64, v65
    v_cvt_pk_bf16_f32 v103, v66, v67
    ds_write2_b64 v98, v[100:101], v[102:103] offset0:0 offset1:68
    v_pk_mul_f32 v[40:41], v[48:49], v[56:57] op_sel:[0,0] op_sel_hi:[1,0]
    v_pk_mul_f32 v[42:43], v[50:51], v[58:59] op_sel:[0,0] op_sel_hi:[1,0]
    v_pk_fma_f32 v[52:53], v[48:49], v[56:57], v[40:41] op_sel:[1,1,0] op_sel_hi:[0,1,1] neg_lo:[1,0,0]
    v_pk_fma_f32 v[54:55], v[50:51], v[58:59], v[42:43] op_sel:[1,1,0] op_sel_hi:[0,1,1] neg_lo:[1,0,0]
    v_pk_mul_f32 v[68:69], v[64:65], v[56:57] op_sel:[0,0] op_sel_hi:[1,0]
    v_pk_mul_f32 v[70:71], v[66:67], v[58:59] op_sel:[0,0] op_sel_hi:[1,0]
    v_pk_fma_f32 v[60:61], v[64:65], v[56:57], v[68:69] op_sel:[1,1,0] op_sel_hi:[0,1,1] neg_lo:[1,0,0]
    v_pk_fma_f32 v[62:63], v[66:67], v[58:59], v[70:71] op_sel:[1,1,0] op_sel_hi:[0,1,1] neg_lo:[1,0,0]
    v_cvt_pk_bf16_f32 v104, v52, v53
    v_cvt_pk_bf16_f32 v105, v54, v55
    v_cvt_pk_bf16_f32 v106, v60, v61
    v_cvt_pk_bf16_f32 v107, v62, v63
    ds_write2_b64 v98, v[104:105], v[106:107] offset0:136 offset1:204
    s_waitcnt vmcnt(0)
    v_pk_mul_f32 v[40:41], v[52:53], v[56:57] op_sel:[0,0] op_sel_hi:[1,0]
    s_nop 0
    v_pk_mul_f32 v[42:43], v[54:55], v[58:59] op_sel:[0,0] op_sel_hi:[1,0]
    v_pk_fma_f32 v[48:49], v[52:53], v[56:57], v[40:41] op_sel:[1,1,0] op_sel_hi:[0,1,1] neg_lo:[1,0,0]
    v_pk_fma_f32 v[50:51], v[54:55], v[58:59], v[42:43] op_sel:[1,1,0] op_sel_hi:[0,1,1] neg_lo:[1,0,0]
    v_pk_mul_f32 v[68:69], v[60:61], v[56:57] op_sel:[0,0] op_sel_hi:[1,0]
    v_pk_mul_f32 v[70:71], v[62:63], v[58:59] op_sel:[0,0] op_sel_hi:[1,0]
    v_pk_fma_f32 v[64:65], v[60:61], v[56:57], v[68:69] op_sel:[1,1,0] op_sel_hi:[0,1,1] neg_lo:[1,0,0]
    v_pk_fma_f32 v[66:67], v[62:63], v[58:59], v[70:71] op_sel:[1,1,0] op_sel_hi:[0,1,1] neg_lo:[1,0,0]
    v_cvt_pk_bf16_f32 v100, v48, v49
    v_cvt_pk_bf16_f32 v101, v50, v51
    v_cvt_pk_bf16_f32 v102, v64, v65
    v_cvt_pk_bf16_f32 v103, v66, v67
    ds_write2_b64 v99, v[100:101], v[102:103] offset0:0 offset1:68
    s_add_u32 s69, s69, 221184
    s_cmp_eq_u32 s69, 2211840
    s_cselect_b32 s69, 0, s69
    s_add_u32 s69, s69, 221184
    s_cmp_eq_u32 s69, 2211840
    s_cselect_b32 s69, 0, s69
    s_add_u32 s68, s68, 128
    s_cmp_eq_u32 s68, 1280
    s_cselect_b32 s68, 0, s68
    s_add_u32 s68, s68, 128
    s_cmp_eq_u32 s68, 1280
    s_cselect_b32 s68, 0, s68
    s_add_u32 s68, s68, 128
    s_cmp_eq_u32 s68, 1280
    s_cselect_b32 s68, 0, s68
    v_pk_mul_f32 v[40:41], v[48:49], v[56:57] op_sel:[0,0] op_sel_hi:[1,0]
    v_pk_mul_f32 v[42:43], v[50:51], v[58:59] op_sel:[0,0] op_sel_hi:[1,0]
    v_pk_fma_f32 v[52:53], v[48:49], v[56:57], v[40:41] op_sel:[1,1,0] op_sel_hi:[0,1,1] neg_lo:[1,0,0]
    s_nop 0
    v_pk_fma_f32 v[54:55], v[50:51], v[58:59], v[42:43] op_sel:[1,1,0] op_sel_hi:[0,1,1] neg_lo:[1,0,0]
    v_pk_mul_f32 v[68:69], v[64:65], v[56:57] op_sel:[0,0] op_sel_hi:[1,0]
    v_pk_mul_f32 v[70:71], v[66:67], v[58:59] op_sel:[0,0] op_sel_hi:[1,0]
    v_pk_fma_f32 v[60:61], v[64:65], v[56:57], v[68:69] op_sel:[1,1,0] op_sel_hi:[0,1,1] neg_lo:[1,0,0]
    v_pk_fma_f32 v[62:63], v[66:67], v[58:59], v[70:71] op_sel:[1,1,0] op_sel_hi:[0,1,1] neg_lo:[1,0,0]
    v_cvt_pk_bf16_f32 v104, v52, v53
    v_cvt_pk_bf16_f32 v105, v54, v55
    v_cvt_pk_bf16_f32 v106, v60, v61
    v_cvt_pk_bf16_f32 v107, v62, v63
    ds_write2_b64 v99, v[104:105], v[106:107] offset0:136 offset1:204
    ds_read_b128 a[0:3], v17 offset:0
    ds_read_b128 a[4:7], v17 offset:64
    ds_read_b128 a[8:11], v17 offset:128
    ds_read_b128 a[12:15], v17 offset:192
    ds_read_b128 a[16:19], v17 offset:256
    ds_read_b128 a[20:23], v17 offset:320
    ds_read_b128 a[24:27], v17 offset:384
    ds_read_b128 a[28:31], v17 offset:448
    v_pk_mul_f32 v[40:41], v[52:53], v[56:57] op_sel:[0,0] op_sel_hi:[1,0]
    v_pk_mul_f32 v[42:43], v[54:55], v[58:59] op_sel:[0,0] op_sel_hi:[1,0]
    v_pk_fma_f32 v[48:49], v[52:53], v[56:57], v[40:41] op_sel:[1,1,0] op_sel_hi:[0,1,1] neg_lo:[1,0,0]
    v_pk_fma_f32 v[50:51], v[54:55], v[58:59], v[42:43] op_sel:[1,1,0] op_sel_hi:[0,1,1] neg_lo:[1,0,0]
    v_pk_mul_f32 v[68:69], v[60:61], v[56:57] op_sel:[0,0] op_sel_hi:[1,0]
    v_pk_mul_f32 v[70:71], v[62:63], v[58:59] op_sel:[0,0] op_sel_hi:[1,0]
    v_pk_fma_f32 v[64:65], v[60:61], v[56:57], v[68:69] op_sel:[1,1,0] op_sel_hi:[0,1,1] neg_lo:[1,0,0]
    v_pk_fma_f32 v[66:67], v[62:63], v[58:59], v[70:71] op_sel:[1,1,0] op_sel_hi:[0,1,1] neg_lo:[1,0,0]
    s_waitcnt lgkmcnt(0)
    v_cvt_pk_bf16_f32 v100, v48, v49
    s_nop 0
    v_cvt_pk_bf16_f32 v101, v50, v51
    v_mfma_f32_16x16x32_bf16 v[80:83], a[0:3], a[64:67], 0
    v_cvt_pk_bf16_f32 v102, v64, v65
    v_cvt_pk_bf16_f32 v103, v66, v67
    ds_write2_b64 v96, v[100:101], v[102:103] offset0:0 offset1:68
    v_mfma_f32_16x16x32_bf16 v[84:87], a[0:3], a[96:99], 0
    v_pk_mul_f32 v[40:41], v[48:49], v[56:57] op_sel:[0,0] op_sel_hi:[1,0]
    v_pk_mul_f32 v[42:43], v[50:51], v[58:59] op_sel:[0,0] op_sel_hi:[1,0]
    v_pk_fma_f32 v[52:53], v[48:49], v[56:57], v[40:41] op_sel:[1,1,0] op_sel_hi:[0,1,1] neg_lo:[1,0,0]
    v_pk_fma_f32 v[54:55], v[50:51], v[58:59], v[42:43] op_sel:[1,1,0] op_sel_hi:[0,1,1] neg_lo:[1,0,0]
    v_pk_mul_f32 v[68:69], v[64:65], v[56:57] op_sel:[0,0] op_sel_hi:[1,0]
    v_pk_mul_f32 v[70:71], v[66:67], v[58:59] op_sel:[0,0] op_sel_hi:[1,0]
    v_pk_fma_f32 v[60:61], v[64:65], v[56:57], v[68:69] op_sel:[1,1,0] op_sel_hi:[0,1,1] neg_lo:[1,0,0]
    v_pk_fma_f32 v[62:63], v[66:67], v[58:59], v[70:71] op_sel:[1,1,0] op_sel_hi:[0,1,1] neg_lo:[1,0,0]
    v_cvt_pk_bf16_f32 v104, v52, v53
    v_cvt_pk_bf16_f32 v105, v54, v55
    v_mfma_f32_16x16x32_bf16 v[80:83], a[4:7], a[68:71], v[80:83]
    v_cvt_pk_bf16_f32 v106, v60, v61
    v_cvt_pk_bf16_f32 v107, v62, v63
    ds_write2_b64 v96, v[104:105], v[106:107] offset0:136 offset1:204
    v_mfma_f32_16x16x32_bf16 v[84:87], a[4:7], a[100:103], v[84:87]
    v_pk_mul_f32 v[40:41], v[52:53], v[56:57] op_sel:[0,0] op_sel_hi:[1,0]
    v_pk_mul_f32 v[42:43], v[54:55], v[58:59] op_sel:[0,0] op_sel_hi:[1,0]
    v_pk_fma_f32 v[48:49], v[52:53], v[56:57], v[40:41] op_sel:[1,1,0] op_sel_hi:[0,1,1] neg_lo:[1,0,0]
    v_pk_fma_f32 v[50:51], v[54:55], v[58:59], v[42:43] op_sel:[1,1,0] op_sel_hi:[0,1,1] neg_lo:[1,0,0]
    v_pk_mul_f32 v[68:69], v[60:61], v[56:57] op_sel:[0,0] op_sel_hi:[1,0]
    v_pk_mul_f32 v[70:71], v[62:63], v[58:59] op_sel:[0,0] op_sel_hi:[1,0]
    v_pk_fma_f32 v[64:65], v[60:61], v[56:57], v[68:69] op_sel:[1,1,0] op_sel_hi:[0,1,1] neg_lo:[1,0,0]
    v_pk_fma_f32 v[66:67], v[62:63], v[58:59], v[70:71] op_sel:[1,1,0] op_sel_hi:[0,1,1] neg_lo:[1,0,0]
    v_cvt_pk_bf16_f32 v100, v48, v49
    v_cvt_pk_bf16_f32 v101, v50, v51
    v_mfma_f32_16x16x32_bf16 v[80:83], a[8:11], a[72:75], v[80:83]
    v_cvt_pk_bf16_f32 v102, v64, v65
    v_cvt_pk_bf16_f32 v103, v66, v67
    ds_write2_b64 v97, v[100:101], v[102:103] offset0:0 offset1:68
    v_mfma_f32_16x16x32_bf16 v[84:87], a[8:11], a[104:107], v[84:87]
    v_pk_mul_f32 v[40:41], v[48:49], v[56:57] op_sel:[0,0] op_sel_hi:[1,0]
    v_pk_mul_f32 v[42:43], v[50:51], v[58:59] op_sel:[0,0] op_sel_hi:[1,0]
    v_pk_fma_f32 v[52:53], v[48:49], v[56:57], v[40:41] op_sel:[1,1,0] op_sel_hi:[0,1,1] neg_lo:[1,0,0]
    v_pk_fma_f32 v[54:55], v[50:51], v[58:59], v[42:43] op_sel:[1,1,0] op_sel_hi:[0,1,1] neg_lo:[1,0,0]
    v_pk_mul_f32 v[68:69], v[64:65], v[56:57] op_sel:[0,0] op_sel_hi:[1,0]
    v_pk_mul_f32 v[70:71], v[66:67], v[58:59] op_sel:[0,0] op_sel_hi:[1,0]
    v_pk_fma_f32 v[60:61], v[64:65], v[56:57], v[68:69] op_sel:[1,1,0] op_sel_hi:[0,1,1] neg_lo:[1,0,0]
    v_pk_fma_f32 v[62:63], v[66:67], v[58:59], v[70:71] op_sel:[1,1,0] op_sel_hi:[0,1,1] neg_lo:[1,0,0]
    v_cvt_pk_bf16_f32 v104, v52, v53
    v_cvt_pk_bf16_f32 v105, v54, v55
    v_mfma_f32_16x16x32_bf16 v[80:83], a[12:15], a[76:79], v[80:83]
    v_cvt_pk_bf16_f32 v106, v60, v61
    v_cvt_pk_bf16_f32 v107, v62, v63
    ds_write2_b64 v97, v[104:105], v[106:107] offset0:136 offset1:204
    v_mfma_f32_16x16x32_bf16 v[84:87], a[12:15], a[108:111], v[84:87]
    v_pk_mul_f32 v[40:41], v[52:53], v[56:57] op_sel:[0,0] op_sel_hi:[1,0]
    v_pk_mul_f32 v[42:43], v[54:55], v[58:59] op_sel:[0,0] op_sel_hi:[1,0]
    v_pk_fma_f32 v[48:49], v[52:53], v[56:57], v[40:41] op_sel:[1,1,0] op_sel_hi:[0,1,1] neg_lo:[1,0,0]
    v_pk_fma_f32 v[50:51], v[54:55], v[58:59], v[42:43] op_sel:[1,1,0] op_sel_hi:[0,1,1] neg_lo:[1,0,0]
    v_pk_mul_f32 v[68:69], v[60:61], v[56:57] op_sel:[0,0] op_sel_hi:[1,0]
    v_pk_mul_f32 v[70:71], v[62:63], v[58:59] op_sel:[0,0] op_sel_hi:[1,0]
    v_pk_fma_f32 v[64:65], v[60:61], v[56:57], v[68:69] op_sel:[1,1,0] op_sel_hi:[0,1,1] neg_lo:[1,0,0]
    v_pk_fma_f32 v[66:67], v[62:63], v[58:59], v[70:71] op_sel:[1,1,0] op_sel_hi:[0,1,1] neg_lo:[1,0,0]
    v_cvt_pk_bf16_f32 v100, v48, v49
    v_cvt_pk_bf16_f32 v101, v50, v51
    v_mfma_f32_16x16x32_bf16 v[80:83], a[16:19], a[80:83], v[80:83]
    v_cvt_pk_bf16_f32 v102, v64, v65
    v_cvt_pk_bf16_f32 v103, v66, v67
    ds_write2_b64 v98, v[100:101], v[102:103] offset0:0 offset1:68
    v_mfma_f32_16x16x32_bf16 v[84:87], a[16:19], a[112:115], v[84:87]
    v_pk_mul_f32 v[40:41], v[48:49], v[56:57] op_sel:[0,0] op_sel_hi:[1,0]
    v_pk_mul_f32 v[42:43], v[50:51], v[58:59] op_sel:[0,0] op_sel_hi:[1,0]
    v_pk_fma_f32 v[52:53], v[48:49], v[56:57], v[40:41] op_sel:[1,1,0] op_sel_hi:[0,1,1] neg_lo:[1,0,0]
    v_pk_fma_f32 v[54:55], v[50:51], v[58:59], v[42:43] op_sel:[1,1,0] op_sel_hi:[0,1,1] neg_lo:[1,0,0]
    v_pk_mul_f32 v[68:69], v[64:65], v[56:57] op_sel:[0,0] op_sel_hi:[1,0]
    v_pk_mul_f32 v[70:71], v[66:67], v[58:59] op_sel:[0,0] op_sel_hi:[1,0]
    v_pk_fma_f32 v[60:61], v[64:65], v[56:57], v[68:69] op_sel:[1,1,0] op_sel_hi:[0,1,1] neg_lo:[1,0,0]
    v_pk_fma_f32 v[62:63], v[66:67], v[58:59], v[70:71] op_sel:[1,1,0] op_sel_hi:[0,1,1] neg_lo:[1,0,0]
    v_cvt_pk_bf16_f32 v104, v52, v53
    v_cvt_pk_bf16_f32 v105, v54, v55
    v_mfma_f32_16x16x32_bf16 v[80:83], a[20:23], a[84:87], v[80:83]
    v_cvt_pk_bf16_f32 v106, v60, v61
    v_cvt_pk_bf16_f32 v107, v62, v63
    ds_write2_b64 v98, v[104:105], v[106:107] offset0:136 offset1:204
    v_mfma_f32_16x16x32_bf16 v[84:87], a[20:23], a[116:119], v[84:87]
    v_pk_mul_f32 v[40:41], v[52:53], v[56:57] op_sel:[0,0] op_sel_hi:[1,0]
    v_pk_mul_f32 v[42:43], v[54:55], v[58:59] op_sel:[0,0] op_sel_hi:[1,0]
    v_pk_fma_f32 v[48:49], v[52:53], v[56:57], v[40:41] op_sel:[1,1,0] op_sel_hi:[0,1,1] neg_lo:[1,0,0]
    v_pk_fma_f32 v[50:51], v[54:55], v[58:59], v[42:43] op_sel:[1,1,0] op_sel_hi:[0,1,1] neg_lo:[1,0,0]
    v_pk_mul_f32 v[68:69], v[60:61], v[56:57] op_sel:[0,0] op_sel_hi:[1,0]
    v_pk_mul_f32 v[70:71], v[62:63], v[58:59] op_sel:[0,0] op_sel_hi:[1,0]
    v_pk_fma_f32 v[64:65], v[60:61], v[56:57], v[68:69] op_sel:[1,1,0] op_sel_hi:[0,1,1] neg_lo:[1,0,0]
    v_pk_fma_f32 v[66:67], v[62:63], v[58:59], v[70:71] op_sel:[1,1,0] op_sel_hi:[0,1,1] neg_lo:[1,0,0]
    v_cvt_pk_bf16_f32 v100, v48, v49
    v_cvt_pk_bf16_f32 v101, v50, v51
    v_mfma_f32_16x16x32_bf16 v[80:83], a[24:27], a[88:91], v[80:83]
    v_cvt_pk_bf16_f32 v102, v64, v65
    v_cvt_pk_bf16_f32 v103, v66, v67
    ds_write2_b64 v99, v[100:101], v[102:103] offset0:0 offset1:68
    v_mfma_f32_16x16x32_bf16 v[84:87], a[24:27], a[120:123], v[84:87]
    v_pk_mul_f32 v[40:41], v[48:49], v[56:57] op_sel:[0,0] op_sel_hi:[1,0]
    v_pk_mul_f32 v[42:43], v[50:51], v[58:59] op_sel:[0,0] op_sel_hi:[1,0]
    v_pk_fma_f32 v[52:53], v[48:49], v[56:57], v[40:41] op_sel:[1,1,0] op_sel_hi:[0,1,1] neg_lo:[1,0,0]
    v_pk_fma_f32 v[54:55], v[50:51], v[58:59], v[42:43] op_sel:[1,1,0] op_sel_hi:[0,1,1] neg_lo:[1,0,0]
    v_pk_mul_f32 v[68:69], v[64:65], v[56:57] op_sel:[0,0] op_sel_hi:[1,0]
    v_pk_mul_f32 v[70:71], v[66:67], v[58:59] op_sel:[0,0] op_sel_hi:[1,0]
    v_pk_fma_f32 v[60:61], v[64:65], v[56:57], v[68:69] op_sel:[1,1,0] op_sel_hi:[0,1,1] neg_lo:[1,0,0]
    v_pk_fma_f32 v[62:63], v[66:67], v[58:59], v[70:71] op_sel:[1,1,0] op_sel_hi:[0,1,1] neg_lo:[1,0,0]
    v_cvt_pk_bf16_f32 v104, v52, v53
    v_cvt_pk_bf16_f32 v105, v54, v55
    v_mfma_f32_16x16x32_bf16 v[80:83], a[28:31], a[92:95], v[80:83]
    v_cvt_pk_bf16_f32 v106, v60, v61
    v_cvt_pk_bf16_f32 v107, v62, v63
    ds_write2_b64 v99, v[104:105], v[106:107] offset0:136 offset1:204
    v_mfma_f32_16x16x32_bf16 v[84:87], a[28:31], a[124:127], v[84:87]
    ds_read_b128 a[32:35], v17 offset:0
    ds_read_b128 a[36:39], v17 offset:64
    ds_read_b128 a[40:43], v17 offset:128
    ds_read_b128 a[44:47], v17 offset:192
    ds_read_b128 a[48:51], v17 offset:256
    ds_read_b128 a[52:55], v17 offset:320
    ds_read_b128 a[56:59], v17 offset:384
    ds_read_b128 a[60:63], v17 offset:448
    v_and_b32 v2, 15, v1
    v_lshrrev_b32 v3, 4, v1
    v_lshlrev_b32 v4, 7, v2
    s_min_u32 s62, s52, 2
    s_mul_i32 s62, s62, 2688
    s_add_u32 s62, s62, 150528
    v_lshl_add_u32 v4, v3, 4, v4
    v_add_u32 v4, s62, v4
    v_lshlrev_b32 v18, 2, v1
    v_add_u32 v18, s62, v18
    v_lshlrev_b32 v3, 4, v1
    v_sub_u32 v19, s72, v3
    v_add_u32 v19, 1008, v19
    v_and_b32 v5, 31, v1
    v_lshlrev_b32 v5, 2, v5
    v_add_u32 v5, s62, v5
    v_cmp_gt_u32 vcc, 32, v1
    s_waitcnt lgkmcnt(7)
    v_mfma_f32_16x16x32_bf16 v[88:91], a[32:35], a[64:67], 0
    v_mfma_f32_16x16x32_bf16 v[92:95], a[32:35], a[96:99], 0
    s_waitcnt lgkmcnt(6)
    v_mfma_f32_16x16x32_bf16 v[88:91], a[36:39], a[68:71], v[88:91]
    v_mfma_f32_16x16x32_bf16 v[92:95], a[36:39], a[100:103], v[92:95]
    s_waitcnt lgkmcnt(5)
    v_mfma_f32_16x16x32_bf16 v[88:91], a[40:43], a[72:75], v[88:91]
    v_mfma_f32_16x16x32_bf16 v[92:95], a[40:43], a[104:107], v[92:95]
    s_waitcnt lgkmcnt(4)
    v_mfma_f32_16x16x32_bf16 v[88:91], a[44:47], a[76:79], v[88:91]
    v_mfma_f32_16x16x32_bf16 v[92:95], a[44:47], a[108:111], v[92:95]
    s_waitcnt lgkmcnt(3)
    v_mfma_f32_16x16x32_bf16 v[88:91], a[48:51], a[80:83], v[88:91]
    v_mfma_f32_16x16x32_bf16 v[92:95], a[48:51], a[112:115], v[92:95]
    s_waitcnt lgkmcnt(2)
    v_mfma_f32_16x16x32_bf16 v[88:91], a[52:55], a[84:87], v[88:91]
    v_mfma_f32_16x16x32_bf16 v[92:95], a[52:55], a[116:119], v[92:95]
    s_waitcnt lgkmcnt(1)
    v_mfma_f32_16x16x32_bf16 v[88:91], a[56:59], a[88:91], v[88:91]
    v_mfma_f32_16x16x32_bf16 v[92:95], a[56:59], a[120:123], v[92:95]
    s_waitcnt lgkmcnt(0)
    v_mfma_f32_16x16x32_bf16 v[88:91], a[60:63], a[92:95], v[88:91]
    v_mfma_f32_16x16x32_bf16 v[92:95], a[60:63], a[124:127], v[92:95]
    v_mov_b32 v7, 128
    v_mov_b32 v3, 1152
    v_cndmask_b32 v7, v7, v3, vcc
    v_add_u32 v57, v5, v7
    v_mov_b32 v7, 2048
    v_mov_b32 v3, 1280
    v_cndmask_b32 v7, v7, v3, vcc
    v_add_u32_e64 v58, v5, v7
    v_mov_b32 v7, 2176
    v_mov_b32 v3, 1408
    v_cndmask_b32 v7, v7, v3, vcc
    v_add_u32 v59, v5, v7
    v_mov_b32 v7, 2176
    v_mov_b32 v3, 1536
    v_cndmask_b32 v7, v7, v3, vcc
    v_add_u32 v60, v5, v7
    v_mov_b32 v7, 2176
    v_mov_b32 v3, 1664
    v_cndmask_b32 v7, v7, v3, vcc
    v_add_u32 v61, v5, v7
    v_mov_b32 v7, 2304
    v_mov_b32 v3, 1792
    v_cndmask_b32 v7, v7, v3, vcc
    v_add_u32 v62, v5, v7
    v_mov_b32 v7, 132
    v_mov_b32 v3, 1920
    v_cndmask_b32 v7, v7, v3, vcc
    v_add_u32 v63, v5, v7
    v_mul_f32 v80, v14, v80
    v_mul_f32 v81, v14, v81
    v_mul_f32 v82, v14, v82
    v_mul_f32 v83, v14, v83
    v_mul_f32 v84, v14, v84
    v_mul_f32 v85, v14, v85
    v_mul_f32 v86, v14, v86
    v_mul_f32 v87, v14, v87
    v_cmp_gt_u32 vcc, 5, v2
    v_mul_f32 v88, v14, v88
    v_mul_f32 v89, v14, v89
    v_mul_f32 v90, v14, v90
    v_mul_f32 v91, v14, v91
    v_mul_f32 v92, v14, v92
    v_mul_f32 v93, v14, v93
    v_mul_f32 v94, v14, v94
    v_mul_f32_e64 v95, v14, v95
    ds_write_b128 v4, v[80:83] offset:0
    ds_write_b128 v4, v[88:91] offset:64
    s_and_saveexec_b64 s[60:61], vcc
    ds_write_b128 v4, v[84:87] offset:2048
    ds_write_b128 v4, v[92:95] offset:2112
    s_mov_b64 exec, -1
    ds_read_b32 v24, v18 offset:0
    ds_read_b32 v32, v18 offset:4
    ds_read_b32 v25, v57 offset:0
    ds_read_b32 v26, v58 offset:0
    ds_read_b32 v27, v59 offset:0
    ds_read_b32 v28, v60 offset:0
    ds_read_b32 v29, v61 offset:0
    ds_read_b32 v30, v62 offset:0
    ds_read_b32 v31, v63 offset:0
    ds_read_b32 v44, v18 offset:256
    ds_read_b32 v45, v18 offset:2432
    ds_read_b32 v46, v18 offset:260
    ds_read_b32 v64, v18 offset:512
    ds_read_b32 v65, v18 offset:516
    ds_read_b32 v66, v18 offset:768
    ds_read_b32 v67, v18 offset:772
    v_mov_b32 v49, 0
    v_mov_b32 v50, 0
    v_mov_b32 v51, 0
    v_mov_b32 v52, 0
    v_mov_b32 v53, 0
    v_mov_b32 v54, 0
    v_mov_b32 v55, 0
    v_mov_b32 v2, s72
    v_and_b32 v3, 1, v1
    v_cmp_eq_u32_e64 vcc, 0, v3
    s_waitcnt lgkmcnt(7)
    v_cvt_pk_bf16_f32 v36, v31, v30
    v_cvt_pk_bf16_f32 v37, v29, v28
    v_cvt_pk_bf16_f32 v38, v27, v26
    v_cvt_pk_bf16_f32 v39, v25, v24
    ds_write_b128 v19, v[36:39] offset:3072
    v_cvt_pk_bf16_f32 v40, v32, v31
    v_cvt_pk_bf16_f32 v41, v30, v29
    v_cvt_pk_bf16_f32 v42, v28, v27
    v_cvt_pk_bf16_f32 v43, v26, v25
    ds_write_b128 v19, v[40:43] offset:7232
    v_cvt_pk_bf16_f32 v48, v24, 0
    s_mov_b64 exec, 1
    ds_write_b128 v2, v[48:51] offset:8256
    ds_write_b128 v2, v[52:55] offset:8272
    ds_write_b128 v2, v[52:55] offset:4096
    ds_write_b128 v2, v[52:55] offset:4112
    s_mov_b64 exec, -1
    s_waitcnt lgkmcnt(6)
    s_nop 0
    v_cvt_pk_bf16_f32 v36, v46, v46
    v_cvt_pk_bf16_f32 v37, v45, v45
    v_cvt_pk_bf16_f32 v38, v45, v44
    v_cvt_pk_bf16_f32 v39, v44, v44
    ds_write_b128 v19, v[36:39] offset:2048
    v_cvt_pk_bf16_f32 v40, v46, v46
    v_cvt_pk_bf16_f32 v41, v46, v45
    v_cvt_pk_bf16_f32 v42, v45, v45
    v_cvt_pk_bf16_f32 v43, v44, v44
    ds_write_b128 v19, v[40:43] offset:6208
    v_cndmask_b32_e64 v28, v65, v64, vcc
    v_cvt_pk_bf16_f32 v36, v65, v65
    v_cvt_pk_bf16_f32 v37, v65, v28
    v_cvt_pk_bf16_f32 v38, v64, v64
    v_cvt_pk_bf16_f32 v39, v64, v64
    ds_write_b128 v19, v[36:39] offset:1024
    v_cvt_pk_bf16_f32 v40, v65, v65
    v_cvt_pk_bf16_f32 v41, v65, v65
    v_cvt_pk_bf16_f32 v42, v28, v64
    v_cvt_pk_bf16_f32 v43, v64, v64
    ds_write_b128 v19, v[40:43] offset:5184
    v_cndmask_b32_e64 v28, v67, v66, vcc
    v_cvt_pk_bf16_f32 v36, v67, v67
    v_cvt_pk_bf16_f32 v37, v67, v28
    v_cvt_pk_bf16_f32 v38, v66, v66
    v_cvt_pk_bf16_f32 v39, v66, v66
    ds_write_b128 v19, v[36:39] offset:0
    v_cvt_pk_bf16_f32 v40, v67, v67
    v_cvt_pk_bf16_f32 v41, v67, v67
    v_cvt_pk_bf16_f32 v42, v28, v66
    v_cvt_pk_bf16_f32 v43, v66, v66
    ds_write_b128 v19, v[40:43] offset:4160
    s_mul_i32 s58, s58, 0x9E3779B1
    s_add_u32 s58, s58, 0x7F4A7C15
    s_branch L_gemm1
L_cs:
    s_lshr_b32 s62, s3, 1
    s_and_b32 s31, s3, 1
    s_lshl_b32 s31, s31, 12
    s_lshr_b32 s30, s3, 2
    s_lshl_b32 s30, s30, 7
    s_add_u32 s31, s31, s30
    s_and_b32 s30, s62, 1
    s_lshl_b32 s30, s30, 2
    s_add_u32 s31, s31, s30
    s_add_u32 s31, s31, 147456
    s_mul_i32 s3, s3, 20480
    s_mul_i32 s63, s62, 37
    s_lshr_b32 s63, s63, 8
    s_mul_i32 s63, s63, 7
    s_sub_u32 s63, s62, s63
    s_cmp_eq_u32 s63, 3
    s_cselect_b32 s63, 8, 4
    s_cselect_b32 s64, 4, 16
    v_lshrrev_b32 v2, 4, v1
    v_mul_u32_u24 v2, s63, v2
    v_bfe_u32 v3, v1, 2, 2
    v_add_u32 v2, v2, v3
    v_add_u32 v3, s64, v2
    v_and_b32 v4, 3, v1
    v_lshlrev_b32 v4, 3, v4
    v_add_u32 v4, 92160, v4
    v_lshrrev_b32 v5, 4, v2
    v_mul_u32_u24 v5, 37888, v5
    v_mul_u32_u24 v2, 640, v2
    v_add3_u32 v2, v2, v5, v4
    v_lshrrev_b32_e64 v5, 4, v3
    v_mul_u32_u24 v5, 37888, v5
    v_mul_u32_u24 v3, 640, v3
    v_add3_u32 v3, v3, v5, v4
    s_add_u32 s69, s69, 221184
    s_cmp_eq_u32 s69, 2211840
    s_cselect_b32 s69, 0, s69
    s_add_u32 s69, s69, 221184
    s_cmp_eq_u32 s69, 2211840
    s_cselect_b32 s69, 0, s69
    s_add_u32 s68, s68, 128
    s_cmp_eq_u32 s68, 1280
    s_cselect_b32 s68, 0, s68
    s_add_u32 s68, s68, 128
    s_cmp_eq_u32 s68, 1280
    s_cselect_b32 s68, 0, s68
    s_add_u32 s68, s68, 128
    s_cmp_eq_u32 s68, 1280
    s_cselect_b32 s68, 0, s68
    s_waitcnt vmcnt(8)
    ds_read_b64_tr_b16 v[100:101], v2 offset:0
    ds_read_b64_tr_b16 v[102:103], v3 offset:0
    ds_read_b64_tr_b16 v[104:105], v2 offset:32
    ds_read_b64_tr_b16 v[106:107], v3 offset:32
    ds_read_b64_tr_b16 v[108:109], v2 offset:64
    ds_read_b64_tr_b16 v[110:111], v3 offset:64
    ds_read_b64_tr_b16 v[112:113], v2 offset:96
    ds_read_b64_tr_b16 v[114:115], v3 offset:96
    ds_read_b64_tr_b16 v[116:117], v2 offset:128
    ds_read_b64_tr_b16 v[118:119], v3 offset:128
    ds_read_b64_tr_b16 v[120:121], v2 offset:160
    ds_read_b64_tr_b16 v[122:123], v3 offset:160
    ds_read_b64_tr_b16 v[124:125], v2 offset:192
    ds_read_b64_tr_b16 v[126:127], v3 offset:192
    ds_read_b64_tr_b16 v[128:129], v2 offset:224
    ds_read_b64_tr_b16 v[130:131], v3 offset:224
    ds_read_b64_tr_b16 v[132:133], v2 offset:256
    ds_read_b64_tr_b16 v[134:135], v3 offset:256
    ds_read_b64_tr_b16 v[136:137], v2 offset:288
    ds_read_b64_tr_b16 v[138:139], v3 offset:288
    s_waitcnt lgkmcnt(10)
    buffer_store_dwordx4 v[100:103], v223, s[16:19], s3 offen offset:0 sc1
    s_nop 0
    buffer_store_dwordx4 v[104:107], v223, s[16:19], s3 offen offset:1024 sc1
    buffer_store_dwordx4 v[108:111], v223, s[16:19], s3 offen offset:2048 sc1
    buffer_store_dwordx4 v[112:115], v223, s[16:19], s3 offen offset:3072 sc1
    buffer_store_dwordx4 v[116:119], v236, s[16:19], s3 offen offset:0 sc1
    s_add_u32 s3, s3, 5120
    ds_read_b64_tr_b16 v[140:141], v2 offset:320
    ds_read_b64_tr_b16 v[142:143], v3 offset:320
    ds_read_b64_tr_b16 v[144:145], v2 offset:352
    ds_read_b64_tr_b16 v[146:147], v3 offset:352
    ds_read_b64_tr_b16 v[148:149], v2 offset:384
    ds_read_b64_tr_b16 v[150:151], v3 offset:384
    ds_read_b64_tr_b16 v[152:153], v2 offset:416
    ds_read_b64_tr_b16 v[154:155], v3 offset:416
    ds_read_b64_tr_b16 v[156:157], v2 offset:448
    ds_read_b64_tr_b16 v[158:159], v3 offset:448
    s_waitcnt lgkmcnt(10)
    s_nop 0
    buffer_store_dwordx4 v[120:123], v223, s[16:19], s3 offen offset:0 sc1
    buffer_store_dwordx4 v[124:127], v223, s[16:19], s3 offen offset:1024 sc1
    buffer_store_dwordx4 v[128:131], v223, s[16:19], s3 offen offset:2048 sc1
    buffer_store_dwordx4 v[132:135], v223, s[16:19], s3 offen offset:3072 sc1
    buffer_store_dwordx4 v[136:139], v236, s[16:19], s3 offen offset:0 sc1
    s_add_u32 s3, s3, 5120
    ds_read_b64_tr_b16 v[160:161], v2 offset:480
    ds_read_b64_tr_b16 v[162:163], v3 offset:480
    ds_read_b64_tr_b16 v[164:165], v2 offset:512
    ds_read_b64_tr_b16 v[166:167], v3 offset:512
    ds_read_b64_tr_b16 v[168:169], v2 offset:544
    ds_read_b64_tr_b16 v[170:171], v3 offset:544
    ds_read_b64_tr_b16 v[172:173], v2 offset:576
    ds_read_b64_tr_b16 v[174:175], v3 offset:576
    ds_read_b64_tr_b16 v[176:177], v2 offset:608
    ds_read_b64_tr_b16 v[178:179], v3 offset:608
    s_waitcnt lgkmcnt(10)
    buffer_store_dwordx4 v[140:143], v223, s[16:19], s3 offen offset:0 sc1
    buffer_store_dwordx4 v[144:147], v223, s[16:19], s3 offen offset:1024 sc1
    buffer_store_dwordx4 v[148:151], v223, s[16:19], s3 offen offset:2048 sc1
    buffer_store_dwordx4 v[152:155], v223, s[16:19], s3 offen offset:3072 sc1
    buffer_store_dwordx4 v[156:159], v236, s[16:19], s3 offen offset:0 sc1
    s_add_u32 s3, s3, 5120
    s_waitcnt lgkmcnt(0)
    buffer_store_dwordx4 v[160:163], v223, s[16:19], s3 offen offset:0 sc1
    buffer_store_dwordx4 v[164:167], v223, s[16:19], s3 offen offset:1024 sc1
    buffer_store_dwordx4 v[168:171], v223, s[16:19], s3 offen offset:2048 sc1
    buffer_store_dwordx4 v[172:175], v223, s[16:19], s3 offen offset:3072 sc1
    buffer_store_dwordx4 v[176:179], v236, s[16:19], s3 offen offset:0 sc1
    s_mov_b32 s60, s31
    s_mul_i32 s58, s58, 0x9E3779B1
    s_add_u32 s58, s58, 0x7F4A7C15
    s_waitcnt vmcnt(0)
    v_mov_b32 v2, 0
    v_mov_b32 v3, s58
    s_mov_b64 exec, 1
    buffer_store_dword v3, v2, s[44:47], s60 offen sc1
    s_mov_b64 exec, -1
    s_branch L_gemm1b
L_ln:
    v_subrev_u32 v196, 124416, v244
    s_nop 0
    v_subrev_u32 v200, 122880, v240
    v_subrev_u32 v197, 124416, v245
    v_subrev_u32 v201, 122880, v241
    v_subrev_u32 v198, 124416, v246
    v_subrev_u32 v202, 122880, v242
    v_subrev_u32 v199, 124416, v247
    v_subrev_u32 v203, 122880, v243
    v_mov_b32 v2, 163232
    v_mov_b32 v3, 0
    ds_write_b32 v2, v3
    ds_write_b32 v2, v3 offset:4
    ds_write_b32 v2, v3 offset:8
    v_lshrrev_b32 v12, 3, v1
    v_mul_u32_u24 v2, 272, v12
    v_and_b32 v3, 7, v1
    v_lshl_add_u32 v2, v3, 4, v2
    v_add_u32 v2, 158592, v2
    v_lshlrev_b32 v12, 3, v12
    v_bfe_u32 v3, v1, 2, 2
    v_mul_u32_u24 v3, 272, v3
    v_and_b32 v13, 3, v1
    v_lshl_add_u32 v3, v13, 3, v3
    v_lshrrev_b32 v13, 4, v1
    v_lshl_add_u32 v3, v13, 5, v3
    v_add_u32 v3, 158592, v3
    v_lshlrev_b32 v13, 4, v1
    s_waitcnt vmcnt(16)
    v_lshlrev_b32_e64 v56, 16, v16
    v_and_b32 v57, 0xffff0000, v16
    v_lshlrev_b32 v58, 16, v17
    v_and_b32 v59, 0xffff0000, v17
    v_pk_mul_f32 v[6:7], v[56:57], v[56:57]
    v_lshlrev_b32 v60, 16, v18
    v_and_b32 v61, 0xffff0000, v18
    v_pk_mul_f32 v[10:11], v[58:59], v[58:59]
    v_lshlrev_b32_e64 v62, 16, v19
    v_and_b32 v63, 0xffff0000, v19
    v_pk_fma_f32 v[6:7], v[60:61], v[60:61], v[6:7]
    v_pk_add_f32 v[4:5], v[56:57], v[60:61]
    v_lshlrev_b32_e64 v64, 16, v20
    v_and_b32 v65, 0xffff0000, v20
    v_pk_fma_f32 v[10:11], v[62:63], v[62:63], v[10:11]
    v_pk_add_f32 v[8:9], v[58:59], v[62:63]
    v_lshlrev_b32_e64 v66, 16, v21
    v_and_b32 v67, 0xffff0000, v21
    v_pk_fma_f32 v[6:7], v[64:65], v[64:65], v[6:7]
    v_pk_add_f32 v[4:5], v[4:5], v[64:65]
    v_lshlrev_b32_e64 v68, 16, v22
    v_and_b32 v69, 0xffff0000, v22
    v_pk_fma_f32 v[10:11], v[66:67], v[66:67], v[10:11]
    v_pk_add_f32 v[8:9], v[8:9], v[66:67]
    v_lshlrev_b32_e64 v70, 16, v23
    v_and_b32 v71, 0xffff0000, v23
    v_pk_fma_f32 v[6:7], v[68:69], v[68:69], v[6:7]
    v_pk_add_f32 v[4:5], v[4:5], v[68:69]
    s_waitcnt vmcnt(14)
    v_lshlrev_b32 v72, 16, v24
    v_and_b32 v73, 0xffff0000, v24
    v_pk_fma_f32 v[10:11], v[70:71], v[70:71], v[10:11]
    v_pk_add_f32 v[8:9], v[8:9], v[70:71]
    v_lshlrev_b32_e64 v74, 16, v25
    v_and_b32 v75, 0xffff0000, v25
    v_pk_fma_f32 v[6:7], v[72:73], v[72:73], v[6:7]
    v_pk_add_f32 v[4:5], v[4:5], v[72:73]
    v_lshlrev_b32_e64 v76, 16, v26
    v_and_b32 v77, 0xffff0000, v26
    v_pk_fma_f32 v[10:11], v[74:75], v[74:75], v[10:11]
    v_pk_add_f32 v[8:9], v[8:9], v[74:75]
    v_lshlrev_b32_e64 v78, 16, v27
    v_and_b32 v79, 0xffff0000, v27
    v_pk_fma_f32 v[6:7], v[76:77], v[76:77], v[6:7]
    v_pk_add_f32 v[4:5], v[4:5], v[76:77]
    v_lshlrev_b32_e64 v80, 16, v28
    v_and_b32 v81, 0xffff0000, v28
    v_pk_fma_f32 v[10:11], v[78:79], v[78:79], v[10:11]
    v_pk_add_f32 v[8:9], v[8:9], v[78:79]
    v_lshlrev_b32_e64 v82, 16, v29
    v_and_b32 v83, 0xffff0000, v29
    v_pk_fma_f32 v[6:7], v[80:81], v[80:81], v[6:7]
    v_pk_add_f32 v[4:5], v[4:5], v[80:81]
    v_lshlrev_b32_e64 v84, 16, v30
    v_and_b32 v85, 0xffff0000, v30
    v_pk_fma_f32 v[10:11], v[82:83], v[82:83], v[10:11]
    v_pk_add_f32 v[8:9], v[8:9], v[82:83]
    v_lshlrev_b32_e64 v86, 16, v31
    v_and_b32 v87, 0xffff0000, v31
    v_pk_fma_f32 v[6:7], v[84:85], v[84:85], v[6:7]
    v_pk_add_f32 v[4:5], v[4:5], v[84:85]
    s_waitcnt vmcnt(12)
    v_lshlrev_b32 v88, 16, v32
    v_and_b32 v89, 0xffff0000, v32
    v_pk_fma_f32 v[10:11], v[86:87], v[86:87], v[10:11]
    v_pk_add_f32 v[8:9], v[8:9], v[86:87]
    v_lshlrev_b32_e64 v90, 16, v33
    v_and_b32 v91, 0xffff0000, v33
    v_pk_fma_f32 v[6:7], v[88:89], v[88:89], v[6:7]
    v_pk_add_f32 v[4:5], v[4:5], v[88:89]
    v_lshlrev_b32_e64 v92, 16, v34
    v_and_b32 v93, 0xffff0000, v34
    v_pk_fma_f32 v[10:11], v[90:91], v[90:91], v[10:11]
    v_pk_add_f32 v[8:9], v[8:9], v[90:91]
    v_lshlrev_b32_e64 v94, 16, v35
    v_and_b32 v95, 0xffff0000, v35
    v_pk_fma_f32 v[6:7], v[92:93], v[92:93], v[6:7]
    v_pk_add_f32 v[4:5], v[4:5], v[92:93]
    v_lshlrev_b32_e64 v96, 16, v36
    v_and_b32 v97, 0xffff0000, v36
    v_pk_fma_f32 v[10:11], v[94:95], v[94:95], v[10:11]
    v_pk_add_f32 v[8:9], v[8:9], v[94:95]
    v_lshlrev_b32_e64 v98, 16, v37
    v_and_b32 v99, 0xffff0000, v37
    v_pk_fma_f32 v[6:7], v[96:97], v[96:97], v[6:7]
    v_pk_add_f32 v[4:5], v[4:5], v[96:97]
    v_lshlrev_b32_e64 v100, 16, v38
    v_and_b32 v101, 0xffff0000, v38
    v_pk_fma_f32 v[10:11], v[98:99], v[98:99], v[10:11]
    v_pk_add_f32 v[8:9], v[8:9], v[98:99]
    v_lshlrev_b32_e64 v102, 16, v39
    v_and_b32 v103, 0xffff0000, v39
    v_pk_fma_f32 v[6:7], v[100:101], v[100:101], v[6:7]
    v_pk_add_f32 v[4:5], v[4:5], v[100:101]
    s_waitcnt vmcnt(10)
    v_lshlrev_b32 v104, 16, v40
    v_and_b32 v105, 0xffff0000, v40
    v_pk_fma_f32 v[10:11], v[102:103], v[102:103], v[10:11]
    v_pk_add_f32 v[8:9], v[8:9], v[102:103]
    v_lshlrev_b32_e64 v106, 16, v41
    v_and_b32 v107, 0xffff0000, v41
    v_pk_fma_f32 v[6:7], v[104:105], v[104:105], v[6:7]
    v_pk_add_f32 v[4:5], v[4:5], v[104:105]
    v_lshlrev_b32_e64 v108, 16, v42
    v_and_b32 v109, 0xffff0000, v42
    v_pk_fma_f32 v[10:11], v[106:107], v[106:107], v[10:11]
    v_pk_add_f32 v[8:9], v[8:9], v[106:107]
    v_lshlrev_b32_e64 v110, 16, v43
    v_and_b32 v111, 0xffff0000, v43
    v_pk_fma_f32 v[6:7], v[108:109], v[108:109], v[6:7]
    v_pk_add_f32 v[4:5], v[4:5], v[108:109]
    v_lshlrev_b32_e64 v112, 16, v44
    v_and_b32 v113, 0xffff0000, v44
    v_pk_fma_f32 v[10:11], v[110:111], v[110:111], v[10:11]
    v_pk_add_f32 v[8:9], v[8:9], v[110:111]
    v_lshlrev_b32_e64 v114, 16, v45
    v_and_b32 v115, 0xffff0000, v45
    v_pk_fma_f32 v[6:7], v[112:113], v[112:113], v[6:7]
    v_pk_add_f32 v[4:5], v[4:5], v[112:113]
    v_lshlrev_b32_e64 v116, 16, v46
    v_and_b32 v117, 0xffff0000, v46
    v_pk_fma_f32 v[10:11], v[114:115], v[114:115], v[10:11]
    v_pk_add_f32 v[8:9], v[8:9], v[114:115]
    v_lshlrev_b32_e64 v118, 16, v47
    v_and_b32 v119, 0xffff0000, v47
    v_pk_fma_f32 v[6:7], v[116:117], v[116:117], v[6:7]
    v_pk_add_f32 v[4:5], v[4:5], v[116:117]
    s_waitcnt vmcnt(8)
    v_lshlrev_b32 v120, 16, v48
    v_and_b32 v121, 0xffff0000, v48
    v_pk_fma_f32 v[10:11], v[118:119], v[118:119], v[10:11]
    v_pk_add_f32 v[8:9], v[8:9], v[118:119]
    v_lshlrev_b32_e64 v122, 16, v49
    v_and_b32 v123, 0xffff0000, v49
    v_pk_fma_f32 v[6:7], v[120:121], v[120:121], v[6:7]
    v_pk_add_f32 v[4:5], v[4:5], v[120:121]
    v_lshlrev_b32_e64 v124, 16, v50
    v_and_b32 v125, 0xffff0000, v50
    v_pk_fma_f32 v[10:11], v[122:123], v[122:123], v[10:11]
    v_pk_add_f32 v[8:9], v[8:9], v[122:123]
    v_lshlrev_b32_e64 v126, 16, v51
    v_and_b32 v127, 0xffff0000, v51
    v_pk_fma_f32 v[6:7], v[124:125], v[124:125], v[6:7]
    v_pk_add_f32 v[4:5], v[4:5], v[124:125]
    v_lshlrev_b32_e64 v128, 16, v52
    v_and_b32 v129, 0xffff0000, v52
    v_pk_fma_f32 v[10:11], v[126:127], v[126:127], v[10:11]
    v_pk_add_f32 v[8:9], v[8:9], v[126:127]
    v_lshlrev_b32_e64 v130, 16, v53
    v_and_b32 v131, 0xffff0000, v53
    v_pk_fma_f32 v[6:7], v[128:129], v[128:129], v[6:7]
    v_pk_add_f32 v[4:5], v[4:5], v[128:129]
    v_lshlrev_b32_e64 v132, 16, v54
    v_and_b32 v133, 0xffff0000, v54
    v_pk_fma_f32 v[10:11], v[130:131], v[130:131], v[10:11]
    v_pk_add_f32 v[8:9], v[8:9], v[130:131]
    v_lshlrev_b32_e64 v134, 16, v55
    v_and_b32 v135, 0xffff0000, v55
    v_pk_fma_f32 v[6:7], v[132:133], v[132:133], v[6:7]
    v_pk_add_f32 v[4:5], v[4:5], v[132:133]
    v_pk_fma_f32 v[10:11], v[134:135], v[134:135], v[10:11]
    v_pk_add_f32 v[8:9], v[8:9], v[134:135]
    v_pk_add_f32 v[4:5], v[4:5], v[8:9]
    v_pk_add_f32 v[6:7], v[6:7], v[10:11]
    v_add_f32 v4, v4, v5
    v_add_f32_e64 v6, v6, v7
    s_nop 0
    v_add_f32_dpp v4, v4, v4 quad_perm:[1,0,3,2] row_mask:0xf bank_mask:0xf
    v_add_f32_dpp v6, v6, v6 quad_perm:[1,0,3,2] row_mask:0xf bank_mask:0xf
    s_nop 0
    v_add_f32_dpp v4, v4, v4 quad_perm:[2,3,0,1] row_mask:0xf bank_mask:0xf
    v_add_f32_dpp v6, v6, v6 quad_perm:[2,3,0,1] row_mask:0xf bank_mask:0xf
    s_nop 0
    v_add_f32_dpp v4, v4, v4 row_half_mirror row_mask:0xf bank_mask:0xf
    v_add_f32_dpp v6, v6, v6 row_half_mirror row_mask:0xf bank_mask:0xf
    s_mov_b32 s60, 0x3acccccd
    v_mul_f32 v4, s60, v4
    v_mul_f32 v6, s60, v6
    v_fma_f32 v6, -v4, v4, v6
    v_max_f32 v6, 0, v6
    v_cvt_pk_bf16_f32 v4, v4, v4
    v_lshlrev_b32 v4, 16, v4
    v_cvt_pk_bf16_f32 v6, v6, v6
    v_lshlrev_b32 v6, 16, v6
    v_add_f32 v6, 0x3727c5ac, v6
    v_cvt_pk_bf16_f32 v6, v6, v6
    v_lshlrev_b32 v6, 16, v6
    v_sqrt_f32 v6, v6
    s_nop 0
    v_cvt_pk_bf16_f32 v6, v6, v6
    v_lshlrev_b32 v6, 16, v6
    v_rcp_f32_e64 v5, v6
    s_lshl_b32 s60, s59, 6
    s_add_u32 s60, s60, 16384
    s_mov_b32 exec_lo, 0x01010101
    s_mov_b32 exec_hi, 0x01010101
    buffer_store_dwordx2 v[4:5], v12, s[44:47], s60 offen sc1
    s_mov_b64 exec, -1
    s_mul_i32 s60, s59, 10240
    s_add_u32 s60, s60, 1048576
    v_pk_add_f32 v[56:57], v[56:57], v[4:5] op_sel_hi:[1,0] neg_lo:[0,1] neg_hi:[0,1]
    v_pk_mul_f32 v[56:57], v[56:57], v[4:5] op_sel:[0,1] op_sel_hi:[1,1]
    v_cvt_pk_bf16_f32 v16, v56, v57
    v_pk_add_f32 v[58:59], v[58:59], v[4:5] op_sel_hi:[1,0] neg_lo:[0,1] neg_hi:[0,1]
    v_pk_mul_f32 v[58:59], v[58:59], v[4:5] op_sel:[0,1] op_sel_hi:[1,1]
    v_cvt_pk_bf16_f32 v17, v58, v59
    s_add_u32 s66, s69, 0
    s_mov_b32 m0, 30720
    s_nop 0
    buffer_load_dwordx4 v196, s[36:39], s66 offen offset:0 lds
    s_nop 0
    buffer_load_dwordx4 v197, s[36:39], s66 offen offset:1024 lds
    v_pk_add_f32 v[60:61], v[60:61], v[4:5] op_sel_hi:[1,0] neg_lo:[0,1] neg_hi:[0,1]
    v_pk_mul_f32 v[60:61], v[60:61], v[4:5] op_sel:[0,1] op_sel_hi:[1,1]
    v_cvt_pk_bf16_f32 v18, v60, v61
    v_pk_add_f32 v[62:63], v[62:63], v[4:5] op_sel_hi:[1,0] neg_lo:[0,1] neg_hi:[0,1]
    v_pk_mul_f32 v[62:63], v[62:63], v[4:5] op_sel:[0,1] op_sel_hi:[1,1]
    v_cvt_pk_bf16_f32 v19, v62, v63
    buffer_load_dwordx4 v198, s[36:39], s66 offen offset:2048 lds
    s_mov_b64 exec, 0xffffffff
    buffer_load_dwordx4 v199, s[36:39], s66 offen offset:3072 lds
    s_mov_b64 exec, -1
    v_pk_add_f32 v[64:65], v[64:65], v[4:5] op_sel_hi:[1,0] neg_lo:[0,1] neg_hi:[0,1]
    v_pk_mul_f32 v[64:65], v[64:65], v[4:5] op_sel:[0,1] op_sel_hi:[1,1]
    v_cvt_pk_bf16_f32 v20, v64, v65
    v_pk_add_f32 v[66:67], v[66:67], v[4:5] op_sel_hi:[1,0] neg_lo:[0,1] neg_hi:[0,1]
    v_pk_mul_f32 v[66:67], v[66:67], v[4:5] op_sel:[0,1] op_sel_hi:[1,1]
    v_cvt_pk_bf16_f32 v21, v66, v67
    s_add_u32 s66, s69, 13824
    s_mov_b32 m0, 34304
    s_nop 0
    buffer_load_dwordx4 v196, s[36:39], s66 offen offset:0 lds
    buffer_load_dwordx4 v197, s[36:39], s66 offen offset:1024 lds
    v_pk_add_f32 v[68:69], v[68:69], v[4:5] op_sel_hi:[1,0] neg_lo:[0,1] neg_hi:[0,1]
    v_pk_mul_f32 v[68:69], v[68:69], v[4:5] op_sel:[0,1] op_sel_hi:[1,1]
    v_cvt_pk_bf16_f32 v22, v68, v69
    v_pk_add_f32 v[70:71], v[70:71], v[4:5] op_sel_hi:[1,0] neg_lo:[0,1] neg_hi:[0,1]
    v_pk_mul_f32 v[70:71], v[70:71], v[4:5] op_sel:[0,1] op_sel_hi:[1,1]
    v_cvt_pk_bf16_f32 v23, v70, v71
    buffer_load_dwordx4 v198, s[36:39], s66 offen offset:2048 lds
    s_mov_b64 exec, 0xffffffff
    buffer_load_dwordx4 v199, s[36:39], s66 offen offset:3072 lds
    s_mov_b64 exec, -1
    ds_write_b128 v2, v[16:19]
    s_nop 0
    ds_write_b128 v2, v[20:23] offset:128
    ds_read_b64_tr_b16 v[140:141], v3 offset:0
    ds_read_b64_tr_b16 v[142:143], v3 offset:1088
    ds_read_b64_tr_b16 v[144:145], v3 offset:128
    ds_read_b64_tr_b16 v[146:147], v3 offset:1216
    v_pk_add_f32 v[72:73], v[72:73], v[4:5] op_sel_hi:[1,0] neg_lo:[0,1] neg_hi:[0,1]
    v_pk_mul_f32 v[72:73], v[72:73], v[4:5] op_sel:[0,1] op_sel_hi:[1,1]
    v_cvt_pk_bf16_f32 v24, v72, v73
    v_pk_add_f32 v[74:75], v[74:75], v[4:5] op_sel_hi:[1,0] neg_lo:[0,1] neg_hi:[0,1]
    v_pk_mul_f32 v[74:75], v[74:75], v[4:5] op_sel:[0,1] op_sel_hi:[1,1]
    v_cvt_pk_bf16_f32 v25, v74, v75
    s_add_u32 s66, s69, 110592
    s_mov_b32 m0, 37888
    s_nop 0
    buffer_load_dwordx4 v196, s[36:39], s66 offen offset:0 lds
    buffer_load_dwordx4 v197, s[36:39], s66 offen offset:1024 lds
    s_nop 0
    v_pk_add_f32 v[76:77], v[76:77], v[4:5] op_sel_hi:[1,0] neg_lo:[0,1] neg_hi:[0,1]
    v_pk_mul_f32 v[76:77], v[76:77], v[4:5] op_sel:[0,1] op_sel_hi:[1,1]
    v_cvt_pk_bf16_f32 v26, v76, v77
    v_pk_add_f32 v[78:79], v[78:79], v[4:5] op_sel_hi:[1,0] neg_lo:[0,1] neg_hi:[0,1]
    v_pk_mul_f32 v[78:79], v[78:79], v[4:5] op_sel:[0,1] op_sel_hi:[1,1]
    v_cvt_pk_bf16_f32 v27, v78, v79
    buffer_load_dwordx4 v198, s[36:39], s66 offen offset:2048 lds
    s_mov_b64 exec, 0xffffffff
    buffer_load_dwordx4 v199, s[36:39], s66 offen offset:3072 lds
    s_mov_b64 exec, -1
    v_pk_add_f32 v[80:81], v[80:81], v[4:5] op_sel_hi:[1,0] neg_lo:[0,1] neg_hi:[0,1]
    v_pk_mul_f32 v[80:81], v[80:81], v[4:5] op_sel:[0,1] op_sel_hi:[1,1]
    v_cvt_pk_bf16_f32 v28, v80, v81
    v_pk_add_f32 v[82:83], v[82:83], v[4:5] op_sel_hi:[1,0] neg_lo:[0,1] neg_hi:[0,1]
    v_pk_mul_f32 v[82:83], v[82:83], v[4:5] op_sel:[0,1] op_sel_hi:[1,1]
    v_cvt_pk_bf16_f32 v29, v82, v83
    s_add_u32 s66, s69, 124416
    s_mov_b32 m0, 41472
    s_nop 0
    buffer_load_dwordx4 v196, s[36:39], s66 offen offset:0 lds
    buffer_load_dwordx4 v197, s[36:39], s66 offen offset:1024 lds
    v_pk_add_f32 v[84:85], v[84:85], v[4:5] op_sel_hi:[1,0] neg_lo:[0,1] neg_hi:[0,1]
    v_pk_mul_f32 v[84:85], v[84:85], v[4:5] op_sel:[0,1] op_sel_hi:[1,1]
    v_cvt_pk_bf16_f32 v30, v84, v85
    v_pk_add_f32 v[86:87], v[86:87], v[4:5] op_sel_hi:[1,0] neg_lo:[0,1] neg_hi:[0,1]
    v_pk_mul_f32 v[86:87], v[86:87], v[4:5] op_sel:[0,1] op_sel_hi:[1,1]
    v_cvt_pk_bf16_f32 v31, v86, v87
    buffer_load_dwordx4 v198, s[36:39], s66 offen offset:2048 lds
    s_mov_b64 exec, 0xffffffff
    buffer_load_dwordx4 v199, s[36:39], s66 offen offset:3072 lds
    s_mov_b64 exec, -1
    s_add_u32 s69, s69, 221184
    s_cmp_eq_u32 s69, 2211840
    s_cselect_b32 s69, 0, s69
    s_waitcnt lgkmcnt(0)
    buffer_store_dwordx4 v[140:143], v13, s[44:47], s60 offen offset:0 sc1
    buffer_store_dwordx4 v[144:147], v13, s[44:47], s60 offen offset:1024 sc1
    s_add_u32 s60, s60, 2048
    s_nop 0
    ds_write_b128 v2, v[24:27]
    ds_write_b128 v2, v[28:31] offset:128
    ds_read_b64_tr_b16 v[148:149], v3 offset:0
    ds_read_b64_tr_b16 v[150:151], v3 offset:1088
    ds_read_b64_tr_b16 v[152:153], v3 offset:128
    ds_read_b64_tr_b16 v[154:155], v3 offset:1216
    v_pk_add_f32 v[88:89], v[88:89], v[4:5] op_sel_hi:[1,0] neg_lo:[0,1] neg_hi:[0,1]
    v_pk_mul_f32 v[88:89], v[88:89], v[4:5] op_sel:[0,1] op_sel_hi:[1,1]
    v_cvt_pk_bf16_f32 v32, v88, v89
    v_pk_add_f32 v[90:91], v[90:91], v[4:5] op_sel_hi:[1,0] neg_lo:[0,1] neg_hi:[0,1]
    v_pk_mul_f32 v[90:91], v[90:91], v[4:5] op_sel:[0,1] op_sel_hi:[1,1]
    v_cvt_pk_bf16_f32 v33, v90, v91
    s_add_u32 s66, s68, 0
    s_mov_b32 m0, 45056
    s_nop 0
    buffer_load_dwordx4 v200, s[32:35], s66 offen offset:0 lds
    buffer_load_dwordx4 v201, s[32:35], s66 offen offset:1024 lds
    v_pk_add_f32 v[92:93], v[92:93], v[4:5] op_sel_hi:[1,0] neg_lo:[0,1] neg_hi:[0,1]
    v_pk_mul_f32 v[92:93], v[92:93], v[4:5] op_sel:[0,1] op_sel_hi:[1,1]
    v_cvt_pk_bf16_f32 v34, v92, v93
    v_pk_add_f32 v[94:95], v[94:95], v[4:5] op_sel_hi:[1,0] neg_lo:[0,1] neg_hi:[0,1]
    v_pk_mul_f32 v[94:95], v[94:95], v[4:5] op_sel:[0,1] op_sel_hi:[1,1]
    v_cvt_pk_bf16_f32 v35, v94, v95
    buffer_load_dwordx4 v202, s[32:35], s66 offen offset:2048 lds
    buffer_load_dwordx4 v203, s[32:35], s66 offen offset:3072 lds
    v_pk_add_f32 v[96:97], v[96:97], v[4:5] op_sel_hi:[1,0] neg_lo:[0,1] neg_hi:[0,1]
    v_pk_mul_f32 v[96:97], v[96:97], v[4:5] op_sel:[0,1] op_sel_hi:[1,1]
    v_cvt_pk_bf16_f32 v36, v96, v97
    v_pk_add_f32 v[98:99], v[98:99], v[4:5] op_sel_hi:[1,0] neg_lo:[0,1] neg_hi:[0,1]
    v_pk_mul_f32 v[98:99], v[98:99], v[4:5] op_sel:[0,1] op_sel_hi:[1,1]
    v_cvt_pk_bf16_f32 v37, v98, v99
    s_add_u32 s66, s68, 40960
    s_mov_b32 m0, 49152
    s_nop 0
    buffer_load_dwordx4 v200, s[32:35], s66 offen offset:0 lds
    buffer_load_dwordx4 v201, s[32:35], s66 offen offset:1024 lds
    v_pk_add_f32 v[100:101], v[100:101], v[4:5] op_sel_hi:[1,0] neg_lo:[0,1] neg_hi:[0,1]
    v_pk_mul_f32 v[100:101], v[100:101], v[4:5] op_sel:[0,1] op_sel_hi:[1,1]
    v_cvt_pk_bf16_f32 v38, v100, v101
    v_pk_add_f32 v[102:103], v[102:103], v[4:5] op_sel_hi:[1,0] neg_lo:[0,1] neg_hi:[0,1]
    v_pk_mul_f32 v[102:103], v[102:103], v[4:5] op_sel:[0,1] op_sel_hi:[1,1]
    v_cvt_pk_bf16_f32 v39, v102, v103
    buffer_load_dwordx4 v202, s[32:35], s66 offen offset:2048 lds
    buffer_load_dwordx4 v203, s[32:35], s66 offen offset:3072 lds
    s_waitcnt lgkmcnt(0)
    buffer_store_dwordx4 v[148:151], v13, s[44:47], s60 offen offset:0 sc1
    buffer_store_dwordx4 v[152:155], v13, s[44:47], s60 offen offset:1024 sc1
    s_add_u32 s60, s60, 2048
    ds_write_b128 v2, v[32:35]
    ds_write_b128 v2, v[36:39] offset:128
    ds_read_b64_tr_b16 v[156:157], v3 offset:0
    ds_read_b64_tr_b16 v[158:159], v3 offset:1088
    ds_read_b64_tr_b16 v[160:161], v3 offset:128
    ds_read_b64_tr_b16 v[162:163], v3 offset:1216
    v_pk_add_f32 v[104:105], v[104:105], v[4:5] op_sel_hi:[1,0] neg_lo:[0,1] neg_hi:[0,1]
    v_pk_mul_f32 v[104:105], v[104:105], v[4:5] op_sel:[0,1] op_sel_hi:[1,1]
    v_cvt_pk_bf16_f32 v40, v104, v105
    v_pk_add_f32 v[106:107], v[106:107], v[4:5] op_sel_hi:[1,0] neg_lo:[0,1] neg_hi:[0,1]
    v_pk_mul_f32 v[106:107], v[106:107], v[4:5] op_sel:[0,1] op_sel_hi:[1,1]
    v_cvt_pk_bf16_f32 v41, v106, v107
    s_add_u32 s66, s68, 81920
    s_mov_b32 m0, 53248
    s_nop 0
    buffer_load_dwordx4 v200, s[32:35], s66 offen offset:0 lds
    buffer_load_dwordx4 v201, s[32:35], s66 offen offset:1024 lds
    v_pk_add_f32 v[108:109], v[108:109], v[4:5] op_sel_hi:[1,0] neg_lo:[0,1] neg_hi:[0,1]
    s_nop 0
    v_pk_mul_f32 v[108:109], v[108:109], v[4:5] op_sel:[0,1] op_sel_hi:[1,1]
    v_cvt_pk_bf16_f32 v42, v108, v109
    v_pk_add_f32 v[110:111], v[110:111], v[4:5] op_sel_hi:[1,0] neg_lo:[0,1] neg_hi:[0,1]
    v_pk_mul_f32 v[110:111], v[110:111], v[4:5] op_sel:[0,1] op_sel_hi:[1,1]
    v_cvt_pk_bf16_f32 v43, v110, v111
    buffer_load_dwordx4 v202, s[32:35], s66 offen offset:2048 lds
    buffer_load_dwordx4 v203, s[32:35], s66 offen offset:3072 lds
    v_pk_add_f32 v[112:113], v[112:113], v[4:5] op_sel_hi:[1,0] neg_lo:[0,1] neg_hi:[0,1]
    v_pk_mul_f32 v[112:113], v[112:113], v[4:5] op_sel:[0,1] op_sel_hi:[1,1]
    v_cvt_pk_bf16_f32 v44, v112, v113
    v_pk_add_f32 v[114:115], v[114:115], v[4:5] op_sel_hi:[1,0] neg_lo:[0,1] neg_hi:[0,1]
    v_pk_mul_f32 v[114:115], v[114:115], v[4:5] op_sel:[0,1] op_sel_hi:[1,1]
    v_cvt_pk_bf16_f32 v45, v114, v115
    s_add_u32 s66, s68, 122880
    s_mov_b32 m0, 57344
    s_nop 0
    s_nop 0
    buffer_load_dwordx4 v200, s[32:35], s66 offen offset:0 lds
    buffer_load_dwordx4 v201, s[32:35], s66 offen offset:1024 lds
    v_pk_add_f32 v[116:117], v[116:117], v[4:5] op_sel_hi:[1,0] neg_lo:[0,1] neg_hi:[0,1]
    v_pk_mul_f32 v[116:117], v[116:117], v[4:5] op_sel:[0,1] op_sel_hi:[1,1]
    v_cvt_pk_bf16_f32 v46, v116, v117
    v_pk_add_f32 v[118:119], v[118:119], v[4:5] op_sel_hi:[1,0] neg_lo:[0,1] neg_hi:[0,1]
    v_pk_mul_f32 v[118:119], v[118:119], v[4:5] op_sel:[0,1] op_sel_hi:[1,1]
    v_cvt_pk_bf16_f32 v47, v118, v119
    buffer_load_dwordx4 v202, s[32:35], s66 offen offset:2048 lds
    buffer_load_dwordx4 v203, s[32:35], s66 offen offset:3072 lds
    s_add_u32 s68, s68, 128
    s_cmp_eq_u32 s68, 1280
    s_cselect_b32 s68, 0, s68
    s_waitcnt lgkmcnt(0)
    buffer_store_dwordx4 v[156:159], v13, s[44:47], s60 offen offset:0 sc1
    buffer_store_dwordx4 v[160:163], v13, s[44:47], s60 offen offset:1024 sc1
    s_add_u32 s60, s60, 2048
    ds_write_b128 v2, v[40:43]
    ds_write_b128 v2, v[44:47] offset:128
    ds_read_b64_tr_b16 v[164:165], v3 offset:0
    ds_read_b64_tr_b16 v[166:167], v3 offset:1088
    ds_read_b64_tr_b16 v[168:169], v3 offset:128
    ds_read_b64_tr_b16 v[170:171], v3 offset:1216
    v_pk_add_f32 v[120:121], v[120:121], v[4:5] op_sel_hi:[1,0] neg_lo:[0,1] neg_hi:[0,1]
    v_pk_mul_f32 v[120:121], v[120:121], v[4:5] op_sel:[0,1] op_sel_hi:[1,1]
    v_cvt_pk_bf16_f32 v48, v120, v121
    v_pk_add_f32 v[122:123], v[122:123], v[4:5] op_sel_hi:[1,0] neg_lo:[0,1] neg_hi:[0,1]
    v_pk_mul_f32 v[122:123], v[122:123], v[4:5] op_sel:[0,1] op_sel_hi:[1,1]
    v_cvt_pk_bf16_f32 v49, v122, v123
    v_pk_add_f32 v[124:125], v[124:125], v[4:5] op_sel_hi:[1,0] neg_lo:[0,1] neg_hi:[0,1]
    v_pk_mul_f32 v[124:125], v[124:125], v[4:5] op_sel:[0,1] op_sel_hi:[1,1]
    v_cvt_pk_bf16_f32 v50, v124, v125
    v_pk_add_f32 v[126:127], v[126:127], v[4:5] op_sel_hi:[1,0] neg_lo:[0,1] neg_hi:[0,1]
    v_pk_mul_f32 v[126:127], v[126:127], v[4:5] op_sel:[0,1] op_sel_hi:[1,1]
    v_cvt_pk_bf16_f32 v51, v126, v127
    v_pk_add_f32 v[128:129], v[128:129], v[4:5] op_sel_hi:[1,0] neg_lo:[0,1] neg_hi:[0,1]
    v_pk_mul_f32 v[128:129], v[128:129], v[4:5] op_sel:[0,1] op_sel_hi:[1,1]
    v_cvt_pk_bf16_f32 v52, v128, v129
    v_pk_add_f32 v[130:131], v[130:131], v[4:5] op_sel_hi:[1,0] neg_lo:[0,1] neg_hi:[0,1]
    v_pk_mul_f32 v[130:131], v[130:131], v[4:5] op_sel:[0,1] op_sel_hi:[1,1]
    v_cvt_pk_bf16_f32 v53, v130, v131
    v_pk_add_f32 v[132:133], v[132:133], v[4:5] op_sel_hi:[1,0] neg_lo:[0,1] neg_hi:[0,1]
    v_pk_mul_f32 v[132:133], v[132:133], v[4:5] op_sel:[0,1] op_sel_hi:[1,1]
    v_cvt_pk_bf16_f32 v54, v132, v133
    v_pk_add_f32 v[134:135], v[134:135], v[4:5] op_sel_hi:[1,0] neg_lo:[0,1] neg_hi:[0,1]
    v_pk_mul_f32 v[134:135], v[134:135], v[4:5] op_sel:[0,1] op_sel_hi:[1,1]
    v_cvt_pk_bf16_f32 v55, v134, v135
    s_waitcnt lgkmcnt(0)
    buffer_store_dwordx4 v[164:167], v13, s[44:47], s60 offen offset:0 sc1
    s_nop 0
    buffer_store_dwordx4 v[168:171], v13, s[44:47], s60 offen offset:1024 sc1
    s_add_u32 s60, s60, 2048
    ds_write_b128 v2, v[48:51]
    ds_write_b128 v2, v[52:55] offset:128
    ds_read_b64_tr_b16 v[172:173], v3 offset:0
    ds_read_b64_tr_b16 v[174:175], v3 offset:1088
    ds_read_b64_tr_b16 v[176:177], v3 offset:128
    ds_read_b64_tr_b16 v[178:179], v3 offset:1216
    s_waitcnt lgkmcnt(0)
    buffer_store_dwordx4 v[172:175], v13, s[44:47], s60 offen offset:0 sc1
    buffer_store_dwordx4 v[176:179], v13, s[44:47], s60 offen offset:1024 sc1
    s_add_u32 s60, s60, 2048
    s_lshr_b32 s60, s59, 2
    s_lshl_b32 s60, s60, 7
    s_and_b32 s61, s59, 3
    s_lshl_b32 s61, s61, 2
    s_add_u32 s60, s60, s61
    s_add_u32 s60, s60, 131072
    s_mul_i32 s58, s58, 0x9E3779B1
    s_add_u32 s58, s58, 0x7F4A7C15
    s_add_u32 s66, s69, 0
    s_mov_b32 m0, 61440
    s_nop 0
    buffer_load_dwordx4 v196, s[36:39], s66 offen offset:0 lds
    buffer_load_dwordx4 v197, s[36:39], s66 offen offset:1024 lds
    buffer_load_dwordx4 v198, s[36:39], s66 offen offset:2048 lds
    s_mov_b64 exec, 0xffffffff
    buffer_load_dwordx4 v199, s[36:39], s66 offen offset:3072 lds
    s_mov_b64 exec, -1
    s_add_u32 s66, s69, 13824
    s_mov_b32 m0, 65024
    s_nop 0
    buffer_load_dwordx4 v196, s[36:39], s66 offen offset:0 lds
    buffer_load_dwordx4 v197, s[36:39], s66 offen offset:1024 lds
    buffer_load_dwordx4 v198, s[36:39], s66 offen offset:2048 lds
    s_mov_b64 exec, 0xffffffff
    buffer_load_dwordx4 v199, s[36:39], s66 offen offset:3072 lds
    s_mov_b64 exec, -1
    s_add_u32 s66, s69, 110592
    s_mov_b32 m0, 68608
    s_nop 0
    buffer_load_dwordx4 v196, s[36:39], s66 offen offset:0 lds
    buffer_load_dwordx4 v197, s[36:39], s66 offen offset:1024 lds
    buffer_load_dwordx4 v198, s[36:39], s66 offen offset:2048 lds
    s_mov_b64 exec, 0xffffffff
    buffer_load_dwordx4 v199, s[36:39], s66 offen offset:3072 lds
    s_mov_b64 exec, -1
    s_add_u32 s66, s69, 124416
    s_mov_b32 m0, 72192
    s_nop 0
    buffer_load_dwordx4 v196, s[36:39], s66 offen offset:0 lds
    buffer_load_dwordx4 v197, s[36:39], s66 offen offset:1024 lds
    buffer_load_dwordx4 v198, s[36:39], s66 offen offset:2048 lds
    s_mov_b64 exec, 0xffffffff
    buffer_load_dwordx4 v199, s[36:39], s66 offen offset:3072 lds
    s_mov_b64 exec, -1
    s_add_u32 s69, s69, 221184
    s_cmp_eq_u32 s69, 2211840
    s_cselect_b32 s69, 0, s69
    s_waitcnt vmcnt(16)
    v_mov_b32 v2, 0
    v_mov_b32 v3, s58
    s_mov_b64 exec, 1
    buffer_store_dword v3, v2, s[44:47], s60 offen sc1
    s_mov_b64 exec, -1
    s_add_u32 s66, s68, 0
    s_mov_b32 m0, 75776
    s_nop 0
    buffer_load_dwordx4 v200, s[32:35], s66 offen offset:0 lds
    buffer_load_dwordx4 v201, s[32:35], s66 offen offset:1024 lds
    buffer_load_dwordx4 v202, s[32:35], s66 offen offset:2048 lds
    buffer_load_dwordx4 v203, s[32:35], s66 offen offset:3072 lds
    s_add_u32 s66, s68, 40960
    s_mov_b32 m0, 79872
    s_nop 0
    buffer_load_dwordx4 v200, s[32:35], s66 offen offset:0 lds
    buffer_load_dwordx4 v201, s[32:35], s66 offen offset:1024 lds
    buffer_load_dwordx4 v202, s[32:35], s66 offen offset:2048 lds
    buffer_load_dwordx4 v203, s[32:35], s66 offen offset:3072 lds
    s_add_u32 s66, s68, 81920
    s_mov_b32 m0, 83968
    s_nop 0
    buffer_load_dwordx4 v200, s[32:35], s66 offen offset:0 lds
    buffer_load_dwordx4 v201, s[32:35], s66 offen offset:1024 lds
    buffer_load_dwordx4 v202, s[32:35], s66 offen offset:2048 lds
    buffer_load_dwordx4 v203, s[32:35], s66 offen offset:3072 lds
    s_add_u32 s66, s68, 122880
    s_mov_b32 m0, 88064
    s_nop 0
    buffer_load_dwordx4 v200, s[32:35], s66 offen offset:0 lds
    buffer_load_dwordx4 v201, s[32:35], s66 offen offset:1024 lds
    buffer_load_dwordx4 v202, s[32:35], s66 offen offset:2048 lds
    buffer_load_dwordx4 v203, s[32:35], s66 offen offset:3072 lds
    s_add_u32 s68, s68, 128
    s_cmp_eq_u32 s68, 1280
    s_cselect_b32 s68, 0, s68
    s_add_u32 s66, s68, 0
    s_mov_b32 m0, 106496
    s_nop 0
    buffer_load_dwordx4 v200, s[32:35], s66 offen offset:0 lds
    buffer_load_dwordx4 v201, s[32:35], s66 offen offset:1024 lds
    buffer_load_dwordx4 v202, s[32:35], s66 offen offset:2048 lds
    buffer_load_dwordx4 v203, s[32:35], s66 offen offset:3072 lds
    s_add_u32 s66, s68, 40960
    s_mov_b32 m0, 110592
    s_nop 0
    buffer_load_dwordx4 v200, s[32:35], s66 offen offset:0 lds
    buffer_load_dwordx4 v201, s[32:35], s66 offen offset:1024 lds
    buffer_load_dwordx4 v202, s[32:35], s66 offen offset:2048 lds
    buffer_load_dwordx4 v203, s[32:35], s66 offen offset:3072 lds
    s_add_u32 s66, s68, 81920
    s_mov_b32 m0, 114688
    s_nop 0
    buffer_load_dwordx4 v200, s[32:35], s66 offen offset:0 lds
    buffer_load_dwordx4 v201, s[32:35], s66 offen offset:1024 lds
    buffer_load_dwordx4 v202, s[32:35], s66 offen offset:2048 lds
    buffer_load_dwordx4 v203, s[32:35], s66 offen offset:3072 lds
    s_add_u32 s66, s68, 122880
    s_mov_b32 m0, 118784
    s_nop 0
    buffer_load_dwordx4 v200, s[32:35], s66 offen offset:0 lds
    buffer_load_dwordx4 v201, s[32:35], s66 offen offset:1024 lds
    buffer_load_dwordx4 v202, s[32:35], s66 offen offset:2048 lds
    buffer_load_dwordx4 v203, s[32:35], s66 offen offset:3072 lds
    s_add_u32 s68, s68, 128
    s_cmp_eq_u32 s68, 1280
    s_cselect_b32 s68, 0, s68
L_gemm1:
L_gemm1b:
    v_mov_b32 v128, 0x3f803f80
    v_mov_b32 v129, 0x3f803f80
    v_mov_b32 v130, 0x3f803f80
    v_mov_b32 v131, 0x3f803f80
    s_cmp_eq_u32 s52, 3
    s_cselect_b64 s[26:27], -1, 0
    s_barrier
    ds_read_b128 a[56:59], v250 offset:0
    ds_read_b128 a[60:63], v250 offset:2048
    ds_read_b64_tr_b16 a[0:1], v248 offset:0
    ds_read_b64_tr_b16 a[2:3], v248 offset:3584
    ds_read_b64_tr_b16 a[4:5], v248 offset:32
    ds_read_b64_tr_b16 a[6:7], v248 offset:3616
    ds_read_b64_tr_b16 a[8:9], v248 offset:64
    ds_read_b64_tr_b16 a[10:11], v248 offset:3648
    ds_read_b64_tr_b16 a[12:13], v248 offset:96
    ds_read_b64_tr_b16 a[14:15], v248 offset:3680
    ds_read_b64_tr_b16 a[16:17], v248 offset:128
    ds_read_b64_tr_b16 a[18:19], v248 offset:3712
    ds_read_b64_tr_b16 a[20:21], v248 offset:160
    ds_read_b64_tr_b16 a[22:23], v248 offset:3744
    ds_read_b64_tr_b16 a[24:25], v248 offset:192
    ds_read_b64_tr_b16 a[26:27], v248 offset:3776
    ds_read_b64_tr_b16 a[232:233], v208 offset:0
    ds_read_b64_tr_b16 a[234:235], v208 offset:3584
    ds_read_b64_tr_b16 a[236:237], v208 offset:32
    ds_read_b64_tr_b16 a[238:239], v208 offset:3616
    s_waitcnt lgkmcnt(15)
    v_mfma_f32_16x16x32_bf16 v[64:67], a[0:3], a[56:59], 0
    ds_read_b128 a[64:67], v251 offset:0
    ds_read_b128 a[68:71], v251 offset:2048
    v_mfma_f32_16x16x32_bf16 v[68:71], a[0:3], a[60:63], 0
    ds_read_b64_tr_b16 a[28:29], v248 offset:7168
    s_add_u32 m0, s71, 92160
    s_waitcnt lgkmcnt(15)
    v_mfma_f32_16x16x32_bf16 v[72:75], a[4:7], a[56:59], 0
    ds_read_b64_tr_b16 a[30:31], v248 offset:10752
    ds_read_b64_tr_b16 a[32:33], v248 offset:7200
    v_mfma_f32_16x16x32_bf16 v[76:79], a[4:7], a[60:63], 0
    ds_read_b64_tr_b16 a[34:35], v248 offset:10784
    v_mfma_f32_16x16x32_bf16 v[80:83], a[8:11], a[56:59], 0
    buffer_load_dwordx4 v244, s[36:39], s69 offen offset:0 lds
    ds_read_b64_tr_b16 a[36:37], v248 offset:7232
    ds_read_b64_tr_b16 a[38:39], v248 offset:10816
    v_mfma_f32_16x16x32_bf16 v[84:87], a[8:11], a[60:63], 0
    ds_read_b64_tr_b16 a[40:41], v248 offset:7264
    s_waitcnt lgkmcnt(7)
    v_mfma_f32_16x16x32_bf16 v[88:91], a[12:15], a[56:59], 0
    s_nop 0
    ds_read_b64_tr_b16 a[42:43], v248 offset:10848
    buffer_load_dwordx4 v245, s[36:39], s69 offen offset:1024 lds
    v_mfma_f32_16x16x32_bf16 v[92:95], a[12:15], a[60:63], 0
    ds_read_b64_tr_b16 a[44:45], v248 offset:7296
    ds_read_b64_tr_b16 a[46:47], v248 offset:10880
    v_mfma_f32_16x16x32_bf16 v[96:99], a[16:19], a[56:59], 0
    ds_read_b64_tr_b16 a[48:49], v248 offset:7328
    v_mfma_f32_16x16x32_bf16 v[100:103], a[16:19], a[60:63], 0
    ds_read_b64_tr_b16 a[50:51], v248 offset:10912
    buffer_load_dwordx4 v246, s[36:39], s69 offen offset:2048 lds
    ds_read_b64_tr_b16 a[52:53], v248 offset:7360
    v_mfma_f32_16x16x32_bf16 v[104:107], a[20:23], a[56:59], 0
    ds_read_b64_tr_b16 a[54:55], v248 offset:10944
    v_mfma_f32_16x16x32_bf16 v[108:111], a[20:23], a[60:63], 0
    ds_read_b64_tr_b16 a[240:241], v208 offset:7168
    s_mov_b64 exec, 0xffffffff
    buffer_load_dwordx4 v247, s[36:39], s69 offen offset:3072 lds
    s_mov_b64 exec, -1
    v_mfma_f32_16x16x32_bf16 v[112:115], a[24:27], a[56:59], 0
    ds_read_b64_tr_b16 a[242:243], v208 offset:10752
    ds_read_b64_tr_b16 a[244:245], v208 offset:7200
    v_mfma_f32_16x16x32_bf16 v[116:119], a[24:27], a[60:63], 0
    ds_read_b64_tr_b16 a[246:247], v208 offset:10784
    v_mfma_f32_16x16x32_bf16 v[120:123], a[232:235], v[128:131], 0
    s_add_u32 s69, s69, 221184
    s_cmp_eq_u32 s69, 2211840
    s_cselect_b32 s69, 0, s69
    v_mfma_f32_16x16x32_bf16 v[124:127], a[236:239], v[128:131], 0
    s_waitcnt lgkmcnt(4)
    v_mfma_f32_16x16x32_bf16 v[64:67], a[28:31], a[64:67], v[64:67]
    v_mfma_f32_16x16x32_bf16 v[68:71], a[28:31], a[68:71], v[68:71]
    s_waitcnt vmcnt(52)
    s_waitcnt lgkmcnt(0)
    s_barrier
    ds_read_b128 a[56:59], v250 offset:30720
    v_mfma_f32_16x16x32_bf16 v[72:75], a[32:35], a[64:67], v[72:75]
    ds_read_b128 a[60:63], v250 offset:32768
    ds_read_b64_tr_b16 a[0:1], v248 offset:30720
    v_mfma_f32_16x16x32_bf16 v[76:79], a[32:35], a[68:71], v[76:79]
    s_add_u32 m0, s71, 0
    ds_read_b64_tr_b16 a[2:3], v248 offset:34304
    v_mfma_f32_16x16x32_bf16 v[80:83], a[36:39], a[64:67], v[80:83]
    ds_read_b64_tr_b16 a[4:5], v248 offset:30752
    s_nop 0
    ds_read_b64_tr_b16 a[6:7], v248 offset:34336
    v_mfma_f32_16x16x32_bf16 v[84:87], a[36:39], a[68:71], v[84:87]
    ds_read_b64_tr_b16 a[8:9], v248 offset:30784
    buffer_load_dwordx4 v244, s[36:39], s69 offen offset:0 lds
    ds_read_b64_tr_b16 a[10:11], v248 offset:34368
    v_mfma_f32_16x16x32_bf16 v[88:91], a[40:43], a[64:67], v[88:91]
    ds_read_b64_tr_b16 a[12:13], v248 offset:30816
    v_mfma_f32_16x16x32_bf16 v[92:95], a[40:43], a[68:71], v[92:95]
    ds_read_b64_tr_b16 a[14:15], v248 offset:34400
    ds_read_b64_tr_b16 a[16:17], v248 offset:30848
    v_mfma_f32_16x16x32_bf16 v[96:99], a[44:47], a[64:67], v[96:99]
    ds_read_b64_tr_b16 a[18:19], v248 offset:34432
    buffer_load_dwordx4 v245, s[36:39], s69 offen offset:1024 lds
    v_mfma_f32_16x16x32_bf16 v[100:103], a[44:47], a[68:71], v[100:103]
    ds_read_b64_tr_b16 a[20:21], v248 offset:30880
    ds_read_b64_tr_b16 a[22:23], v248 offset:34464
    v_mfma_f32_16x16x32_bf16 v[104:107], a[48:51], a[64:67], v[104:107]
    ds_read_b64_tr_b16 a[24:25], v248 offset:30912
    ds_read_b64_tr_b16 a[26:27], v248 offset:34496
    v_mfma_f32_16x16x32_bf16 v[108:111], a[48:51], a[68:71], v[108:111]
    ds_read_b64_tr_b16 a[232:233], v208 offset:30720
    buffer_load_dwordx4 v246, s[36:39], s69 offen offset:2048 lds
    v_mfma_f32_16x16x32_bf16 v[112:115], a[52:55], a[64:67], v[112:115]
    ds_read_b64_tr_b16 a[234:235], v208 offset:34304
    ds_read_b64_tr_b16 a[236:237], v208 offset:30752
    v_mfma_f32_16x16x32_bf16 v[116:119], a[52:55], a[68:71], v[116:119]
    ds_read_b64_tr_b16 a[238:239], v208 offset:34336
    v_mfma_f32_16x16x32_bf16 v[120:123], a[240:243], v[128:131], v[120:123]
    s_mov_b64 exec, 0xffffffff
    buffer_load_dwordx4 v247, s[36:39], s69 offen offset:3072 lds
    s_mov_b64 exec, -1
    v_mfma_f32_16x16x32_bf16 v[124:127], a[244:247], v[128:131], v[124:127]
    s_waitcnt lgkmcnt(4)
    v_mfma_f32_16x16x32_bf16 v[64:67], a[0:3], a[56:59], v[64:67]
    ds_read_b128 a[64:67], v251 offset:30720
    v_mov_b32_e64 v16, 0
    ds_read_b128 a[68:71], v251 offset:32768
    v_mfma_f32_16x16x32_bf16 v[68:71], a[0:3], a[60:63], v[68:71]
    ds_read_b64_tr_b16 a[28:29], v248 offset:37888
    s_add_u32 m0, s70, 0
    v_mov_b32 v17, 0
    v_mfma_f32_16x16x32_bf16 v[72:75], a[4:7], a[56:59], v[72:75]
    ds_read_b64_tr_b16 a[30:31], v248 offset:41472
    v_mov_b32 v18, 0
    ds_read_b64_tr_b16 a[32:33], v248 offset:37920
    v_mfma_f32_16x16x32_bf16 v[76:79], a[4:7], a[60:63], v[76:79]
    v_mov_b32 v19, 0
    ds_read_b64_tr_b16 a[34:35], v248 offset:41504
    buffer_load_dwordx4 v240, s[32:35], s68 offen offset:0 lds
    v_mfma_f32_16x16x32_bf16 v[80:83], a[8:11], a[56:59], v[80:83]
    ds_read_b64_tr_b16 a[36:37], v248 offset:37952
    ds_read_b64_tr_b16 a[38:39], v248 offset:41536
    v_mfma_f32_16x16x32_bf16 v[84:87], a[8:11], a[60:63], v[84:87]
    ds_read_b64_tr_b16 a[40:41], v248 offset:37984
    buffer_load_dwordx4 v241, s[32:35], s68 offen offset:1024 lds
    v_mfma_f32_16x16x32_bf16 v[88:91], a[12:15], a[56:59], v[88:91]
    ds_read_b64_tr_b16 a[42:43], v248 offset:41568
    v_mfma_f32_16x16x32_bf16 v[92:95], a[12:15], a[60:63], v[92:95]
    ds_read_b64_tr_b16 a[44:45], v248 offset:38016
    ds_read_b64_tr_b16 a[46:47], v248 offset:41600
    v_mfma_f32_16x16x32_bf16 v[96:99], a[16:19], a[56:59], v[96:99]
    buffer_load_dwordx4 v242, s[32:35], s68 offen offset:2048 lds
    ds_read_b64_tr_b16 a[48:49], v248 offset:38048
    v_mfma_f32_16x16x32_bf16 v[100:103], a[16:19], a[60:63], v[100:103]
    ds_read_b64_tr_b16 a[50:51], v248 offset:41632
    ds_read_b64_tr_b16 a[52:53], v248 offset:38080
    v_mfma_f32_16x16x32_bf16 v[104:107], a[20:23], a[56:59], v[104:107]
    buffer_load_dwordx4 v243, s[32:35], s68 offen offset:3072 lds
    ds_read_b64_tr_b16 a[54:55], v248 offset:41664
    v_mfma_f32_16x16x32_bf16 v[108:111], a[20:23], a[60:63], v[108:111]
    ds_read_b64_tr_b16 a[240:241], v208 offset:37888
    v_mfma_f32_16x16x32_bf16 v[112:115], a[24:27], a[56:59], v[112:115]
    ds_read_b64_tr_b16 a[242:243], v208 offset:41472
    s_add_u32 s68, s68, 128
    s_cmp_eq_u32 s68, 1280
    s_cselect_b32 s68, 0, s68
    ds_read_b64_tr_b16 a[244:245], v208 offset:37920
    v_mfma_f32_16x16x32_bf16 v[116:119], a[24:27], a[60:63], v[116:119]
    ds_read_b64_tr_b16 a[246:247], v208 offset:41504
    s_waitcnt lgkmcnt(7)
    v_mfma_f32_16x16x32_bf16 v[120:123], a[232:235], v[128:131], v[120:123]
    s_mul_i32 s69, s68, 1728
    s_mov_b64 exec, 0xffffff
    ds_write_b128 v211, v[16:19]
    s_mov_b64 exec, -1
    v_mfma_f32_16x16x32_bf16 v[124:127], a[236:239], v[128:131], v[124:127]
    v_mfma_f32_16x16x32_bf16 v[64:67], a[28:31], a[64:67], v[64:67]
    v_mfma_f32_16x16x32_bf16 v[68:71], a[28:31], a[68:71], v[68:71]
    s_waitcnt vmcnt(28)
    s_waitcnt lgkmcnt(1)
    s_barrier
    ds_read_b128 a[56:59], v252 offset:0
    v_mfma_f32_16x16x32_bf16 v[72:75], a[32:35], a[64:67], v[72:75]
    ds_read_b128 a[60:63], v252 offset:2048
    ds_read_b64_tr_b16 a[0:1], v249 offset:0
    v_mfma_f32_16x16x32_bf16 v[76:79], a[32:35], a[68:71], v[76:79]
    s_add_u32 m0, s71, 30720
    ds_read_b64_tr_b16 a[2:3], v249 offset:3584
    v_mfma_f32_16x16x32_bf16 v[80:83], a[36:39], a[64:67], v[80:83]
    ds_read_b64_tr_b16 a[4:5], v249 offset:32
    ds_read_b64_tr_b16 a[6:7], v249 offset:3616
    v_mfma_f32_16x16x32_bf16 v[84:87], a[36:39], a[68:71], v[84:87]
    ds_read_b64_tr_b16 a[8:9], v249 offset:64
    buffer_load_dwordx4 v244, s[36:39], s69 offen offset:0 lds
    ds_read_b64_tr_b16 a[10:11], v249 offset:3648
    v_mfma_f32_16x16x32_bf16 v[88:91], a[40:43], a[64:67], v[88:91]
    ds_read_b64_tr_b16 a[12:13], v249 offset:96
    v_mfma_f32_16x16x32_bf16 v[92:95], a[40:43], a[68:71], v[92:95]
    ds_read_b64_tr_b16 a[14:15], v249 offset:3680
    ds_read_b64_tr_b16 a[16:17], v249 offset:128
    v_mfma_f32_16x16x32_bf16 v[96:99], a[44:47], a[64:67], v[96:99]
    ds_read_b64_tr_b16 a[18:19], v249 offset:3712
    buffer_load_dwordx4 v245, s[36:39], s69 offen offset:1024 lds
    v_mfma_f32_16x16x32_bf16 v[100:103], a[44:47], a[68:71], v[100:103]
    ds_read_b64_tr_b16 a[20:21], v249 offset:160
    ds_read_b64_tr_b16 a[22:23], v249 offset:3744
    v_mfma_f32_16x16x32_bf16 v[104:107], a[48:51], a[64:67], v[104:107]
    ds_read_b64_tr_b16 a[24:25], v249 offset:192
    ds_read_b64_tr_b16 a[26:27], v249 offset:3776
    v_mfma_f32_16x16x32_bf16 v[108:111], a[48:51], a[68:71], v[108:111]
    ds_read_b64_tr_b16 a[232:233], v209 offset:0
    buffer_load_dwordx4 v246, s[36:39], s69 offen offset:2048 lds
    v_mfma_f32_16x16x32_bf16 v[112:115], a[52:55], a[64:67], v[112:115]
    ds_read_b64_tr_b16 a[234:235], v209 offset:3584
    ds_read_b64_tr_b16 a[236:237], v209 offset:32
    v_mfma_f32_16x16x32_bf16 v[116:119], a[52:55], a[68:71], v[116:119]
    ds_read_b64_tr_b16 a[238:239], v209 offset:3616
    v_mfma_f32_16x16x32_bf16 v[120:123], a[240:243], v[128:131], v[120:123]
    s_mov_b64 exec, 0xffffffff
    buffer_load_dwordx4 v247, s[36:39], s69 offen offset:3072 lds
    s_mov_b64 exec, -1
    v_mfma_f32_16x16x32_bf16 v[124:127], a[244:247], v[128:131], v[124:127]
    s_waitcnt lgkmcnt(4)
    v_mfma_f32_16x16x32_bf16 v[64:67], a[0:3], a[56:59], v[64:67]
    ds_read_b128 a[64:67], v253 offset:0
    ds_read_b128 a[68:71], v253 offset:2048
    v_mfma_f32_16x16x32_bf16 v[68:71], a[0:3], a[60:63], v[68:71]
    ds_read_b64_tr_b16 a[28:29], v249 offset:7168
    s_add_u32 m0, s70, 30720
    v_mfma_f32_16x16x32_bf16 v[72:75], a[4:7], a[56:59], v[72:75]
    ds_read_b64_tr_b16 a[30:31], v249 offset:10752
    ds_read_b64_tr_b16 a[32:33], v249 offset:7200
    v_mfma_f32_16x16x32_bf16 v[76:79], a[4:7], a[60:63], v[76:79]
    ds_read_b64_tr_b16 a[34:35], v249 offset:10784
    buffer_load_dwordx4 v240, s[32:35], s68 offen offset:0 lds
    v_mfma_f32_16x16x32_bf16 v[80:83], a[8:11], a[56:59], v[80:83]
    ds_read_b64_tr_b16 a[36:37], v249 offset:7232
    ds_read_b64_tr_b16 a[38:39], v249 offset:10816
    v_mfma_f32_16x16x32_bf16 v[84:87], a[8:11], a[60:63], v[84:87]
    ds_read_b64_tr_b16 a[40:41], v249 offset:7264
    buffer_load_dwordx4 v241, s[32:35], s68 offen offset:1024 lds
    v_mfma_f32_16x16x32_bf16 v[88:91], a[12:15], a[56:59], v[88:91]
    ds_read_b64_tr_b16 a[42:43], v249 offset:10848
    v_mfma_f32_16x16x32_bf16 v[92:95], a[12:15], a[60:63], v[92:95]
    ds_read_b64_tr_b16 a[44:45], v249 offset:7296
    ds_read_b64_tr_b16 a[46:47], v249 offset:10880
    v_mfma_f32_16x16x32_bf16 v[96:99], a[16:19], a[56:59], v[96:99]
    buffer_load_dwordx4 v242, s[32:35], s68 offen offset:2048 lds
    ds_read_b64_tr_b16 a[48:49], v249 offset:7328
    v_mfma_f32_16x16x32_bf16 v[100:103], a[16:19], a[60:63], v[100:103]
    ds_read_b64_tr_b16 a[50:51], v249 offset:10912
    ds_read_b64_tr_b16 a[52:53], v249 offset:7360
    v_mfma_f32_16x16x32_bf16 v[104:107], a[20:23], a[56:59], v[104:107]
    buffer_load_dwordx4 v243, s[32:35], s68 offen offset:3072 lds
    ds_read_b64_tr_b16 a[54:55], v249 offset:10944
    v_mfma_f32_16x16x32_bf16 v[108:111], a[20:23], a[60:63], v[108:111]
    ds_read_b64_tr_b16 a[240:241], v209 offset:7168
    v_mfma_f32_16x16x32_bf16 v[112:115], a[24:27], a[56:59], v[112:115]
    ds_read_b64_tr_b16 a[242:243], v209 offset:10752
    s_add_u32 s68, s68, 128
    s_cmp_eq_u32 s68, 1280
    s_cselect_b32 s68, 0, s68
    ds_read_b64_tr_b16 a[244:245], v209 offset:7200
    v_mfma_f32_16x16x32_bf16 v[116:119], a[24:27], a[60:63], v[116:119]
    ds_read_b64_tr_b16 a[246:247], v209 offset:10784
    s_waitcnt lgkmcnt(7)
    v_mfma_f32_16x16x32_bf16 v[120:123], a[232:235], v[128:131], v[120:123]
    s_mul_i32 s69, s68, 1728
    v_mfma_f32_16x16x32_bf16 v[124:127], a[236:239], v[128:131], v[124:127]
    v_mfma_f32_16x16x32_bf16 v[64:67], a[28:31], a[64:67], v[64:67]
    v_mfma_f32_16x16x32_bf16 v[68:71], a[28:31], a[68:71], v[68:71]
    s_waitcnt vmcnt(16)
    s_waitcnt lgkmcnt(0)
    s_barrier
    ds_read_b128 a[56:59], v252 offset:30720
    s_nop 0
    v_mfma_f32_16x16x32_bf16 v[72:75], a[32:35], a[64:67], v[72:75]
    ds_read_b128 a[60:63], v252 offset:32768
    ds_read_b64_tr_b16 a[0:1], v249 offset:30720
    v_mfma_f32_16x16x32_bf16 v[76:79], a[32:35], a[68:71], v[76:79]
    s_add_u32 m0, s71, 61440
    ds_read_b64_tr_b16 a[2:3], v249 offset:34304
    v_mfma_f32_16x16x32_bf16 v[80:83], a[36:39], a[64:67], v[80:83]
    ds_read_b64_tr_b16 a[4:5], v249 offset:30752
    ds_read_b64_tr_b16 a[6:7], v249 offset:34336
    v_mfma_f32_16x16x32_bf16 v[84:87], a[36:39], a[68:71], v[84:87]
    ds_read_b64_tr_b16 a[8:9], v249 offset:30784
    buffer_load_dwordx4 v244, s[36:39], s69 offen offset:0 lds
    ds_read_b64_tr_b16 a[10:11], v249 offset:34368
    v_mfma_f32_16x16x32_bf16 v[88:91], a[40:43], a[64:67], v[88:91]
    ds_read_b64_tr_b16 a[12:13], v249 offset:30816
    v_mfma_f32_16x16x32_bf16 v[92:95], a[40:43], a[68:71], v[92:95]
    ds_read_b64_tr_b16 a[14:15], v249 offset:34400
    ds_read_b64_tr_b16 a[16:17], v249 offset:30848
    v_mfma_f32_16x16x32_bf16 v[96:99], a[44:47], a[64:67], v[96:99]
    s_mov_b64 exec, s[26:27]
    buffer_load_dwordx2 v[12:13], v238, s[44:47], 0 offen sc1
    s_mov_b64 exec, -1
    ds_read_b64_tr_b16 a[18:19], v249 offset:34432
    buffer_load_dwordx4 v245, s[36:39], s69 offen offset:1024 lds
    v_mfma_f32_16x16x32_bf16 v[100:103], a[44:47], a[68:71], v[100:103]
    ds_read_b64_tr_b16 a[20:21], v249 offset:30880
    ds_read_b64_tr_b16 a[22:23], v249 offset:34464
    v_mfma_f32_16x16x32_bf16 v[104:107], a[48:51], a[64:67], v[104:107]
    ds_read_b64_tr_b16 a[24:25], v249 offset:30912
    ds_read_b64_tr_b16 a[26:27], v249 offset:34496
    v_mfma_f32_16x16x32_bf16 v[108:111], a[48:51], a[68:71], v[108:111]
    ds_read_b64_tr_b16 a[232:233], v209 offset:30720
    buffer_load_dwordx4 v246, s[36:39], s69 offen offset:2048 lds
    v_mfma_f32_16x16x32_bf16 v[112:115], a[52:55], a[64:67], v[112:115]
    ds_read_b64_tr_b16 a[234:235], v209 offset:34304
    ds_read_b64_tr_b16 a[236:237], v209 offset:30752
    v_mfma_f32_16x16x32_bf16 v[116:119], a[52:55], a[68:71], v[116:119]
    ds_read_b64_tr_b16 a[238:239], v209 offset:34336
    v_mfma_f32_16x16x32_bf16 v[120:123], a[240:243], v[128:131], v[120:123]
    s_mov_b64 exec, 0xffffffff
    buffer_load_dwordx4 v247, s[36:39], s69 offen offset:3072 lds
    s_mov_b64 exec, -1
    v_mfma_f32_16x16x32_bf16 v[124:127], a[244:247], v[128:131], v[124:127]
    s_waitcnt lgkmcnt(4)
    v_mfma_f32_16x16x32_bf16 v[64:67], a[0:3], a[56:59], v[64:67]
    ds_read_b128 a[64:67], v253 offset:30720
    ds_read_b128 a[68:71], v253 offset:32768
    v_mfma_f32_16x16x32_bf16 v[68:71], a[0:3], a[60:63], v[68:71]
    ds_read_b64_tr_b16 a[28:29], v249 offset:37888
    s_add_u32 m0, s70, 61440
    v_mfma_f32_16x16x32_bf16 v[72:75], a[4:7], a[56:59], v[72:75]
    ds_read_b64_tr_b16 a[30:31], v249 offset:41472
    ds_read_b64_tr_b16 a[32:33], v249 offset:37920
    v_mfma_f32_16x16x32_bf16 v[76:79], a[4:7], a[60:63], v[76:79]
    ds_read_b64_tr_b16 a[34:35], v249 offset:41504
    buffer_load_dwordx4 v240, s[32:35], s68 offen offset:0 lds
    v_mfma_f32_16x16x32_bf16 v[80:83], a[8:11], a[56:59], v[80:83]
    ds_read_b64_tr_b16 a[36:37], v249 offset:37952
    ds_read_b64_tr_b16 a[38:39], v249 offset:41536
    v_mfma_f32_16x16x32_bf16 v[84:87], a[8:11], a[60:63], v[84:87]
    ds_read_b64_tr_b16 a[40:41], v249 offset:37984
    buffer_load_dwordx4 v241, s[32:35], s68 offen offset:1024 lds
    v_mfma_f32_16x16x32_bf16 v[88:91], a[12:15], a[56:59], v[88:91]
    ds_read_b64_tr_b16 a[42:43], v249 offset:41568
    v_mfma_f32_16x16x32_bf16 v[92:95], a[12:15], a[60:63], v[92:95]
    ds_read_b64_tr_b16 a[44:45], v249 offset:38016
    ds_read_b64_tr_b16 a[46:47], v249 offset:41600
    v_mfma_f32_16x16x32_bf16 v[96:99], a[16:19], a[56:59], v[96:99]
    buffer_load_dwordx4 v242, s[32:35], s68 offen offset:2048 lds
    ds_read_b64_tr_b16 a[48:49], v249 offset:38048
    v_mfma_f32_16x16x32_bf16 v[100:103], a[16:19], a[60:63], v[100:103]
    ds_read_b64_tr_b16 a[50:51], v249 offset:41632
    ds_read_b64_tr_b16 a[52:53], v249 offset:38080
    v_mfma_f32_16x16x32_bf16 v[104:107], a[20:23], a[56:59], v[104:107]
    buffer_load_dwordx4 v243, s[32:35], s68 offen offset:3072 lds
    ds_read_b64_tr_b16 a[54:55], v249 offset:41664
    v_mfma_f32_16x16x32_bf16 v[108:111], a[20:23], a[60:63], v[108:111]
    ds_read_b64_tr_b16 a[240:241], v209 offset:37888
    v_mfma_f32_16x16x32_bf16 v[112:115], a[24:27], a[56:59], v[112:115]
    ds_read_b64_tr_b16 a[242:243], v209 offset:41472
    s_add_u32 s68, s68, 128
    s_cmp_eq_u32 s68, 1280
    s_cselect_b32 s68, 0, s68
    ds_read_b64_tr_b16 a[244:245], v209 offset:37920
    v_mfma_f32_16x16x32_bf16 v[116:119], a[24:27], a[60:63], v[116:119]
    ds_read_b64_tr_b16 a[246:247], v209 offset:41504
    s_waitcnt lgkmcnt(7)
    v_mfma_f32_16x16x32_bf16 v[120:123], a[232:235], v[128:131], v[120:123]
    s_mul_i32 s69, s68, 1728
    v_mfma_f32_16x16x32_bf16 v[124:127], a[236:239], v[128:131], v[124:127]
    v_mfma_f32_16x16x32_bf16 v[64:67], a[28:31], a[64:67], v[64:67]
    v_mfma_f32_16x16x32_bf16 v[68:71], a[28:31], a[68:71], v[68:71]
    s_waitcnt vmcnt(16)
    s_waitcnt lgkmcnt(0)
    s_barrier
    ds_read_b128 a[56:59], v250 offset:0
    s_nop 0
    v_mfma_f32_16x16x32_bf16 v[72:75], a[32:35], a[64:67], v[72:75]
    ds_read_b128 a[60:63], v250 offset:2048
    ds_read_b64_tr_b16 a[0:1], v248 offset:0
    v_mfma_f32_16x16x32_bf16 v[76:79], a[32:35], a[68:71], v[76:79]
    s_add_u32 m0, s71, 92160
    ds_read_b64_tr_b16 a[2:3], v248 offset:3584
    v_mfma_f32_16x16x32_bf16 v[80:83], a[36:39], a[64:67], v[80:83]
    ds_read_b64_tr_b16 a[4:5], v248 offset:32
    ds_read_b64_tr_b16 a[6:7], v248 offset:3616
    v_mfma_f32_16x16x32_bf16 v[84:87], a[36:39], a[68:71], v[84:87]
    ds_read_b64_tr_b16 a[8:9], v248 offset:64
    buffer_load_dwordx4 v244, s[36:39], s69 offen offset:0 lds
    ds_read_b64_tr_b16 a[10:11], v248 offset:3648
    v_mfma_f32_16x16x32_bf16 v[88:91], a[40:43], a[64:67], v[88:91]
    ds_read_b64_tr_b16 a[12:13], v248 offset:96
    v_mfma_f32_16x16x32_bf16 v[92:95], a[40:43], a[68:71], v[92:95]
    ds_read_b64_tr_b16 a[14:15], v248 offset:3680
    ds_read_b64_tr_b16 a[16:17], v248 offset:128
    v_mfma_f32_16x16x32_bf16 v[96:99], a[44:47], a[64:67], v[96:99]
    ds_read_b64_tr_b16 a[18:19], v248 offset:3712
    buffer_load_dwordx4 v245, s[36:39], s69 offen offset:1024 lds
    v_mfma_f32_16x16x32_bf16 v[100:103], a[44:47], a[68:71], v[100:103]
    ds_read_b64_tr_b16 a[20:21], v248 offset:160
    ds_read_b64_tr_b16 a[22:23], v248 offset:3744
    v_mfma_f32_16x16x32_bf16 v[104:107], a[48:51], a[64:67], v[104:107]
    ds_read_b64_tr_b16 a[24:25], v248 offset:192
    ds_read_b64_tr_b16 a[26:27], v248 offset:3776
    v_mfma_f32_16x16x32_bf16 v[108:111], a[48:51], a[68:71], v[108:111]
    ds_read_b64_tr_b16 a[232:233], v208 offset:0
    buffer_load_dwordx4 v246, s[36:39], s69 offen offset:2048 lds
    v_mfma_f32_16x16x32_bf16 v[112:115], a[52:55], a[64:67], v[112:115]
    ds_read_b64_tr_b16 a[234:235], v208 offset:3584
    ds_read_b64_tr_b16 a[236:237], v208 offset:32
    v_mfma_f32_16x16x32_bf16 v[116:119], a[52:55], a[68:71], v[116:119]
    ds_read_b64_tr_b16 a[238:239], v208 offset:3616
    v_mfma_f32_16x16x32_bf16 v[120:123], a[240:243], v[128:131], v[120:123]
    s_mov_b64 exec, 0xffffffff
    buffer_load_dwordx4 v247, s[36:39], s69 offen offset:3072 lds
    s_mov_b64 exec, -1
    v_mfma_f32_16x16x32_bf16 v[124:127], a[244:247], v[128:131], v[124:127]
    s_waitcnt lgkmcnt(4)
    v_mfma_f32_16x16x32_bf16 v[64:67], a[0:3], a[56:59], v[64:67]
    ds_read_b128 a[64:67], v251 offset:0
    ds_read_b128 a[68:71], v251 offset:2048
    v_mfma_f32_16x16x32_bf16 v[68:71], a[0:3], a[60:63], v[68:71]
    ds_read_b64_tr_b16 a[28:29], v248 offset:7168
    s_add_u32 m0, s70, 92160
    v_mfma_f32_16x16x32_bf16 v[72:75], a[4:7], a[56:59], v[72:75]
    ds_read_b64_tr_b16 a[30:31], v248 offset:10752
    ds_read_b64_tr_b16 a[32:33], v248 offset:7200
    v_mfma_f32_16x16x32_bf16 v[76:79], a[4:7], a[60:63], v[76:79]
    ds_read_b64_tr_b16 a[34:35], v248 offset:10784
    buffer_load_dwordx4 v240, s[32:35], s68 offen offset:0 lds
    v_mfma_f32_16x16x32_bf16 v[80:83], a[8:11], a[56:59], v[80:83]
    ds_read_b64_tr_b16 a[36:37], v248 offset:7232
    ds_read_b64_tr_b16 a[38:39], v248 offset:10816
    v_mfma_f32_16x16x32_bf16 v[84:87], a[8:11], a[60:63], v[84:87]
    ds_read_b64_tr_b16 a[40:41], v248 offset:7264
    buffer_load_dwordx4 v241, s[32:35], s68 offen offset:1024 lds
    v_mfma_f32_16x16x32_bf16 v[88:91], a[12:15], a[56:59], v[88:91]
    ds_read_b64_tr_b16 a[42:43], v248 offset:10848
    v_mfma_f32_16x16x32_bf16 v[92:95], a[12:15], a[60:63], v[92:95]
    ds_read_b64_tr_b16 a[44:45], v248 offset:7296
    ds_read_b64_tr_b16 a[46:47], v248 offset:10880
    v_mfma_f32_16x16x32_bf16 v[96:99], a[16:19], a[56:59], v[96:99]
    buffer_load_dwordx4 v242, s[32:35], s68 offen offset:2048 lds
    s_mov_b64 exec, s[26:27]
    buffer_load_dwordx4 v[8:11], v215, s[44:47], 0 offen sc1
    s_mov_b64 exec, -1
    ds_read_b64_tr_b16 a[48:49], v248 offset:7328
    v_mfma_f32_16x16x32_bf16 v[100:103], a[16:19], a[60:63], v[100:103]
    ds_read_b64_tr_b16 a[50:51], v248 offset:10912
    ds_read_b64_tr_b16 a[52:53], v248 offset:7360
    v_mfma_f32_16x16x32_bf16 v[104:107], a[20:23], a[56:59], v[104:107]
    buffer_load_dwordx4 v243, s[32:35], s68 offen offset:3072 lds
    ds_read_b64_tr_b16 a[54:55], v248 offset:10944
    v_mfma_f32_16x16x32_bf16 v[108:111], a[20:23], a[60:63], v[108:111]
    ds_read_b64_tr_b16 a[240:241], v208 offset:7168
    v_mfma_f32_16x16x32_bf16 v[112:115], a[24:27], a[56:59], v[112:115]
    ds_read_b64_tr_b16 a[242:243], v208 offset:10752
    s_add_u32 s68, s68, 128
    s_cmp_eq_u32 s68, 1280
    s_cselect_b32 s68, 0, s68
    ds_read_b64_tr_b16 a[244:245], v208 offset:7200
    v_mfma_f32_16x16x32_bf16 v[116:119], a[24:27], a[60:63], v[116:119]
    ds_read_b64_tr_b16 a[246:247], v208 offset:10784
    s_waitcnt lgkmcnt(7)
    v_mfma_f32_16x16x32_bf16 v[120:123], a[232:235], v[128:131], v[120:123]
    s_mul_i32 s69, s68, 1728
    s_mov_b64 exec, s[26:27]
    s_cbranch_execz L_ret1w
    s_waitcnt vmcnt(15)
    v_cmp_ne_u32 vcc, s58, v12
    v_cmp_ne_u32 s[66:67], s58, v13
    s_or_b64 vcc, vcc, s[66:67]
    s_cbranch_vccnz L_slow1w
L_ret1w:
    s_mov_b64 exec, -1
    v_mfma_f32_16x16x32_bf16 v[124:127], a[236:239], v[128:131], v[124:127]
    v_mfma_f32_16x16x32_bf16 v[64:67], a[28:31], a[64:67], v[64:67]
    v_mfma_f32_16x16x32_bf16 v[68:71], a[28:31], a[68:71], v[68:71]
    s_waitcnt vmcnt(16)
    s_waitcnt lgkmcnt(0)
    s_barrier
    ds_read_b128 a[56:59], v250 offset:30720
    v_mfma_f32_16x16x32_bf16 v[72:75], a[32:35], a[64:67], v[72:75]
    ds_read_b128 a[60:63], v250 offset:32768
    ds_read_b64_tr_b16 a[0:1], v248 offset:30720
    v_mfma_f32_16x16x32_bf16 v[76:79], a[32:35], a[68:71], v[76:79]
    s_add_u32 m0, s71, 0
    buffer_load_dwordx4 a[72:75], v223, s[16:19], s28 offen offset:0 sc1
    ds_read_b64_tr_b16 a[2:3], v248 offset:34304
    v_mfma_f32_16x16x32_bf16 v[80:83], a[36:39], a[64:67], v[80:83]
    s_nop 0
    ds_read_b64_tr_b16 a[4:5], v248 offset:30752
    ds_read_b64_tr_b16 a[6:7], v248 offset:34336
    v_mfma_f32_16x16x32_bf16 v[84:87], a[36:39], a[68:71], v[84:87]
    ds_read_b64_tr_b16 a[8:9], v248 offset:30784
    buffer_load_dwordx4 v244, s[36:39], s69 offen offset:0 lds
    ds_read_b64_tr_b16 a[10:11], v248 offset:34368
    v_mfma_f32_16x16x32_bf16 v[88:91], a[40:43], a[64:67], v[88:91]
    ds_read_b64_tr_b16 a[12:13], v248 offset:30816
    v_mfma_f32_16x16x32_bf16 v[92:95], a[40:43], a[68:71], v[92:95]
    ds_read_b64_tr_b16 a[14:15], v248 offset:34400
    ds_read_b64_tr_b16 a[16:17], v248 offset:30848
    v_mfma_f32_16x16x32_bf16 v[96:99], a[44:47], a[64:67], v[96:99]
    ds_read_b64_tr_b16 a[18:19], v248 offset:34432
    buffer_load_dwordx4 v245, s[36:39], s69 offen offset:1024 lds
    v_mfma_f32_16x16x32_bf16 v[100:103], a[44:47], a[68:71], v[100:103]
    ds_read_b64_tr_b16 a[20:21], v248 offset:30880
    ds_read_b64_tr_b16 a[22:23], v248 offset:34464
    v_mfma_f32_16x16x32_bf16 v[104:107], a[48:51], a[64:67], v[104:107]
    ds_read_b64_tr_b16 a[24:25], v248 offset:30912
    ds_read_b64_tr_b16 a[26:27], v248 offset:34496
    v_mfma_f32_16x16x32_bf16 v[108:111], a[48:51], a[68:71], v[108:111]
    ds_read_b64_tr_b16 a[232:233], v208 offset:30720
    buffer_load_dwordx4 v246, s[36:39], s69 offen offset:2048 lds
    v_mfma_f32_16x16x32_bf16 v[112:115], a[52:55], a[64:67], v[112:115]
    ds_read_b64_tr_b16 a[234:235], v208 offset:34304
    ds_read_b64_tr_b16 a[236:237], v208 offset:30752
    v_mfma_f32_16x16x32_bf16 v[116:119], a[52:55], a[68:71], v[116:119]
    buffer_load_dwordx4 a[76:79], v223, s[16:19], s28 offen offset:1024 sc1
    ds_read_b64_tr_b16 a[238:239], v208 offset:34336
    v_mfma_f32_16x16x32_bf16 v[120:123], a[240:243], v[128:131], v[120:123]
    s_mov_b64 exec, 0xffffffff
    buffer_load_dwordx4 v247, s[36:39], s69 offen offset:3072 lds
    s_mov_b64 exec, -1
    v_mfma_f32_16x16x32_bf16 v[124:127], a[244:247], v[128:131], v[124:127]
    s_waitcnt lgkmcnt(4)
    v_mfma_f32_16x16x32_bf16 v[64:67], a[0:3], a[56:59], v[64:67]
    ds_read_b128 a[64:67], v251 offset:30720
    ds_read_b128 a[68:71], v251 offset:32768
    v_mfma_f32_16x16x32_bf16 v[68:71], a[0:3], a[60:63], v[68:71]
    ds_read_b64_tr_b16 a[28:29], v248 offset:37888
    s_add_u32 m0, s70, 0
    s_nop 0
    v_mfma_f32_16x16x32_bf16 v[72:75], a[4:7], a[56:59], v[72:75]
    ds_read_b64_tr_b16 a[30:31], v248 offset:41472
    ds_read_b64_tr_b16 a[32:33], v248 offset:37920
    v_mfma_f32_16x16x32_bf16 v[76:79], a[4:7], a[60:63], v[76:79]
    ds_read_b64_tr_b16 a[34:35], v248 offset:41504
    buffer_load_dwordx4 v240, s[32:35], s68 offen offset:0 lds
    v_mfma_f32_16x16x32_bf16 v[80:83], a[8:11], a[56:59], v[80:83]
    ds_read_b64_tr_b16 a[36:37], v248 offset:37952
    ds_read_b64_tr_b16 a[38:39], v248 offset:41536
    v_mfma_f32_16x16x32_bf16 v[84:87], a[8:11], a[60:63], v[84:87]
    ds_read_b64_tr_b16 a[40:41], v248 offset:37984
    buffer_load_dwordx4 v241, s[32:35], s68 offen offset:1024 lds
    v_mfma_f32_16x16x32_bf16 v[88:91], a[12:15], a[56:59], v[88:91]
    ds_read_b64_tr_b16 a[42:43], v248 offset:41568
    v_mfma_f32_16x16x32_bf16 v[92:95], a[12:15], a[60:63], v[92:95]
    ds_read_b64_tr_b16 a[44:45], v248 offset:38016
    buffer_load_dwordx4 a[80:83], v223, s[16:19], s28 offen offset:2048 sc1
    ds_read_b64_tr_b16 a[46:47], v248 offset:41600
    v_mfma_f32_16x16x32_bf16 v[96:99], a[16:19], a[56:59], v[96:99]
    buffer_load_dwordx4 v242, s[32:35], s68 offen offset:2048 lds
    ds_read_b64_tr_b16 a[48:49], v248 offset:38048
    v_mfma_f32_16x16x32_bf16 v[100:103], a[16:19], a[60:63], v[100:103]
    ds_read_b64_tr_b16 a[50:51], v248 offset:41632
    ds_read_b64_tr_b16 a[52:53], v248 offset:38080
    v_mfma_f32_16x16x32_bf16 v[104:107], a[20:23], a[56:59], v[104:107]
    buffer_load_dwordx4 v243, s[32:35], s68 offen offset:3072 lds
    ds_read_b64_tr_b16 a[54:55], v248 offset:41664
    v_mfma_f32_16x16x32_bf16 v[108:111], a[20:23], a[60:63], v[108:111]
    ds_read_b64_tr_b16 a[240:241], v208 offset:37888
    v_mfma_f32_16x16x32_bf16 v[112:115], a[24:27], a[56:59], v[112:115]
    ds_read_b64_tr_b16 a[242:243], v208 offset:41472
    s_add_u32 s68, s68, 128
    s_cmp_eq_u32 s68, 1280
    s_cselect_b32 s68, 0, s68
    ds_read_b64_tr_b16 a[244:245], v208 offset:37920
    v_mfma_f32_16x16x32_bf16 v[116:119], a[24:27], a[60:63], v[116:119]
    ds_read_b64_tr_b16 a[246:247], v208 offset:41504
    s_waitcnt lgkmcnt(7)
    v_mfma_f32_16x16x32_bf16 v[120:123], a[232:235], v[128:131], v[120:123]
    s_mul_i32 s69, s68, 1728
    s_mov_b64 exec, s[26:27]
    s_cbranch_execz L_ret1
    s_waitcnt vmcnt(12)
    v_cmp_ne_u32 vcc, s58, v8
    v_cmp_ne_u32 s[66:67], s58, v9
    s_or_b64 vcc, vcc, s[66:67]
    v_cmp_ne_u32 s[66:67], s58, v10
    s_or_b64 vcc, vcc, s[66:67]
    v_cmp_ne_u32 s[66:67], s58, v11
    s_or_b64 vcc, vcc, s[66:67]
    s_cbranch_vccnz L_slow1
L_ret1:
    s_mov_b64 exec, -1
    v_mfma_f32_16x16x32_bf16 v[124:127], a[236:239], v[128:131], v[124:127]
    v_mfma_f32_16x16x32_bf16 v[64:67], a[28:31], a[64:67], v[64:67]
    v_mfma_f32_16x16x32_bf16 v[68:71], a[28:31], a[68:71], v[68:71]
    s_waitcnt vmcnt(19)
    s_waitcnt lgkmcnt(0)
    s_barrier
    buffer_load_dwordx4 a[84:87], v223, s[16:19], s28 offen offset:3072 sc1
    ds_read_b128 a[56:59], v252 offset:0
    v_mfma_f32_16x16x32_bf16 v[72:75], a[32:35], a[64:67], v[72:75]
    ds_read_b128 a[60:63], v252 offset:2048
    ds_read_b64_tr_b16 a[0:1], v249 offset:0
    v_mfma_f32_16x16x32_bf16 v[76:79], a[32:35], a[68:71], v[76:79]
    s_add_u32 m0, s71, 30720
    buffer_load_dword v14, v239, s[44:47], s4 offen offset:0 sc1
    ds_read_b64_tr_b16 a[2:3], v249 offset:3584
    v_mfma_f32_16x16x32_bf16 v[80:83], a[36:39], a[64:67], v[80:83]
    ds_read_b64_tr_b16 a[4:5], v249 offset:32
    ds_read_b64_tr_b16 a[6:7], v249 offset:3616
    v_mfma_f32_16x16x32_bf16 v[84:87], a[36:39], a[68:71], v[84:87]
    ds_read_b64_tr_b16 a[8:9], v249 offset:64
    buffer_load_dwordx4 v244, s[36:39], s69 offen offset:0 lds
    ds_read_b64_tr_b16 a[10:11], v249 offset:3648
    v_mfma_f32_16x16x32_bf16 v[88:91], a[40:43], a[64:67], v[88:91]
    ds_read_b64_tr_b16 a[12:13], v249 offset:96
    v_mfma_f32_16x16x32_bf16 v[92:95], a[40:43], a[68:71], v[92:95]
    ds_read_b64_tr_b16 a[14:15], v249 offset:3680
    ds_read_b64_tr_b16 a[16:17], v249 offset:128
    v_mfma_f32_16x16x32_bf16 v[96:99], a[44:47], a[64:67], v[96:99]
    ds_read_b64_tr_b16 a[18:19], v249 offset:3712
    buffer_load_dwordx4 v245, s[36:39], s69 offen offset:1024 lds
    v_mfma_f32_16x16x32_bf16 v[100:103], a[44:47], a[68:71], v[100:103]
    ds_read_b64_tr_b16 a[20:21], v249 offset:160
    ds_read_b64_tr_b16 a[22:23], v249 offset:3744
    v_mfma_f32_16x16x32_bf16 v[104:107], a[48:51], a[64:67], v[104:107]
    ds_read_b64_tr_b16 a[24:25], v249 offset:192
    ds_read_b64_tr_b16 a[26:27], v249 offset:3776
    v_mfma_f32_16x16x32_bf16 v[108:111], a[48:51], a[68:71], v[108:111]
    buffer_load_dwordx4 a[88:91], v236, s[16:19], s28 offen offset:0 sc1
    ds_read_b64_tr_b16 a[232:233], v209 offset:0
    buffer_load_dwordx4 v246, s[36:39], s69 offen offset:2048 lds
    v_mfma_f32_16x16x32_bf16 v[112:115], a[52:55], a[64:67], v[112:115]
    ds_read_b64_tr_b16 a[234:235], v209 offset:3584
    ds_read_b64_tr_b16 a[236:237], v209 offset:32
    v_mfma_f32_16x16x32_bf16 v[116:119], a[52:55], a[68:71], v[116:119]
    ds_read_b64_tr_b16 a[238:239], v209 offset:3616
    v_mfma_f32_16x16x32_bf16 v[120:123], a[240:243], v[128:131], v[120:123]
    s_mov_b64 exec, 0xffffffff
    buffer_load_dwordx4 v247, s[36:39], s69 offen offset:3072 lds
    s_mov_b64 exec, -1
    buffer_load_dword v15, v239, s[44:47], s4 offen offset:128 sc1
    v_mfma_f32_16x16x32_bf16 v[124:127], a[244:247], v[128:131], v[124:127]
    s_waitcnt lgkmcnt(4)
    v_mfma_f32_16x16x32_bf16 v[64:67], a[0:3], a[56:59], v[64:67]
    ds_read_b128 a[64:67], v253 offset:0
    ds_read_b128 a[68:71], v253 offset:2048
    v_mfma_f32_16x16x32_bf16 v[68:71], a[0:3], a[60:63], v[68:71]
    ds_read_b64_tr_b16 a[28:29], v249 offset:7168
    s_add_u32 m0, s70, 30720
    v_mfma_f32_16x16x32_bf16 v[72:75], a[4:7], a[56:59], v[72:75]
    ds_read_b64_tr_b16 a[30:31], v249 offset:10752
    ds_read_b64_tr_b16 a[32:33], v249 offset:7200
    v_mfma_f32_16x16x32_bf16 v[76:79], a[4:7], a[60:63], v[76:79]
    ds_read_b64_tr_b16 a[34:35], v249 offset:10784
    v_mfma_f32_16x16x32_bf16 v[80:83], a[8:11], a[56:59], v[80:83]
    ds_read_b64_tr_b16 a[36:37], v249 offset:7232
    buffer_load_dwordx4 v240, s[32:35], s68 offen offset:0 lds
    ds_read_b64_tr_b16 a[38:39], v249 offset:10816
    v_mfma_f32_16x16x32_bf16 v[84:87], a[8:11], a[60:63], v[84:87]
    s_add_u32 s28, s28, 40960
    s_cmp_eq_u32 s28, s29
    s_cselect_b32 s28, s1, s28
    ds_read_b64_tr_b16 a[40:41], v249 offset:7264
    v_mfma_f32_16x16x32_bf16 v[88:91], a[12:15], a[56:59], v[88:91]
    ds_read_b64_tr_b16 a[42:43], v249 offset:10848
    v_mfma_f32_16x16x32_bf16 v[92:95], a[12:15], a[60:63], v[92:95]
    ds_read_b64_tr_b16 a[44:45], v249 offset:7296
    ds_read_b64_tr_b16 a[46:47], v249 offset:10880
    v_mfma_f32_16x16x32_bf16 v[96:99], a[16:19], a[56:59], v[96:99]
    buffer_load_dwordx4 v241, s[32:35], s68 offen offset:1024 lds
    ds_read_b64_tr_b16 a[48:49], v249 offset:7328
    v_mfma_f32_16x16x32_bf16 v[100:103], a[16:19], a[60:63], v[100:103]
    ds_read_b64_tr_b16 a[50:51], v249 offset:10912
    ds_read_b64_tr_b16 a[52:53], v249 offset:7360
    v_mfma_f32_16x16x32_bf16 v[104:107], a[20:23], a[56:59], v[104:107]
    ds_read_b64_tr_b16 a[54:55], v249 offset:10944
    v_mfma_f32_16x16x32_bf16 v[108:111], a[20:23], a[60:63], v[108:111]
    buffer_load_dwordx4 v242, s[32:35], s68 offen offset:2048 lds
    ds_read_b64_tr_b16 a[240:241], v209 offset:7168
    v_mfma_f32_16x16x32_bf16 v[112:115], a[24:27], a[56:59], v[112:115]
    ds_read_b64_tr_b16 a[242:243], v209 offset:10752
    ds_read_b64_tr_b16 a[244:245], v209 offset:7200
    v_mfma_f32_16x16x32_bf16 v[116:119], a[24:27], a[60:63], v[116:119]
    ds_read_b64_tr_b16 a[246:247], v209 offset:10784
    s_waitcnt lgkmcnt(7)
    v_mfma_f32_16x16x32_bf16 v[120:123], a[232:235], v[128:131], v[120:123]
    buffer_load_dwordx4 v243, s[32:35], s68 offen offset:3072 lds
    v_mfma_f32_16x16x32_bf16 v[124:127], a[236:239], v[128:131], v[124:127]
    buffer_load_dwordx4 a[92:95], v223, s[16:19], s28 offen offset:0 sc1
    v_mfma_f32_16x16x32_bf16 v[64:67], a[28:31], a[64:67], v[64:67]
    v_mfma_f32_16x16x32_bf16 v[68:71], a[28:31], a[68:71], v[68:71]
    s_waitcnt vmcnt(24)
    s_waitcnt lgkmcnt(0)
    s_barrier
    ds_read_b128 a[56:59], v252 offset:30720
    v_mfma_f32_16x16x32_bf16 v[72:75], a[32:35], a[64:67], v[72:75]
    s_mul_i32 s60, s52, 3072
    s_add_u32 m0, s60, 150432
    s_nop 0
    buffer_load_dwordx4 v237, s[44:47], 0 offen sc1 lds
    ds_read_b128 a[60:63], v252 offset:32768
    ds_read_b64_tr_b16 a[0:1], v249 offset:30720
    s_nop 0
    v_mfma_f32_16x16x32_bf16 v[76:79], a[32:35], a[68:71], v[76:79]
    ds_read_b64_tr_b16 a[2:3], v249 offset:34304
    v_mfma_f32_16x16x32_bf16 v[80:83], a[36:39], a[64:67], v[80:83]
    ds_read_b64_tr_b16 a[4:5], v249 offset:30752
    ds_read_b64_tr_b16 a[6:7], v249 offset:34336
    v_mfma_f32_16x16x32_bf16 v[84:87], a[36:39], a[68:71], v[84:87]
    ds_read_b64_tr_b16 a[8:9], v249 offset:30784
    ds_read_b64_tr_b16 a[10:11], v249 offset:34368
    v_mfma_f32_16x16x32_bf16 v[88:91], a[40:43], a[64:67], v[88:91]
    ds_read_b64_tr_b16 a[12:13], v249 offset:30816
    v_mfma_f32_16x16x32_bf16 v[92:95], a[40:43], a[68:71], v[92:95]
    ds_read_b64_tr_b16 a[14:15], v249 offset:34400
    ds_read_b64_tr_b16 a[16:17], v249 offset:30848
    v_mfma_f32_16x16x32_bf16 v[96:99], a[44:47], a[64:67], v[96:99]
    s_add_u32 m0, s60, 151456
    s_nop 0
    s_nop 0
    buffer_load_dwordx4 v212, s[44:47], 0 offen sc1 lds
    ds_read_b64_tr_b16 a[18:19], v249 offset:34432
    v_mfma_f32_16x16x32_bf16 v[100:103], a[44:47], a[68:71], v[100:103]
    ds_read_b64_tr_b16 a[20:21], v249 offset:30880
    buffer_load_dwordx4 a[96:99], v223, s[16:19], s28 offen offset:1024 sc1
    ds_read_b64_tr_b16 a[22:23], v249 offset:34464
    v_mfma_f32_16x16x32_bf16 v[104:107], a[48:51], a[64:67], v[104:107]
    ds_read_b64_tr_b16 a[24:25], v249 offset:30912
    ds_read_b64_tr_b16 a[26:27], v249 offset:34496
    v_mfma_f32_16x16x32_bf16 v[108:111], a[48:51], a[68:71], v[108:111]
    ds_read_b64_tr_b16 a[232:233], v209 offset:30720
    v_mfma_f32_16x16x32_bf16 v[112:115], a[52:55], a[64:67], v[112:115]
    ds_read_b64_tr_b16 a[234:235], v209 offset:34304
    ds_read_b64_tr_b16 a[236:237], v209 offset:30752
    v_mfma_f32_16x16x32_bf16 v[116:119], a[52:55], a[68:71], v[116:119]
    ds_read_b64_tr_b16 a[238:239], v209 offset:34336
    v_mfma_f32_16x16x32_bf16 v[120:123], a[240:243], v[128:131], v[120:123]
    s_add_u32 m0, s60, 152480
    s_nop 0
    buffer_load_dwordx4 v213, s[44:47], 0 offen sc1 lds
    v_mfma_f32_16x16x32_bf16 v[124:127], a[244:247], v[128:131], v[124:127]
    s_waitcnt lgkmcnt(4)
    v_mfma_f32_16x16x32_bf16 v[64:67], a[0:3], a[56:59], v[64:67]
    ds_read_b128 a[64:67], v253 offset:30720
    ds_read_b128 a[68:71], v253 offset:32768
    v_mfma_f32_16x16x32_bf16 v[68:71], a[0:3], a[60:63], v[68:71]
    ds_read_b64_tr_b16 a[28:29], v249 offset:37888
    v_mfma_f32_16x16x32_bf16 v[72:75], a[4:7], a[56:59], v[72:75]
    ds_read_b64_tr_b16 a[30:31], v249 offset:41472
    ds_read_b64_tr_b16 a[32:33], v249 offset:37920
    v_mfma_f32_16x16x32_bf16 v[76:79], a[4:7], a[60:63], v[76:79]
    buffer_load_dwordx4 a[100:103], v223, s[16:19], s28 offen offset:2048 sc1
    ds_read_b64_tr_b16 a[34:35], v249 offset:41504
    v_mfma_f32_16x16x32_bf16 v[80:83], a[8:11], a[56:59], v[80:83]
    ds_read_b64_tr_b16 a[36:37], v249 offset:37952
    ds_read_b64_tr_b16 a[38:39], v249 offset:41536
    v_mfma_f32_16x16x32_bf16 v[84:87], a[8:11], a[60:63], v[84:87]
    ds_read_b64_tr_b16 a[40:41], v249 offset:37984
    v_mfma_f32_16x16x32_bf16 v[88:91], a[12:15], a[56:59], v[88:91]
    ds_read_b64_tr_b16 a[42:43], v249 offset:41568
    v_mfma_f32_16x16x32_bf16 v[92:95], a[12:15], a[60:63], v[92:95]
    ds_read_b64_tr_b16 a[44:45], v249 offset:38016
    ds_read_b64_tr_b16 a[46:47], v249 offset:41600
    v_mfma_f32_16x16x32_bf16 v[96:99], a[16:19], a[56:59], v[96:99]
    ds_read_b64_tr_b16 a[48:49], v249 offset:38048
    v_mfma_f32_16x16x32_bf16 v[100:103], a[16:19], a[60:63], v[100:103]
    ds_read_b64_tr_b16 a[50:51], v249 offset:41632
    ds_read_b64_tr_b16 a[52:53], v249 offset:38080
    v_mfma_f32_16x16x32_bf16 v[104:107], a[20:23], a[56:59], v[104:107]
    ds_read_b64_tr_b16 a[54:55], v249 offset:41664
    v_mfma_f32_16x16x32_bf16 v[108:111], a[20:23], a[60:63], v[108:111]
    ds_read_b64_tr_b16 a[240:241], v209 offset:37888
    v_mfma_f32_16x16x32_bf16 v[112:115], a[24:27], a[56:59], v[112:115]
    ds_read_b64_tr_b16 a[242:243], v209 offset:41472
    ds_read_b64_tr_b16 a[244:245], v209 offset:37920
    v_mfma_f32_16x16x32_bf16 v[116:119], a[24:27], a[60:63], v[116:119]
    ds_read_b64_tr_b16 a[246:247], v209 offset:41504
    buffer_load_dwordx4 a[104:107], v223, s[16:19], s28 offen offset:3072 sc1
    s_waitcnt lgkmcnt(7)
    v_mfma_f32_16x16x32_bf16 v[120:123], a[232:235], v[128:131], v[120:123]
    v_mfma_f32_16x16x32_bf16 v[124:127], a[236:239], v[128:131], v[124:127]
    v_mfma_f32_16x16x32_bf16 v[64:67], a[28:31], a[64:67], v[64:67]
    v_mfma_f32_16x16x32_bf16 v[68:71], a[28:31], a[68:71], v[68:71]
    s_waitcnt vmcnt(19)
    s_waitcnt lgkmcnt(0)
    s_barrier
    ds_read_b128 a[56:59], v250 offset:0
    v_mfma_f32_16x16x32_bf16 v[72:75], a[32:35], a[64:67], v[72:75]
    ds_read_b128 a[60:63], v250 offset:2048
    ds_read_b64_tr_b16 a[0:1], v248 offset:0
    v_mfma_f32_16x16x32_bf16 v[76:79], a[32:35], a[68:71], v[76:79]
    ds_read_b64_tr_b16 a[2:3], v248 offset:3584
    v_mfma_f32_16x16x32_bf16 v[80:83], a[36:39], a[64:67], v[80:83]
    ds_read_b64_tr_b16 a[4:5], v248 offset:32
    ds_read_b64_tr_b16 a[6:7], v248 offset:3616
    v_mfma_f32_16x16x32_bf16 v[84:87], a[36:39], a[68:71], v[84:87]
    ds_read_b64_tr_b16 a[8:9], v248 offset:64
    ds_read_b64_tr_b16 a[10:11], v248 offset:3648
    v_mfma_f32_16x16x32_bf16 v[88:91], a[40:43], a[64:67], v[88:91]
    ds_read_b64_tr_b16 a[12:13], v248 offset:96
    v_mfma_f32_16x16x32_bf16 v[92:95], a[40:43], a[68:71], v[92:95]
    ds_read_b64_tr_b16 a[14:15], v248 offset:3680
    buffer_load_dwordx4 a[108:111], v236, s[16:19], s28 offen offset:0 sc1
    ds_read_b64_tr_b16 a[16:17], v248 offset:128
    v_mfma_f32_16x16x32_bf16 v[96:99], a[44:47], a[64:67], v[96:99]
    ds_read_b64_tr_b16 a[18:19], v248 offset:3712
    v_mfma_f32_16x16x32_bf16 v[100:103], a[44:47], a[68:71], v[100:103]
    ds_read_b64_tr_b16 a[20:21], v248 offset:160
    ds_read_b64_tr_b16 a[22:23], v248 offset:3744
    v_mfma_f32_16x16x32_bf16 v[104:107], a[48:51], a[64:67], v[104:107]
    ds_read_b64_tr_b16 a[24:25], v248 offset:192
    ds_read_b64_tr_b16 a[26:27], v248 offset:3776
    v_mfma_f32_16x16x32_bf16 v[108:111], a[48:51], a[68:71], v[108:111]
    ds_read_b64_tr_b16 a[232:233], v208 offset:0
    v_mfma_f32_16x16x32_bf16 v[112:115], a[52:55], a[64:67], v[112:115]
    ds_read_b64_tr_b16 a[234:235], v208 offset:3584
    ds_read_b64_tr_b16 a[236:237], v208 offset:32
    v_mfma_f32_16x16x32_bf16 v[116:119], a[52:55], a[68:71], v[116:119]
    ds_read_b64_tr_b16 a[238:239], v208 offset:3616
    v_mfma_f32_16x16x32_bf16 v[120:123], a[240:243], v[128:131], v[120:123]
    v_mfma_f32_16x16x32_bf16 v[124:127], a[244:247], v[128:131], v[124:127]
    s_waitcnt lgkmcnt(4)
    v_mfma_f32_16x16x32_bf16 v[64:67], a[0:3], a[56:59], v[64:67]
    ds_read_b128 a[64:67], v251 offset:0
    ds_read_b128 a[68:71], v251 offset:2048
    v_mfma_f32_16x16x32_bf16 v[68:71], a[0:3], a[60:63], v[68:71]
    ds_read_b64_tr_b16 a[28:29], v248 offset:7168
    s_add_u32 s28, s28, 40960
    s_cmp_eq_u32 s28, s29
    s_cselect_b32 s28, s1, s28
    v_mfma_f32_16x16x32_bf16 v[72:75], a[4:7], a[56:59], v[72:75]
    ds_read_b64_tr_b16 a[30:31], v248 offset:10752
    s_nop 0
    ds_read_b64_tr_b16 a[32:33], v248 offset:7200
    v_mfma_f32_16x16x32_bf16 v[76:79], a[4:7], a[60:63], v[76:79]
    ds_read_b64_tr_b16 a[34:35], v248 offset:10784
    v_mfma_f32_16x16x32_bf16 v[80:83], a[8:11], a[56:59], v[80:83]
    ds_read_b64_tr_b16 a[36:37], v248 offset:7232
    ds_read_b64_tr_b16 a[38:39], v248 offset:10816
    v_mfma_f32_16x16x32_bf16 v[84:87], a[8:11], a[60:63], v[84:87]
    ds_read_b64_tr_b16 a[40:41], v248 offset:7264
    v_mfma_f32_16x16x32_bf16 v[88:91], a[12:15], a[56:59], v[88:91]
    ds_read_b64_tr_b16 a[42:43], v248 offset:10848
    v_mfma_f32_16x16x32_bf16 v[92:95], a[12:15], a[60:63], v[92:95]
    ds_read_b64_tr_b16 a[44:45], v248 offset:7296
    ds_read_b64_tr_b16 a[46:47], v248 offset:10880
    v_mfma_f32_16x16x32_bf16 v[96:99], a[16:19], a[56:59], v[96:99]
    ds_read_b64_tr_b16 a[48:49], v248 offset:7328
    v_mfma_f32_16x16x32_bf16 v[100:103], a[16:19], a[60:63], v[100:103]
    ds_read_b64_tr_b16 a[50:51], v248 offset:10912
    ds_read_b64_tr_b16 a[52:53], v248 offset:7360
    v_mfma_f32_16x16x32_bf16 v[104:107], a[20:23], a[56:59], v[104:107]
    ds_read_b64_tr_b16 a[54:55], v248 offset:10944
    v_mfma_f32_16x16x32_bf16 v[108:111], a[20:23], a[60:63], v[108:111]
    ds_read_b64_tr_b16 a[240:241], v208 offset:7168
    buffer_load_dwordx4 a[112:115], v223, s[16:19], s28 offen offset:0 sc1
    v_mfma_f32_16x16x32_bf16 v[112:115], a[24:27], a[56:59], v[112:115]
    ds_read_b64_tr_b16 a[242:243], v208 offset:10752
    ds_read_b64_tr_b16 a[244:245], v208 offset:7200
    v_mfma_f32_16x16x32_bf16 v[116:119], a[24:27], a[60:63], v[116:119]
    ds_read_b64_tr_b16 a[246:247], v208 offset:10784
    s_waitcnt lgkmcnt(7)
    v_mfma_f32_16x16x32_bf16 v[120:123], a[232:235], v[128:131], v[120:123]
    v_mfma_f32_16x16x32_bf16 v[124:127], a[236:239], v[128:131], v[124:127]
    v_mfma_f32_16x16x32_bf16 v[64:67], a[28:31], a[64:67], v[64:67]
    v_mfma_f32_16x16x32_bf16 v[68:71], a[28:31], a[68:71], v[68:71]
    s_waitcnt vmcnt(9)
    s_waitcnt lgkmcnt(0)
    s_barrier
    ds_read_b128 a[56:59], v250 offset:30720
    v_mfma_f32_16x16x32_bf16 v[72:75], a[32:35], a[64:67], v[72:75]
    ds_read_b128 a[60:63], v250 offset:32768
    ds_read_b64_tr_b16 a[0:1], v248 offset:30720
    v_mfma_f32_16x16x32_bf16 v[76:79], a[32:35], a[68:71], v[76:79]
    ds_read_b64_tr_b16 a[2:3], v248 offset:34304
    v_mfma_f32_16x16x32_bf16 v[80:83], a[36:39], a[64:67], v[80:83]
    ds_read_b64_tr_b16 a[4:5], v248 offset:30752
    ds_read_b64_tr_b16 a[6:7], v248 offset:34336
    v_mfma_f32_16x16x32_bf16 v[84:87], a[36:39], a[68:71], v[84:87]
    ds_read_b64_tr_b16 a[8:9], v248 offset:30784
    buffer_load_dwordx4 a[116:119], v223, s[16:19], s28 offen offset:1024 sc1
    ds_read_b64_tr_b16 a[10:11], v248 offset:34368
    v_mfma_f32_16x16x32_bf16 v[88:91], a[40:43], a[64:67], v[88:91]
    ds_read_b64_tr_b16 a[12:13], v248 offset:30816
    v_mfma_f32_16x16x32_bf16 v[92:95], a[40:43], a[68:71], v[92:95]
    ds_read_b64_tr_b16 a[14:15], v248 offset:34400
    ds_read_b64_tr_b16 a[16:17], v248 offset:30848
    v_mfma_f32_16x16x32_bf16 v[96:99], a[44:47], a[64:67], v[96:99]
    ds_read_b64_tr_b16 a[18:19], v248 offset:34432
    v_mfma_f32_16x16x32_bf16 v[100:103], a[44:47], a[68:71], v[100:103]
    ds_read_b64_tr_b16 a[20:21], v248 offset:30880
    ds_read_b64_tr_b16 a[22:23], v248 offset:34464
    v_mfma_f32_16x16x32_bf16 v[104:107], a[48:51], a[64:67], v[104:107]
    ds_read_b64_tr_b16 a[24:25], v248 offset:30912
    ds_read_b64_tr_b16 a[26:27], v248 offset:34496
    v_mfma_f32_16x16x32_bf16 v[108:111], a[48:51], a[68:71], v[108:111]
    ds_read_b64_tr_b16 a[232:233], v208 offset:30720
    v_mfma_f32_16x16x32_bf16 v[112:115], a[52:55], a[64:67], v[112:115]
    ds_read_b64_tr_b16 a[234:235], v208 offset:34304
    ds_read_b64_tr_b16 a[236:237], v208 offset:30752
    v_mfma_f32_16x16x32_bf16 v[116:119], a[52:55], a[68:71], v[116:119]
    ds_read_b64_tr_b16 a[238:239], v208 offset:34336
    v_mfma_f32_16x16x32_bf16 v[120:123], a[240:243], v[128:131], v[120:123]
    v_mfma_f32_16x16x32_bf16 v[124:127], a[244:247], v[128:131], v[124:127]
    buffer_load_dwordx4 a[120:123], v223, s[16:19], s28 offen offset:2048 sc1
    s_waitcnt lgkmcnt(4)
    v_mfma_f32_16x16x32_bf16 v[64:67], a[0:3], a[56:59], v[64:67]
    s_nop 0
    ds_read_b64_tr_b16 a[240:241], v208 offset:37888
    ds_read_b64_tr_b16 a[242:243], v208 offset:41472
    v_mfma_f32_16x16x32_bf16 v[68:71], a[0:3], a[60:63], v[68:71]
    ds_read_b64_tr_b16 a[244:245], v208 offset:37920
    v_mfma_f32_16x16x32_bf16 v[72:75], a[4:7], a[56:59], v[72:75]
    ds_read_b64_tr_b16 a[246:247], v208 offset:41504
    ds_read_b128 a[64:67], v251 offset:30720
    v_mfma_f32_16x16x32_bf16 v[76:79], a[4:7], a[60:63], v[76:79]
    ds_read_b128 a[68:71], v251 offset:32768
    v_mfma_f32_16x16x32_bf16 v[80:83], a[8:11], a[56:59], v[80:83]
    ds_read_b64_tr_b16 a[28:29], v248 offset:37888
    ds_read_b64_tr_b16 a[30:31], v248 offset:41472
    v_mfma_f32_16x16x32_bf16 v[84:87], a[8:11], a[60:63], v[84:87]
    ds_read_b64_tr_b16 a[32:33], v248 offset:37920
    v_mfma_f32_16x16x32_bf16 v[88:91], a[12:15], a[56:59], v[88:91]
    ds_read_b64_tr_b16 a[34:35], v248 offset:41504
    v_mfma_f32_16x16x32_bf16 v[92:95], a[12:15], a[60:63], v[92:95]
    ds_read_b64_tr_b16 a[36:37], v248 offset:37952
    ds_read_b64_tr_b16 a[38:39], v248 offset:41536
    v_mfma_f32_16x16x32_bf16 v[96:99], a[16:19], a[56:59], v[96:99]
    ds_read_b64_tr_b16 a[40:41], v248 offset:37984
    v_mfma_f32_16x16x32_bf16 v[100:103], a[16:19], a[60:63], v[100:103]
    ds_read_b64_tr_b16 a[42:43], v248 offset:41568
    buffer_load_dwordx4 a[124:127], v223, s[16:19], s28 offen offset:3072 sc1
    ds_read_b64_tr_b16 a[44:45], v248 offset:38016
    v_mfma_f32_16x16x32_bf16 v[104:107], a[20:23], a[56:59], v[104:107]
    ds_read_b64_tr_b16 a[46:47], v248 offset:41600
    v_mfma_f32_16x16x32_bf16 v[108:111], a[20:23], a[60:63], v[108:111]
    ds_read_b64_tr_b16 a[48:49], v248 offset:38048
    v_mfma_f32_16x16x32_bf16 v[112:115], a[24:27], a[56:59], v[112:115]
    ds_read_b64_tr_b16 a[50:51], v248 offset:41632
    ds_read_b64_tr_b16 a[52:53], v248 offset:38080
    v_mfma_f32_16x16x32_bf16 v[116:119], a[24:27], a[60:63], v[116:119]
    ds_read_b64_tr_b16 a[54:55], v248 offset:41664
    s_waitcnt lgkmcnt(7)
    v_mfma_f32_16x16x32_bf16 v[120:123], a[232:235], v[128:131], v[120:123]
    s_nop 0
    v_mfma_f32_16x16x32_bf16 v[124:127], a[236:239], v[128:131], v[124:127]
    v_mfma_f32_16x16x32_bf16 v[120:123], a[240:243], v[128:131], v[120:123]
    v_mfma_f32_16x16x32_bf16 v[124:127], a[244:247], v[128:131], v[124:127]
    v_mfma_f32_16x16x32_bf16 v[64:67], a[28:31], a[64:67], v[64:67]
    v_mfma_f32_16x16x32_bf16 v[68:71], a[28:31], a[68:71], v[68:71]
    buffer_load_dwordx4 a[128:131], v236, s[16:19], s28 offen offset:0 sc1
    v_mfma_f32_16x16x32_bf16 v[72:75], a[32:35], a[64:67], v[72:75]
    s_mov_b32 exec_lo, 0x00010001
    s_mov_b32 exec_hi, 0x00010001
    ds_write_b128 v210, v[120:123] offset:0
    ds_write_b128 v210, v[124:127] offset:64
    s_mov_b64 exec, -1
    v_mfma_f32_16x16x32_bf16 v[76:79], a[32:35], a[68:71], v[76:79]
    v_mfma_f32_16x16x32_bf16 v[80:83], a[36:39], a[64:67], v[80:83]
    v_mfma_f32_16x16x32_bf16 v[84:87], a[36:39], a[68:71], v[84:87]
    s_waitcnt vmcnt(8)
    s_waitcnt lgkmcnt(0)
    s_barrier
    ds_read_b128 v[20:23], v222 offset:0
    v_mfma_f32_16x16x32_bf16 v[88:91], a[40:43], a[64:67], v[88:91]
    ds_read_b128 v[24:27], v222 offset:64
    v_mfma_f32_16x16x32_bf16 v[92:95], a[40:43], a[68:71], v[92:95]
    ds_read_b128 v[28:31], v222 offset:256
    ds_read_b128 v[32:35], v222 offset:320
    v_mfma_f32_16x16x32_bf16 v[96:99], a[44:47], a[64:67], v[96:99]
    ds_read_b128 v[36:39], v222 offset:128
    v_mfma_f32_16x16x32_bf16 v[100:103], a[44:47], a[68:71], v[100:103]
    ds_read_b128 v[40:43], v222 offset:192
    v_mfma_f32_16x16x32_bf16 v[104:107], a[48:51], a[64:67], v[104:107]
    ds_read_b128 v[44:47], v222 offset:384
    v_mfma_f32_16x16x32_bf16 v[108:111], a[48:51], a[68:71], v[108:111]
    v_mfma_f32_16x16x32_bf16 v[112:115], a[52:55], a[64:67], v[112:115]
    s_add_u32 s28, s28, 40960
    s_cmp_eq_u32 s28, s29
    s_cselect_b32 s28, s1, s28
    v_mfma_f32_16x16x32_bf16 v[116:119], a[52:55], a[68:71], v[116:119]
    s_add_u32 s5, s7, 131072
    s_add_u32 s6, s7, 262144
    v_mov_b32 v2, 163232
    s_cmp_eq_u32 s76, 0
    s_cbranch_scc1 L_noconv
    ds_read_b128 v[160:163], v231 offset:1344
    ds_read2_b32 v[128:129], v230 offset0:240 offset1:241
    ds_read2_b32 v[130:131], v230 offset0:242 offset1:243
    ds_read_b128 v[164:167], v231 offset:2880
    ds_read2_b32 v[132:133], v230 offset0:112 offset1:113
    ds_read2_b32 v[134:135], v230 offset0:114 offset1:115
    ds_read_b128 v[168:171], v231 offset:4416
    ds_read2_b32 v[136:137], v229 offset0:240 offset1:241
    ds_read2_b32 v[138:139], v229 offset0:242 offset1:243
    s_waitcnt lgkmcnt(0)
    v_pk_fma_f32 v[64:65], v[20:21], v[14:15], v[64:65] op_sel:[0,0,0] op_sel_hi:[1,0,1] neg_lo:[1,0,0] neg_hi:[1,0,0]
    s_nop 0
    v_pk_fma_f32 v[66:67], v[22:23], v[14:15], v[66:67] op_sel:[0,0,0] op_sel_hi:[1,0,1] neg_lo:[1,0,0] neg_hi:[1,0,0]
    v_cvt_pk_bf16_f32 v48, v64, v65
    v_cvt_pk_bf16_f32 v49, v66, v67
    v_pk_max_i16 v48, v48, 0
    v_pk_max_i16 v49, v49, 0
    ds_read_b128 v[172:175], v231 offset:5952
    ds_read2_b32 v[140:141], v229 offset0:112 offset1:113
    ds_read2_b32 v[142:143], v229 offset0:114 offset1:115
    v_pk_fma_f32 v[68:69], v[20:21], v[14:15], v[68:69] op_sel:[0,1,0] op_sel_hi:[1,1,1] neg_lo:[1,0,0] neg_hi:[1,0,0]
    v_pk_fma_f32 v[70:71], v[22:23], v[14:15], v[70:71] op_sel:[0,1,0] op_sel_hi:[1,1,1] neg_lo:[1,0,0] neg_hi:[1,0,0]
    v_cvt_pk_bf16_f32 v192, v68, v69
    v_cvt_pk_bf16_f32 v193, v70, v71
    v_pk_max_i16 v192, v192, 0
    v_pk_max_i16 v193, v193, 0
    ds_read_b128 v[176:179], v231 offset:7488
    ds_read2_b32 v[144:145], v228 offset0:240 offset1:241
    ds_read2_b32 v[146:147], v228 offset0:242 offset1:243
    v_pk_fma_f32 v[72:73], v[24:25], v[14:15], v[72:73] op_sel:[0,0,0] op_sel_hi:[1,0,1] neg_lo:[1,0,0] neg_hi:[1,0,0]
    v_pk_fma_f32 v[74:75], v[26:27], v[14:15], v[74:75] op_sel:[0,0,0] op_sel_hi:[1,0,1] neg_lo:[1,0,0] neg_hi:[1,0,0]
    v_cvt_pk_bf16_f32 v50, v72, v73
    v_cvt_pk_bf16_f32 v51, v74, v75
    v_pk_max_i16 v50, v50, 0
    v_pk_max_i16 v51, v51, 0
    buffer_store_dwordx4 v[48:51], v223, s[12:15], s7 offen offset:0 sc1
    ds_read_b128 v[180:183], v231 offset:9024
    ds_read2_b32 v[148:149], v228 offset0:112 offset1:113
    ds_read2_b32 v[150:151], v228 offset0:114 offset1:115
    v_pk_fma_f32 v[76:77], v[24:25], v[14:15], v[76:77] op_sel:[0,1,0] op_sel_hi:[1,1,1] neg_lo:[1,0,0] neg_hi:[1,0,0]
    v_pk_fma_f32 v[78:79], v[26:27], v[14:15], v[78:79] op_sel:[0,1,0] op_sel_hi:[1,1,1] neg_lo:[1,0,0] neg_hi:[1,0,0]
    v_cvt_pk_bf16_f32 v194, v76, v77
    v_cvt_pk_bf16_f32 v195, v78, v79
    v_pk_max_i16 v194, v194, 0
    v_pk_max_i16 v195, v195, 0
    buffer_store_dwordx4 v[192:195], v223, s[12:15], s7 offen offset:1024 sc1
    ds_read_b128 v[184:187], v231 offset:10560
    ds_read2_b32 v[152:153], v227 offset0:240 offset1:241
    ds_read2_b32 v[154:155], v227 offset0:242 offset1:243
    v_pk_fma_f32 v[96:97], v[28:29], v[14:15], v[96:97] op_sel:[0,0,0] op_sel_hi:[1,0,1] neg_lo:[1,0,0] neg_hi:[1,0,0]
    v_pk_fma_f32 v[98:99], v[30:31], v[14:15], v[98:99] op_sel:[0,0,0] op_sel_hi:[1,0,1] neg_lo:[1,0,0] neg_hi:[1,0,0]
    v_cvt_pk_bf16_f32 v56, v96, v97
    v_cvt_pk_bf16_f32 v57, v98, v99
    v_pk_max_i16 v56, v56, 0
    v_pk_max_i16 v57, v57, 0
    ds_read_b128 v[188:191], v231 offset:12096
    ds_read2_b32 v[156:157], v227 offset0:112 offset1:113
    ds_read2_b32 v[158:159], v227 offset0:114 offset1:115
    v_pk_fma_f32 v[100:101], v[28:29], v[14:15], v[100:101] op_sel:[0,1,0] op_sel_hi:[1,1,1] neg_lo:[1,0,0] neg_hi:[1,0,0]
    v_pk_fma_f32 v[102:103], v[30:31], v[14:15], v[102:103] op_sel:[0,1,0] op_sel_hi:[1,1,1] neg_lo:[1,0,0] neg_hi:[1,0,0]
    v_cvt_pk_bf16_f32 v200, v100, v101
    v_cvt_pk_bf16_f32 v201, v102, v103
    v_pk_max_i16 v200, v200, 0
    v_pk_max_i16 v201, v201, 0
    v_mfma_f32_16x16x32_bf16 v[16:19], v[128:131], v[160:163], 0
    ds_read2_b32 v[64:65], v230 offset0:224 offset1:225
    v_mfma_f32_16x16x32_bf16 v[20:23], v[128:131], v[164:167], 0
    ds_read2_b32 v[66:67], v230 offset0:226 offset1:227
    v_fma_f32 v104, -v32, v14, v104
    v_mfma_f32_16x16x32_bf16 v[20:23], v[132:135], v[160:163], v[20:23]
    ds_read2_b32 v[68:69], v230 offset0:96 offset1:97
    v_fma_f32 v105, -v33, v14, v105
    v_mfma_f32_16x16x32_bf16 v[24:27], v[132:135], v[164:167], 0
    ds_read2_b32 v[70:71], v230 offset0:98 offset1:99
    v_fma_f32 v106, -v34, v14, v106
    v_mfma_f32_16x16x32_bf16 v[24:27], v[128:131], v[168:171], v[24:27]
    ds_read_b128 v[120:123], v231 offset:10368
    v_fma_f32 v107, -v35, v14, v107
    v_mfma_f32_16x16x32_bf16 v[24:27], v[136:139], v[160:163], v[24:27]
    ds_read2_b32 v[72:73], v229 offset0:224 offset1:225
    v_fma_f32 v108, -v32, v15, v108
    v_mfma_f32_16x16x32_bf16 v[28:31], v[132:135], v[168:171], 0
    ds_read2_b32 v[74:75], v229 offset0:226 offset1:227
    v_fma_f32 v109, -v33, v15, v109
    v_mfma_f32_16x16x32_bf16 v[28:31], v[136:139], v[164:167], v[28:31]
    ds_read2_b32 v[76:77], v229 offset0:96 offset1:97
    v_fma_f32 v110, -v34, v15, v110
    s_waitcnt lgkmcnt(5)
    s_nop 0
    v_mfma_f32_16x16x32_bf16 v[28:31], v[128:131], v[172:175], v[28:31]
    ds_read2_b32 v[78:79], v229 offset0:98 offset1:99
    v_fma_f32 v111, -v35, v15, v111
    v_mfma_f32_16x16x32_bf16 v[28:31], v[140:143], v[160:163], v[28:31]
    ds_read_b128 v[124:127], v231 offset:11904
    v_cvt_pk_bf16_f32 v58, v104, v105
    v_cvt_pk_bf16_f32 v59, v106, v107
    v_mfma_f32_16x16x32_bf16 v[32:35], v[136:139], v[168:171], 0
    v_pk_max_i16 v58, v58, 0
    v_fma_f32 v80, -v36, v14, v80
    v_pk_max_i16 v59, v59, 0
    v_fma_f32 v81, -v37, v14, v81
    v_mfma_f32_16x16x32_bf16 v[32:35], v[132:135], v[172:175], v[32:35]
    buffer_store_dwordx4 v[56:59], v223, s[12:15], s6 offen offset:0 sc1
    v_cvt_pk_bf16_f32 v202, v108, v109
    v_fma_f32 v82, -v38, v14, v82
    v_cvt_pk_bf16_f32 v203, v110, v111
    v_mfma_f32_16x16x32_bf16 v[32:35], v[140:143], v[164:167], v[32:35]
    v_fma_f32 v83, -v39, v14, v83
    v_pk_max_i16 v202, v202, 0
    v_pk_max_i16 v203, v203, 0
    v_fma_f32 v84, -v36, v15, v84
    v_mfma_f32_16x16x32_bf16 v[32:35], v[128:131], v[176:179], v[32:35]
    buffer_store_dwordx4 v[200:203], v223, s[12:15], s6 offen offset:1024 sc1
    v_fma_f32 v85, -v37, v15, v85
    ds_read_b128 v[96:99], v231 offset:1152
    ds_read_b128 v[100:103], v231 offset:2688
    v_mfma_f32_16x16x32_bf16 v[32:35], v[144:147], v[160:163], v[32:35]
    v_fma_f32 v86, -v38, v15, v86
    ds_read_b128 v[104:107], v231 offset:4224
    v_fma_f32 v87, -v39, v15, v87
    ds_read_b128 v[108:111], v231 offset:5760
    v_mfma_f32_16x16x32_bf16 v[36:39], v[136:139], v[172:175], 0
    v_fma_f32 v88, -v40, v14, v88
    v_cvt_pk_bf16_f32 v52, v80, v81
    v_mfma_f32_16x16x32_bf16 v[36:39], v[140:143], v[168:171], v[36:39]
    v_fma_f32 v89, -v41, v14, v89
    v_cvt_pk_bf16_f32 v53, v82, v83
    v_fma_f32 v90, -v42, v14, v90
    v_mfma_f32_16x16x32_bf16 v[36:39], v[132:135], v[176:179], v[36:39]
    v_pk_max_i16 v52, v52, 0
    v_fma_f32 v91, -v43, v14, v91
    v_pk_max_i16 v53, v53, 0
    v_mfma_f32_16x16x32_bf16 v[36:39], v[144:147], v[164:167], v[36:39]
    v_fma_f32 v92, -v40, v15, v92
    v_cvt_pk_bf16_f32 v196, v84, v85
    v_mfma_f32_16x16x32_bf16 v[36:39], v[128:131], v[180:183], v[36:39]
    v_fma_f32 v93, -v41, v15, v93
    v_cvt_pk_bf16_f32 v197, v86, v87
    v_fma_f32 v94, -v42, v15, v94
    v_mfma_f32_16x16x32_bf16 v[36:39], v[148:151], v[160:163], v[36:39]
    v_pk_max_i16 v196, v196, 0
    v_fma_f32 v95, -v43, v15, v95
    v_pk_max_i16 v197, v197, 0
    v_mfma_f32_16x16x32_bf16 v[40:43], v[140:143], v[172:175], 0
    v_cvt_pk_bf16_f32 v54, v88, v89
    v_cvt_pk_bf16_f32 v55, v90, v91
    v_pk_max_i16 v54, v54, 0
    v_mfma_f32_16x16x32_bf16 v[40:43], v[136:139], v[176:179], v[40:43]
    v_fma_f32 v112, -v44, v14, v112
    v_pk_max_i16 v55, v55, 0
    buffer_store_dwordx4 v[52:55], v223, s[12:15], s5 offen offset:0 sc1
    v_fma_f32 v113, -v45, v14, v113
    v_mfma_f32_16x16x32_bf16 v[40:43], v[144:147], v[168:171], v[40:43]
    v_cvt_pk_bf16_f32 v198, v92, v93
    v_cvt_pk_bf16_f32 v199, v94, v95
    v_fma_f32 v114, -v46, v14, v114
    v_pk_max_i16 v198, v198, 0
    v_mfma_f32_16x16x32_bf16 v[40:43], v[132:135], v[180:183], v[40:43]
    v_pk_max_i16 v199, v199, 0
    v_fma_f32 v115, -v47, v14, v115
    buffer_store_dwordx4 v[196:199], v223, s[12:15], s5 offen offset:1024 sc1
    ds_read2_b32 v[80:81], v228 offset0:224 offset1:225
    v_mfma_f32_16x16x32_bf16 v[40:43], v[148:151], v[164:167], v[40:43]
    v_fma_f32 v116, -v44, v15, v116
    ds_read2_b32 v[82:83], v228 offset0:226 offset1:227
    ds_read2_b32 v[84:85], v228 offset0:96 offset1:97
    v_mfma_f32_16x16x32_bf16 v[40:43], v[128:131], v[184:187], v[40:43]
    v_fma_f32 v117, -v45, v15, v117
    ds_read2_b32 v[86:87], v228 offset0:98 offset1:99
    ds_read2_b32 v[88:89], v227 offset0:224 offset1:225
    v_fma_f32 v118, -v46, v15, v118
    v_mfma_f32_16x16x32_bf16 v[40:43], v[152:155], v[160:163], v[40:43]
    ds_read2_b32 v[90:91], v227 offset0:226 offset1:227
    ds_read2_b32 v[92:93], v227 offset0:96 offset1:97
    v_fma_f32 v119, -v47, v15, v119
    ds_read2_b32 v[94:95], v227 offset0:98 offset1:99
    v_mfma_f32_16x16x32_bf16 v[44:47], v[140:143], v[176:179], 0
    v_cvt_pk_bf16_f32 v60, v112, v113
    v_cvt_pk_bf16_f32 v61, v114, v115
    v_mfma_f32_16x16x32_bf16 v[44:47], v[144:147], v[172:175], v[44:47]
    v_pk_max_i16 v60, v60, 0
    v_mfma_f32_16x16x32_bf16 v[44:47], v[136:139], v[180:183], v[44:47]
    v_pk_max_i16 v61, v61, 0
    v_mfma_f32_16x16x32_bf16 v[44:47], v[148:151], v[168:171], v[44:47]
    v_cvt_pk_bf16_f32 v62, v116, v117
    v_cvt_pk_bf16_f32 v63, v118, v119
    v_mfma_f32_16x16x32_bf16 v[44:47], v[132:135], v[184:187], v[44:47]
    v_pk_max_i16 v62, v62, 0
    v_mfma_f32_16x16x32_bf16 v[44:47], v[152:155], v[164:167], v[44:47]
    v_pk_max_i16 v63, v63, 0
    v_mfma_f32_16x16x32_bf16 v[44:47], v[128:131], v[188:191], v[44:47]
    s_nop 1
    v_permlane16_swap_b32 v60, v62
    v_permlane16_swap_b32 v61, v63
    s_nop 0
    buffer_store_dwordx4 v[60:63], v214, s[12:15], s8 offen sc1
    ds_read_b128 v[112:115], v231 offset:7296
    v_mfma_f32_16x16x32_bf16 v[44:47], v[156:159], v[160:163], v[44:47]
    ds_read_b128 v[116:119], v231 offset:8832
    s_waitcnt lgkmcnt(2)
    v_mfma_f32_16x16x32_bf16 v[16:19], v[64:67], v[96:99], v[16:19]
    ds_read_b128 v[160:163], v231 offset:960
    v_mfma_f32_16x16x32_bf16 v[20:23], v[64:67], v[100:103], v[20:23]
    s_nop 0
    ds_read2_b32 v[128:129], v230 offset0:208 offset1:209
    v_mfma_f32_16x16x32_bf16 v[20:23], v[68:71], v[96:99], v[20:23]
    ds_read2_b32 v[130:131], v230 offset0:210 offset1:211
    v_mfma_f32_16x16x32_bf16 v[24:27], v[68:71], v[100:103], v[24:27]
    ds_read_b128 v[164:167], v231 offset:2496
    v_mfma_f32_16x16x32_bf16 v[24:27], v[64:67], v[104:107], v[24:27]
    v_mfma_f32_16x16x32_bf16 v[24:27], v[72:75], v[96:99], v[24:27]
    ds_read2_b32 v[132:133], v230 offset0:80 offset1:81
    v_mfma_f32_16x16x32_bf16 v[28:31], v[68:71], v[104:107], v[28:31]
    ds_read2_b32 v[134:135], v230 offset0:82 offset1:83
    v_mfma_f32_16x16x32_bf16 v[28:31], v[72:75], v[100:103], v[28:31]
    ds_read_b128 v[168:171], v231 offset:4032
    v_mfma_f32_16x16x32_bf16 v[32:35], v[72:75], v[104:107], v[32:35]
    v_mfma_f32_16x16x32_bf16 v[28:31], v[64:67], v[108:111], v[28:31]
    ds_read2_b32 v[136:137], v229 offset0:208 offset1:209
    v_mfma_f32_16x16x32_bf16 v[28:31], v[76:79], v[96:99], v[28:31]
    ds_read2_b32 v[138:139], v229 offset0:210 offset1:211
    v_mfma_f32_16x16x32_bf16 v[32:35], v[68:71], v[108:111], v[32:35]
    ds_read_b128 v[172:175], v231 offset:5568
    v_mfma_f32_16x16x32_bf16 v[32:35], v[76:79], v[100:103], v[32:35]
    v_mfma_f32_16x16x32_bf16 v[36:39], v[72:75], v[108:111], v[36:39]
    ds_read2_b32 v[140:141], v229 offset0:80 offset1:81
    v_mfma_f32_16x16x32_bf16 v[36:39], v[76:79], v[104:107], v[36:39]
    ds_read2_b32 v[142:143], v229 offset0:82 offset1:83
    v_mfma_f32_16x16x32_bf16 v[40:43], v[76:79], v[108:111], v[40:43]
    ds_read_b128 v[176:179], v231 offset:7104
    s_waitcnt lgkmcnt(4)
    v_mfma_f32_16x16x32_bf16 v[32:35], v[64:67], v[112:115], v[32:35]
    s_nop 0
    ds_read2_b32 v[144:145], v228 offset0:208 offset1:209
    v_mfma_f32_16x16x32_bf16 v[32:35], v[80:83], v[96:99], v[32:35]
    v_mfma_f32_16x16x32_bf16 v[36:39], v[68:71], v[112:115], v[36:39]
    ds_read2_b32 v[146:147], v228 offset0:210 offset1:211
    v_mfma_f32_16x16x32_bf16 v[36:39], v[80:83], v[100:103], v[36:39]
    ds_read_b128 v[180:183], v231 offset:8640
    v_mfma_f32_16x16x32_bf16 v[40:43], v[72:75], v[112:115], v[40:43]
    ds_read2_b32 v[148:149], v228 offset0:80 offset1:81
    v_mfma_f32_16x16x32_bf16 v[40:43], v[80:83], v[104:107], v[40:43]
    v_mfma_f32_16x16x32_bf16 v[44:47], v[76:79], v[112:115], v[44:47]
    ds_read2_b32 v[150:151], v228 offset0:82 offset1:83
    v_mfma_f32_16x16x32_bf16 v[44:47], v[80:83], v[108:111], v[44:47]
    ds_read_b128 v[184:187], v231 offset:10176
    v_mfma_f32_16x16x32_bf16 v[36:39], v[64:67], v[116:119], v[36:39]
    ds_read2_b32 v[152:153], v227 offset0:208 offset1:209
    v_mfma_f32_16x16x32_bf16 v[36:39], v[84:87], v[96:99], v[36:39]
    v_mfma_f32_16x16x32_bf16 v[40:43], v[68:71], v[116:119], v[40:43]
    ds_read2_b32 v[154:155], v227 offset0:210 offset1:211
    v_mfma_f32_16x16x32_bf16 v[40:43], v[84:87], v[100:103], v[40:43]
    ds_read_b128 v[188:191], v231 offset:11712
    v_mfma_f32_16x16x32_bf16 v[44:47], v[72:75], v[116:119], v[44:47]
    ds_read2_b32 v[156:157], v227 offset0:80 offset1:81
    v_mfma_f32_16x16x32_bf16 v[44:47], v[84:87], v[104:107], v[44:47]
    v_mfma_f32_16x16x32_bf16 v[40:43], v[64:67], v[120:123], v[40:43]
    ds_read2_b32 v[158:159], v227 offset0:82 offset1:83
    v_mfma_f32_16x16x32_bf16 v[40:43], v[88:91], v[96:99], v[40:43]
    v_mfma_f32_16x16x32_bf16 v[44:47], v[68:71], v[120:123], v[44:47]
    v_mfma_f32_16x16x32_bf16 v[44:47], v[88:91], v[100:103], v[44:47]
    v_mfma_f32_16x16x32_bf16 v[44:47], v[64:67], v[124:127], v[44:47]
    v_mfma_f32_16x16x32_bf16 v[44:47], v[92:95], v[96:99], v[44:47]
    v_mfma_f32_16x16x32_bf16 v[16:19], v[128:131], v[160:163], v[16:19]
    ds_read_b128 v[96:99], v231 offset:768
    v_mfma_f32_16x16x32_bf16 v[20:23], v[128:131], v[164:167], v[20:23]
    ds_read2_b32 v[64:65], v230 offset0:192 offset1:193
    v_mfma_f32_16x16x32_bf16 v[20:23], v[132:135], v[160:163], v[20:23]
    ds_read2_b32 v[66:67], v230 offset0:194 offset1:195
    v_mfma_f32_16x16x32_bf16 v[24:27], v[132:135], v[164:167], v[24:27]
    ds_read_b128 v[100:103], v231 offset:2304
    v_mfma_f32_16x16x32_bf16 v[24:27], v[128:131], v[168:171], v[24:27]
    v_mfma_f32_16x16x32_bf16 v[24:27], v[136:139], v[160:163], v[24:27]
    ds_read2_b32 v[68:69], v230 offset0:64 offset1:65
    v_mfma_f32_16x16x32_bf16 v[28:31], v[132:135], v[168:171], v[28:31]
    ds_read2_b32 v[70:71], v230 offset0:66 offset1:67
    v_mfma_f32_16x16x32_bf16 v[28:31], v[136:139], v[164:167], v[28:31]
    ds_read_b128 v[104:107], v231 offset:3840
    v_mfma_f32_16x16x32_bf16 v[32:35], v[136:139], v[168:171], v[32:35]
    s_waitcnt lgkmcnt(3)
    v_mfma_f32_16x16x32_bf16 v[28:31], v[128:131], v[172:175], v[28:31]
    s_nop 0
    ds_read2_b32 v[72:73], v229 offset0:192 offset1:193
    v_mfma_f32_16x16x32_bf16 v[28:31], v[140:143], v[160:163], v[28:31]
    ds_read2_b32 v[74:75], v229 offset0:194 offset1:195
    v_mfma_f32_16x16x32_bf16 v[32:35], v[132:135], v[172:175], v[32:35]
    ds_read_b128 v[108:111], v231 offset:5376
    v_mfma_f32_16x16x32_bf16 v[32:35], v[140:143], v[164:167], v[32:35]
    v_mfma_f32_16x16x32_bf16 v[36:39], v[136:139], v[172:175], v[36:39]
    ds_read2_b32 v[76:77], v229 offset0:64 offset1:65
    v_mfma_f32_16x16x32_bf16 v[36:39], v[140:143], v[168:171], v[36:39]
    ds_read2_b32 v[78:79], v229 offset0:66 offset1:67
    v_mfma_f32_16x16x32_bf16 v[40:43], v[140:143], v[172:175], v[40:43]
    ds_read_b128 v[112:115], v231 offset:6912
    v_mfma_f32_16x16x32_bf16 v[32:35], v[128:131], v[176:179], v[32:35]
    s_waitcnt vmcnt(0)
    v_mov_b32 v4, 0
    v_mov_b32 v5, s58
    s_mov_b64 exec, 1
    buffer_store_dword v5, v4, s[44:47], s9 offen sc1
    s_mov_b64 exec, -1
    ds_read2_b32 v[80:81], v228 offset0:192 offset1:193
    v_mfma_f32_16x16x32_bf16 v[32:35], v[144:147], v[160:163], v[32:35]
    v_mfma_f32_16x16x32_bf16 v[36:39], v[132:135], v[176:179], v[36:39]
    s_nop 0
    ds_read2_b32 v[82:83], v228 offset0:194 offset1:195
    v_mfma_f32_16x16x32_bf16 v[36:39], v[144:147], v[164:167], v[36:39]
    ds_read_b128 v[116:119], v231 offset:8448
    v_mfma_f32_16x16x32_bf16 v[40:43], v[136:139], v[176:179], v[40:43]
    ds_read2_b32 v[84:85], v228 offset0:64 offset1:65
    v_mfma_f32_16x16x32_bf16 v[40:43], v[144:147], v[168:171], v[40:43]
    v_mfma_f32_16x16x32_bf16 v[44:47], v[140:143], v[176:179], v[44:47]
    ds_read2_b32 v[86:87], v228 offset0:66 offset1:67
    v_mfma_f32_16x16x32_bf16 v[44:47], v[144:147], v[172:175], v[44:47]
    ds_read_b128 v[120:123], v231 offset:9984
    v_mfma_f32_16x16x32_bf16 v[36:39], v[128:131], v[180:183], v[36:39]
    ds_read2_b32 v[88:89], v227 offset0:192 offset1:193
    v_mfma_f32_16x16x32_bf16 v[36:39], v[148:151], v[160:163], v[36:39]
    v_mfma_f32_16x16x32_bf16 v[40:43], v[132:135], v[180:183], v[40:43]
    ds_read2_b32 v[90:91], v227 offset0:194 offset1:195
    v_mfma_f32_16x16x32_bf16 v[40:43], v[148:151], v[164:167], v[40:43]
    ds_read_b128 v[124:127], v231 offset:11520
    v_mfma_f32_16x16x32_bf16 v[44:47], v[136:139], v[180:183], v[44:47]
    ds_read2_b32 v[92:93], v227 offset0:64 offset1:65
    v_mfma_f32_16x16x32_bf16 v[44:47], v[148:151], v[168:171], v[44:47]
    v_mfma_f32_16x16x32_bf16 v[40:43], v[128:131], v[184:187], v[40:43]
    ds_read2_b32 v[94:95], v227 offset0:66 offset1:67
    v_mfma_f32_16x16x32_bf16 v[40:43], v[152:155], v[160:163], v[40:43]
    v_mfma_f32_16x16x32_bf16 v[44:47], v[132:135], v[184:187], v[44:47]
    v_mfma_f32_16x16x32_bf16 v[44:47], v[152:155], v[164:167], v[44:47]
    v_mfma_f32_16x16x32_bf16 v[44:47], v[128:131], v[188:191], v[44:47]
    v_mfma_f32_16x16x32_bf16 v[44:47], v[156:159], v[160:163], v[44:47]
    v_mfma_f32_16x16x32_bf16 v[16:19], v[64:67], v[96:99], v[16:19]
    ds_read_b128 v[160:163], v231 offset:576
    v_mfma_f32_16x16x32_bf16 v[20:23], v[64:67], v[100:103], v[20:23]
    ds_read2_b32 v[128:129], v230 offset0:176 offset1:177
    s_waitcnt lgkmcnt(2)
    s_nop 0
    v_mfma_f32_16x16x32_bf16 v[20:23], v[68:71], v[96:99], v[20:23]
    ds_read2_b32 v[130:131], v230 offset0:178 offset1:179
    v_mfma_f32_16x16x32_bf16 v[24:27], v[68:71], v[100:103], v[24:27]
    ds_read_b128 v[164:167], v231 offset:2112
    v_mfma_f32_16x16x32_bf16 v[24:27], v[64:67], v[104:107], v[24:27]
    v_mfma_f32_16x16x32_bf16 v[24:27], v[72:75], v[96:99], v[24:27]
    ds_read2_b32 v[132:133], v230 offset0:48 offset1:49
    v_mfma_f32_16x16x32_bf16 v[28:31], v[68:71], v[104:107], v[28:31]
    ds_read2_b32 v[134:135], v230 offset0:50 offset1:51
    v_mfma_f32_16x16x32_bf16 v[28:31], v[72:75], v[100:103], v[28:31]
    ds_read_b128 v[168:171], v231 offset:3648
    v_mfma_f32_16x16x32_bf16 v[32:35], v[72:75], v[104:107], v[32:35]
    v_mfma_f32_16x16x32_bf16 v[28:31], v[64:67], v[108:111], v[28:31]
    ds_read2_b32 v[136:137], v229 offset0:176 offset1:177
    v_mfma_f32_16x16x32_bf16 v[28:31], v[76:79], v[96:99], v[28:31]
    ds_read2_b32 v[138:139], v229 offset0:178 offset1:179
    v_mfma_f32_16x16x32_bf16 v[32:35], v[68:71], v[108:111], v[32:35]
    ds_read_b128 v[172:175], v231 offset:5184
    v_mfma_f32_16x16x32_bf16 v[32:35], v[76:79], v[100:103], v[32:35]
    v_mfma_f32_16x16x32_bf16 v[36:39], v[72:75], v[108:111], v[36:39]
    ds_read2_b32 v[140:141], v229 offset0:48 offset1:49
    v_mfma_f32_16x16x32_bf16 v[36:39], v[76:79], v[104:107], v[36:39]
    ds_read2_b32 v[142:143], v229 offset0:50 offset1:51
    v_mfma_f32_16x16x32_bf16 v[40:43], v[76:79], v[108:111], v[40:43]
    ds_read_b128 v[176:179], v231 offset:6720
    v_mfma_f32_16x16x32_bf16 v[32:35], v[64:67], v[112:115], v[32:35]
    ds_read2_b32 v[144:145], v228 offset0:176 offset1:177
    v_mfma_f32_16x16x32_bf16 v[32:35], v[80:83], v[96:99], v[32:35]
    v_mfma_f32_16x16x32_bf16 v[36:39], v[68:71], v[112:115], v[36:39]
    ds_read2_b32 v[146:147], v228 offset0:178 offset1:179
    v_mfma_f32_16x16x32_bf16 v[36:39], v[80:83], v[100:103], v[36:39]
    ds_read_b128 v[180:183], v231 offset:8256
    v_mfma_f32_16x16x32_bf16 v[40:43], v[72:75], v[112:115], v[40:43]
    ds_read2_b32 v[148:149], v228 offset0:48 offset1:49
    v_mfma_f32_16x16x32_bf16 v[40:43], v[80:83], v[104:107], v[40:43]
    v_mfma_f32_16x16x32_bf16 v[44:47], v[76:79], v[112:115], v[44:47]
    ds_read2_b32 v[150:151], v228 offset0:50 offset1:51
    v_mfma_f32_16x16x32_bf16 v[44:47], v[80:83], v[108:111], v[44:47]
    ds_read_b128 v[184:187], v231 offset:9792
    v_mfma_f32_16x16x32_bf16 v[36:39], v[64:67], v[116:119], v[36:39]
    ds_read2_b32 v[152:153], v227 offset0:176 offset1:177
    v_mfma_f32_16x16x32_bf16 v[36:39], v[84:87], v[96:99], v[36:39]
    v_mfma_f32_16x16x32_bf16 v[40:43], v[68:71], v[116:119], v[40:43]
    ds_read2_b32 v[154:155], v227 offset0:178 offset1:179
    v_mfma_f32_16x16x32_bf16 v[40:43], v[84:87], v[100:103], v[40:43]
    ds_read_b128 v[188:191], v231 offset:11328
    v_mfma_f32_16x16x32_bf16 v[44:47], v[72:75], v[116:119], v[44:47]
    ds_read2_b32 v[156:157], v227 offset0:48 offset1:49
    v_mfma_f32_16x16x32_bf16 v[44:47], v[84:87], v[104:107], v[44:47]
    v_mfma_f32_16x16x32_bf16 v[40:43], v[64:67], v[120:123], v[40:43]
    ds_read2_b32 v[158:159], v227 offset0:50 offset1:51
    v_mfma_f32_16x16x32_bf16 v[40:43], v[88:91], v[96:99], v[40:43]
    v_mfma_f32_16x16x32_bf16 v[44:47], v[68:71], v[120:123], v[44:47]
    v_mfma_f32_16x16x32_bf16 v[44:47], v[88:91], v[100:103], v[44:47]
    v_mfma_f32_16x16x32_bf16 v[44:47], v[64:67], v[124:127], v[44:47]
    v_mfma_f32_16x16x32_bf16 v[44:47], v[92:95], v[96:99], v[44:47]
    s_waitcnt lgkmcnt(0)
    v_mfma_f32_16x16x32_bf16 v[16:19], v[128:131], v[160:163], v[16:19]
    ds_read_b128 v[96:99], v231 offset:384
    v_mfma_f32_16x16x32_bf16 v[20:23], v[128:131], v[164:167], v[20:23]
    s_nop 0
    ds_read2_b32 v[64:65], v230 offset0:160 offset1:161
    v_mfma_f32_16x16x32_bf16 v[20:23], v[132:135], v[160:163], v[20:23]
    ds_read2_b32 v[66:67], v230 offset0:162 offset1:163
    v_mfma_f32_16x16x32_bf16 v[24:27], v[132:135], v[164:167], v[24:27]
    ds_read_b128 v[100:103], v231 offset:1920
    v_mfma_f32_16x16x32_bf16 v[24:27], v[128:131], v[168:171], v[24:27]
    v_mfma_f32_16x16x32_bf16 v[24:27], v[136:139], v[160:163], v[24:27]
    ds_read2_b32 v[68:69], v230 offset0:32 offset1:33
    v_mfma_f32_16x16x32_bf16 v[28:31], v[132:135], v[168:171], v[28:31]
    ds_read2_b32 v[70:71], v230 offset0:34 offset1:35
    v_mfma_f32_16x16x32_bf16 v[28:31], v[136:139], v[164:167], v[28:31]
    ds_read_b128 v[104:107], v231 offset:3456
    v_mfma_f32_16x16x32_bf16 v[32:35], v[136:139], v[168:171], v[32:35]
    v_mfma_f32_16x16x32_bf16 v[28:31], v[128:131], v[172:175], v[28:31]
    ds_read2_b32 v[72:73], v229 offset0:160 offset1:161
    v_mfma_f32_16x16x32_bf16 v[28:31], v[140:143], v[160:163], v[28:31]
    ds_read2_b32 v[74:75], v229 offset0:162 offset1:163
    v_mfma_f32_16x16x32_bf16 v[32:35], v[132:135], v[172:175], v[32:35]
    ds_read_b128 v[108:111], v231 offset:4992
    v_mfma_f32_16x16x32_bf16 v[32:35], v[140:143], v[164:167], v[32:35]
    v_mfma_f32_16x16x32_bf16 v[36:39], v[136:139], v[172:175], v[36:39]
    ds_read2_b32 v[76:77], v229 offset0:32 offset1:33
    v_mfma_f32_16x16x32_bf16 v[36:39], v[140:143], v[168:171], v[36:39]
    ds_read2_b32 v[78:79], v229 offset0:34 offset1:35
    v_mfma_f32_16x16x32_bf16 v[40:43], v[140:143], v[172:175], v[40:43]
    ds_read_b128 v[112:115], v231 offset:6528
    v_mfma_f32_16x16x32_bf16 v[32:35], v[128:131], v[176:179], v[32:35]
    ds_read2_b32 v[80:81], v228 offset0:160 offset1:161
    v_mfma_f32_16x16x32_bf16 v[32:35], v[144:147], v[160:163], v[32:35]
    v_mfma_f32_16x16x32_bf16 v[36:39], v[132:135], v[176:179], v[36:39]
    ds_read2_b32 v[82:83], v228 offset0:162 offset1:163
    v_mfma_f32_16x16x32_bf16 v[36:39], v[144:147], v[164:167], v[36:39]
    ds_read_b128 v[116:119], v231 offset:8064
    v_mfma_f32_16x16x32_bf16 v[40:43], v[136:139], v[176:179], v[40:43]
    buffer_load_dwordx4 a[132:135], v223, s[16:19], s28 offen offset:0 sc1
    ds_read2_b32 v[84:85], v228 offset0:32 offset1:33
    v_mfma_f32_16x16x32_bf16 v[40:43], v[144:147], v[168:171], v[40:43]
    v_mfma_f32_16x16x32_bf16 v[44:47], v[140:143], v[176:179], v[44:47]
    ds_read2_b32 v[86:87], v228 offset0:34 offset1:35
    v_mfma_f32_16x16x32_bf16 v[44:47], v[144:147], v[172:175], v[44:47]
    ds_read_b128 v[120:123], v231 offset:9600
    v_mfma_f32_16x16x32_bf16 v[36:39], v[128:131], v[180:183], v[36:39]
    buffer_load_dwordx4 a[136:139], v223, s[16:19], s28 offen offset:1024 sc1
    ds_read2_b32 v[88:89], v227 offset0:160 offset1:161
    v_mfma_f32_16x16x32_bf16 v[36:39], v[148:151], v[160:163], v[36:39]
    v_mfma_f32_16x16x32_bf16 v[40:43], v[132:135], v[180:183], v[40:43]
    ds_read2_b32 v[90:91], v227 offset0:162 offset1:163
    v_mfma_f32_16x16x32_bf16 v[40:43], v[148:151], v[164:167], v[40:43]
    ds_read_b128 v[124:127], v231 offset:11136
    v_mfma_f32_16x16x32_bf16 v[44:47], v[136:139], v[180:183], v[44:47]
    buffer_load_dwordx4 a[140:143], v223, s[16:19], s28 offen offset:2048 sc1
    ds_read2_b32 v[92:93], v227 offset0:32 offset1:33
    v_mfma_f32_16x16x32_bf16 v[44:47], v[148:151], v[168:171], v[44:47]
    v_mfma_f32_16x16x32_bf16 v[40:43], v[128:131], v[184:187], v[40:43]
    ds_read2_b32 v[94:95], v227 offset0:34 offset1:35
    v_mfma_f32_16x16x32_bf16 v[40:43], v[152:155], v[160:163], v[40:43]
    v_mfma_f32_16x16x32_bf16 v[44:47], v[132:135], v[184:187], v[44:47]
    buffer_load_dwordx4 a[144:147], v223, s[16:19], s28 offen offset:3072 sc1
    v_mfma_f32_16x16x32_bf16 v[44:47], v[152:155], v[164:167], v[44:47]
    v_mfma_f32_16x16x32_bf16 v[44:47], v[128:131], v[188:191], v[44:47]
    v_mfma_f32_16x16x32_bf16 v[44:47], v[156:159], v[160:163], v[44:47]
    s_waitcnt lgkmcnt(0)
    v_mfma_f32_16x16x32_bf16 v[16:19], v[64:67], v[96:99], v[16:19]
    ds_read_b128 v[160:163], v231 offset:192
    s_nop 0
    buffer_load_dwordx4 a[148:151], v236, s[16:19], s28 offen offset:0 sc1
    v_mfma_f32_16x16x32_bf16 v[20:23], v[64:67], v[100:103], v[20:23]
    ds_read2_b32 v[128:129], v230 offset0:144 offset1:145
    v_mfma_f32_16x16x32_bf16 v[20:23], v[68:71], v[96:99], v[20:23]
    ds_read2_b32 v[130:131], v230 offset0:146 offset1:147
    v_mfma_f32_16x16x32_bf16 v[24:27], v[68:71], v[100:103], v[24:27]
    ds_read_b128 v[164:167], v231 offset:1728
    v_mfma_f32_16x16x32_bf16 v[24:27], v[64:67], v[104:107], v[24:27]
    v_mfma_f32_16x16x32_bf16 v[24:27], v[72:75], v[96:99], v[24:27]
    s_add_u32 s28, s28, 40960
    s_cmp_eq_u32 s28, s29
    s_cselect_b32 s28, s1, s28
    ds_read2_b32 v[132:133], v230 offset0:16 offset1:17
    v_mfma_f32_16x16x32_bf16 v[28:31], v[68:71], v[104:107], v[28:31]
    ds_read2_b32 v[134:135], v230 offset0:18 offset1:19
    v_mfma_f32_16x16x32_bf16 v[28:31], v[72:75], v[100:103], v[28:31]
    ds_read_b128 v[168:171], v231 offset:3264
    v_mfma_f32_16x16x32_bf16 v[32:35], v[72:75], v[104:107], v[32:35]
    v_mfma_f32_16x16x32_bf16 v[28:31], v[64:67], v[108:111], v[28:31]
    ds_read2_b32 v[136:137], v229 offset0:144 offset1:145
    buffer_load_dwordx4 a[152:155], v223, s[16:19], s28 offen offset:0 sc1
    v_mfma_f32_16x16x32_bf16 v[28:31], v[76:79], v[96:99], v[28:31]
    ds_read2_b32 v[138:139], v229 offset0:146 offset1:147
    v_mfma_f32_16x16x32_bf16 v[32:35], v[68:71], v[108:111], v[32:35]
    ds_read_b128 v[172:175], v231 offset:4800
    v_mfma_f32_16x16x32_bf16 v[32:35], v[76:79], v[100:103], v[32:35]
    v_mfma_f32_16x16x32_bf16 v[36:39], v[72:75], v[108:111], v[36:39]
    ds_read2_b32 v[140:141], v229 offset0:16 offset1:17
    buffer_load_dwordx4 a[156:159], v223, s[16:19], s28 offen offset:1024 sc1
    v_mfma_f32_16x16x32_bf16 v[36:39], v[76:79], v[104:107], v[36:39]
    ds_read2_b32 v[142:143], v229 offset0:18 offset1:19
    v_mfma_f32_16x16x32_bf16 v[40:43], v[76:79], v[108:111], v[40:43]
    ds_read_b128 v[176:179], v231 offset:6336
    v_mfma_f32_16x16x32_bf16 v[32:35], v[64:67], v[112:115], v[32:35]
    ds_read2_b32 v[144:145], v228 offset0:144 offset1:145
    v_mfma_f32_16x16x32_bf16 v[32:35], v[80:83], v[96:99], v[32:35]
    buffer_load_dwordx4 a[160:163], v223, s[16:19], s28 offen offset:2048 sc1
    v_mfma_f32_16x16x32_bf16 v[36:39], v[68:71], v[112:115], v[36:39]
    ds_read2_b32 v[146:147], v228 offset0:146 offset1:147
    v_mfma_f32_16x16x32_bf16 v[36:39], v[80:83], v[100:103], v[36:39]
    ds_read_b128 v[180:183], v231 offset:7872
    v_mfma_f32_16x16x32_bf16 v[40:43], v[72:75], v[112:115], v[40:43]
    ds_read2_b32 v[148:149], v228 offset0:16 offset1:17
    v_mfma_f32_16x16x32_bf16 v[40:43], v[80:83], v[104:107], v[40:43]
    v_mfma_f32_16x16x32_bf16 v[44:47], v[76:79], v[112:115], v[44:47]
    buffer_load_dwordx4 a[164:167], v223, s[16:19], s28 offen offset:3072 sc1
    ds_read2_b32 v[150:151], v228 offset0:18 offset1:19
    v_mfma_f32_16x16x32_bf16 v[44:47], v[80:83], v[108:111], v[44:47]
    ds_read_b128 v[184:187], v231 offset:9408
    v_mfma_f32_16x16x32_bf16 v[36:39], v[64:67], v[116:119], v[36:39]
    ds_read2_b32 v[152:153], v227 offset0:144 offset1:145
    v_mfma_f32_16x16x32_bf16 v[36:39], v[84:87], v[96:99], v[36:39]
    v_mfma_f32_16x16x32_bf16 v[40:43], v[68:71], v[116:119], v[40:43]
    ds_read2_b32 v[154:155], v227 offset0:146 offset1:147
    buffer_load_dwordx4 a[168:171], v236, s[16:19], s28 offen offset:0 sc1
    v_mfma_f32_16x16x32_bf16 v[40:43], v[84:87], v[100:103], v[40:43]
    ds_read_b128 v[188:191], v231 offset:10944
    v_mfma_f32_16x16x32_bf16 v[44:47], v[72:75], v[116:119], v[44:47]
    ds_read2_b32 v[156:157], v227 offset0:16 offset1:17
    v_mfma_f32_16x16x32_bf16 v[44:47], v[84:87], v[104:107], v[44:47]
    v_mfma_f32_16x16x32_bf16 v[40:43], v[64:67], v[120:123], v[40:43]
    ds_read2_b32 v[158:159], v227 offset0:18 offset1:19
    s_add_u32 s28, s28, 40960
    s_cmp_eq_u32 s28, s29
    s_cselect_b32 s28, s1, s28
    v_mfma_f32_16x16x32_bf16 v[40:43], v[88:91], v[96:99], v[40:43]
    v_mfma_f32_16x16x32_bf16 v[44:47], v[68:71], v[120:123], v[44:47]
    v_mfma_f32_16x16x32_bf16 v[44:47], v[88:91], v[100:103], v[44:47]
    v_mfma_f32_16x16x32_bf16 v[44:47], v[64:67], v[124:127], v[44:47]
    buffer_load_dwordx4 a[172:175], v223, s[16:19], s28 offen offset:0 sc1
    v_mfma_f32_16x16x32_bf16 v[44:47], v[92:95], v[96:99], v[44:47]
    s_waitcnt lgkmcnt(0)
    v_mfma_f32_16x16x32_bf16 v[16:19], v[128:131], v[160:163], v[16:19]
    ds_read_b128 v[96:99], v231 offset:0
    s_nop 0
    v_mfma_f32_16x16x32_bf16 v[20:23], v[128:131], v[164:167], v[20:23]
    ds_read2_b32 v[64:65], v230 offset0:128 offset1:129
    v_mfma_f32_16x16x32_bf16 v[20:23], v[132:135], v[160:163], v[20:23]
    ds_read2_b32 v[66:67], v230 offset0:130 offset1:131
    v_mfma_f32_16x16x32_bf16 v[24:27], v[132:135], v[164:167], v[24:27]
    buffer_load_dwordx4 a[176:179], v223, s[16:19], s28 offen offset:1024 sc1
    ds_read_b128 v[100:103], v231 offset:1536
    v_mfma_f32_16x16x32_bf16 v[24:27], v[128:131], v[168:171], v[24:27]
    v_mfma_f32_16x16x32_bf16 v[24:27], v[136:139], v[160:163], v[24:27]
    ds_read2_b32 v[68:69], v230 offset0:0 offset1:1
    v_mfma_f32_16x16x32_bf16 v[28:31], v[132:135], v[168:171], v[28:31]
    ds_read2_b32 v[70:71], v230 offset0:2 offset1:3
    v_mfma_f32_16x16x32_bf16 v[28:31], v[136:139], v[164:167], v[28:31]
    buffer_load_dwordx4 a[180:183], v223, s[16:19], s28 offen offset:2048 sc1
    ds_read_b128 v[104:107], v231 offset:3072
    v_mfma_f32_16x16x32_bf16 v[32:35], v[136:139], v[168:171], v[32:35]
    v_mfma_f32_16x16x32_bf16 v[28:31], v[128:131], v[172:175], v[28:31]
    ds_read2_b32 v[72:73], v229 offset0:128 offset1:129
    v_mfma_f32_16x16x32_bf16 v[28:31], v[140:143], v[160:163], v[28:31]
    ds_read2_b32 v[74:75], v229 offset0:130 offset1:131
    v_mfma_f32_16x16x32_bf16 v[32:35], v[132:135], v[172:175], v[32:35]
    buffer_load_dwordx4 a[184:187], v223, s[16:19], s28 offen offset:3072 sc1
    ds_read_b128 v[108:111], v231 offset:4608
    v_mfma_f32_16x16x32_bf16 v[32:35], v[140:143], v[164:167], v[32:35]
    v_mfma_f32_16x16x32_bf16 v[36:39], v[136:139], v[172:175], v[36:39]
    ds_read2_b32 v[76:77], v229 offset0:0 offset1:1
    v_mfma_f32_16x16x32_bf16 v[36:39], v[140:143], v[168:171], v[36:39]
    ds_read2_b32 v[78:79], v229 offset0:2 offset1:3
    v_mfma_f32_16x16x32_bf16 v[40:43], v[140:143], v[172:175], v[40:43]
    ds_read_b128 v[112:115], v231 offset:6144
    buffer_load_dwordx4 a[188:191], v236, s[16:19], s28 offen offset:0 sc1
    v_mfma_f32_16x16x32_bf16 v[32:35], v[128:131], v[176:179], v[32:35]
    ds_read2_b32 v[80:81], v228 offset0:128 offset1:129
    v_mfma_f32_16x16x32_bf16 v[32:35], v[144:147], v[160:163], v[32:35]
    v_mfma_f32_16x16x32_bf16 v[36:39], v[132:135], v[176:179], v[36:39]
    ds_read2_b32 v[82:83], v228 offset0:130 offset1:131
    v_mfma_f32_16x16x32_bf16 v[36:39], v[144:147], v[164:167], v[36:39]
    ds_read_b128 v[116:119], v231 offset:7680
    v_mfma_f32_16x16x32_bf16 v[40:43], v[136:139], v[176:179], v[40:43]
    s_add_u32 s28, s28, 40960
    s_cmp_eq_u32 s28, s29
    s_cselect_b32 s28, s1, s28
    ds_read2_b32 v[84:85], v228 offset0:0 offset1:1
    v_mfma_f32_16x16x32_bf16 v[40:43], v[144:147], v[168:171], v[40:43]
    v_mfma_f32_16x16x32_bf16 v[44:47], v[140:143], v[176:179], v[44:47]
    ds_read2_b32 v[86:87], v228 offset0:2 offset1:3
    v_mfma_f32_16x16x32_bf16 v[44:47], v[144:147], v[172:175], v[44:47]
    ds_read_b128 v[120:123], v231 offset:9216
    v_mfma_f32_16x16x32_bf16 v[36:39], v[128:131], v[180:183], v[36:39]
    buffer_load_dwordx4 a[192:195], v223, s[16:19], s28 offen offset:0 sc1
    ds_read2_b32 v[88:89], v227 offset0:128 offset1:129
    v_mfma_f32_16x16x32_bf16 v[36:39], v[148:151], v[160:163], v[36:39]
    v_mfma_f32_16x16x32_bf16 v[40:43], v[132:135], v[180:183], v[40:43]
    ds_read2_b32 v[90:91], v227 offset0:130 offset1:131
    v_mfma_f32_16x16x32_bf16 v[40:43], v[148:151], v[164:167], v[40:43]
    ds_read_b128 v[124:127], v231 offset:10752
    v_mfma_f32_16x16x32_bf16 v[44:47], v[136:139], v[180:183], v[44:47]
    buffer_load_dwordx4 a[196:199], v223, s[16:19], s28 offen offset:1024 sc1
    ds_read2_b32 v[92:93], v227 offset0:0 offset1:1
    v_mfma_f32_16x16x32_bf16 v[44:47], v[148:151], v[168:171], v[44:47]
    v_mfma_f32_16x16x32_bf16 v[40:43], v[128:131], v[184:187], v[40:43]
    ds_read2_b32 v[94:95], v227 offset0:2 offset1:3
    v_mfma_f32_16x16x32_bf16 v[40:43], v[152:155], v[160:163], v[40:43]
    v_mfma_f32_16x16x32_bf16 v[44:47], v[132:135], v[184:187], v[44:47]
    buffer_load_dwordx4 a[200:203], v223, s[16:19], s28 offen offset:2048 sc1
    v_mfma_f32_16x16x32_bf16 v[44:47], v[152:155], v[164:167], v[44:47]
    v_mfma_f32_16x16x32_bf16 v[44:47], v[128:131], v[188:191], v[44:47]
    v_mfma_f32_16x16x32_bf16 v[44:47], v[156:159], v[160:163], v[44:47]
    s_waitcnt lgkmcnt(0)
    s_nop 0
    v_mfma_f32_16x16x32_bf16 v[16:19], v[64:67], v[96:99], v[16:19]
    v_mfma_f32_16x16x32_bf16 v[20:23], v[64:67], v[100:103], v[20:23]
    buffer_load_dwordx4 a[204:207], v223, s[16:19], s28 offen offset:3072 sc1
    v_mfma_f32_16x16x32_bf16 v[20:23], v[68:71], v[96:99], v[20:23]
    v_mfma_f32_16x16x32_bf16 v[24:27], v[68:71], v[100:103], v[24:27]
    v_mfma_f32_16x16x32_bf16 v[24:27], v[64:67], v[104:107], v[24:27]
    v_mfma_f32_16x16x32_bf16 v[24:27], v[72:75], v[96:99], v[24:27]
    buffer_load_dwordx4 a[208:211], v236, s[16:19], s28 offen offset:0 sc1
    v_mfma_f32_16x16x32_bf16 v[28:31], v[68:71], v[104:107], v[28:31]
    v_mfma_f32_16x16x32_bf16 v[28:31], v[72:75], v[100:103], v[28:31]
    v_mfma_f32_16x16x32_bf16 v[32:35], v[72:75], v[104:107], v[32:35]
    v_mfma_f32_16x16x32_bf16 v[28:31], v[64:67], v[108:111], v[28:31]
    s_add_u32 s28, s28, 40960
    s_cmp_eq_u32 s28, s29
    s_cselect_b32 s28, s1, s28
    v_mfma_f32_16x16x32_bf16 v[28:31], v[76:79], v[96:99], v[28:31]
    v_mfma_f32_16x16x32_bf16 v[32:35], v[68:71], v[108:111], v[32:35]
    v_mfma_f32_16x16x32_bf16 v[32:35], v[76:79], v[100:103], v[32:35]
    v_mfma_f32_16x16x32_bf16 v[36:39], v[72:75], v[108:111], v[36:39]
    buffer_load_dwordx4 a[212:215], v223, s[16:19], s28 offen offset:0 sc1
    v_mfma_f32_16x16x32_bf16 v[36:39], v[76:79], v[104:107], v[36:39]
    v_mfma_f32_16x16x32_bf16 v[40:43], v[76:79], v[108:111], v[40:43]
    v_mfma_f32_16x16x32_bf16 v[32:35], v[64:67], v[112:115], v[32:35]
    v_mfma_f32_16x16x32_bf16 v[32:35], v[80:83], v[96:99], v[32:35]
    v_mfma_f32_16x16x32_bf16 v[36:39], v[68:71], v[112:115], v[36:39]
    buffer_load_dwordx4 a[216:219], v223, s[16:19], s28 offen offset:1024 sc1
    v_mfma_f32_16x16x32_bf16 v[36:39], v[80:83], v[100:103], v[36:39]
    v_mfma_f32_16x16x32_bf16 v[40:43], v[72:75], v[112:115], v[40:43]
    v_mfma_f32_16x16x32_bf16 v[40:43], v[80:83], v[104:107], v[40:43]
    v_mfma_f32_16x16x32_bf16 v[44:47], v[76:79], v[112:115], v[44:47]
    buffer_load_dwordx4 a[220:223], v223, s[16:19], s28 offen offset:2048 sc1
    v_mfma_f32_16x16x32_bf16 v[44:47], v[80:83], v[108:111], v[44:47]
    v_mfma_f32_16x16x32_bf16 v[36:39], v[64:67], v[116:119], v[36:39]
    v_mfma_f32_16x16x32_bf16 v[36:39], v[84:87], v[96:99], v[36:39]
    v_mfma_f32_16x16x32_bf16 v[40:43], v[68:71], v[116:119], v[40:43]
    buffer_load_dwordx4 a[224:227], v223, s[16:19], s28 offen offset:3072 sc1
    v_mfma_f32_16x16x32_bf16 v[40:43], v[84:87], v[100:103], v[40:43]
    v_mfma_f32_16x16x32_bf16 v[44:47], v[72:75], v[116:119], v[44:47]
    v_mfma_f32_16x16x32_bf16 v[44:47], v[84:87], v[104:107], v[44:47]
    v_mfma_f32_16x16x32_bf16 v[40:43], v[64:67], v[120:123], v[40:43]
    ds_read_b32 v3, v2
    buffer_load_dwordx4 a[228:231], v236, s[16:19], s28 offen offset:0 sc1
    v_mfma_f32_16x16x32_bf16 v[40:43], v[88:91], v[96:99], v[40:43]
    v_mfma_f32_16x16x32_bf16 v[44:47], v[68:71], v[120:123], v[44:47]
    v_mfma_f32_16x16x32_bf16 v[44:47], v[88:91], v[100:103], v[44:47]
    v_mfma_f32_16x16x32_bf16 v[44:47], v[64:67], v[124:127], v[44:47]
    v_mfma_f32_16x16x32_bf16 v[44:47], v[92:95], v[96:99], v[44:47]
    s_add_u32 s28, s28, 40960
    s_cmp_eq_u32 s28, s29
    s_cselect_b32 s28, s1, s28
    v_and_b32 v6, 15, v1
    v_lshrrev_b32 v7, 5, v1
    v_lshl_add_u32 v6, v6, 1, v7
    v_mul_u32_u24_e64 v6, 48, v6
    v_bfe_u32 v7, v1, 4, 1
    v_lshl_add_u32 v6, v7, 3, v6
    s_min_u32 s60, s52, 2
    s_lshl_b32 s60, s60, 4
    s_add_u32 s60, s60, 150432
    v_add_u32_e64 v6, s60, v6
    ds_read_b64 v[48:49], v6 offset:0
    ds_read_b64 v[50:51], v6 offset:1536
    ds_read_b64 v[52:53], v6 offset:3072
    ds_read_b64 v[54:55], v6 offset:4608
    ds_read_b64 v[56:57], v6 offset:6144
    ds_read_b64 v[58:59], v6 offset:7680
    ds_read_b64 v[60:61], v6 offset:9216
    ds_read_b64 v[62:63], v6 offset:10752
    v_mul_u32_u24 v7, 48, v1
    v_add_u32 v7, s60, v7
    v_mov_b32 v255, v254
    s_waitcnt lgkmcnt(0)
    v_cmp_ne_u32 vcc, 1, v3
    s_cbranch_vccnz L_slow2
L_ret2:
    buffer_load_dwordx4 v[64:67], v232, s[12:15], s24 offen sc1
    v_lshlrev_b32 v8, 16, v48
    v_and_b32 v9, 0xffff0000, v48
    v_lshlrev_b32 v10, 16, v49
    v_and_b32 v11, 0xffff0000, v49
    buffer_load_dwordx4 v[68:71], v233, s[12:15], s24 offen sc1
    v_pk_fma_f32 v[16:17], v[8:9], v[254:255], v[16:17]
    v_pk_fma_f32 v[18:19], v[10:11], v[254:255], v[18:19]
    buffer_load_dwordx4 v[72:75], v234, s[12:15], s24 offen sc1
    v_cvt_pk_bf16_f32 v48, v16, v17
    v_cvt_pk_bf16_f32 v49, v18, v19
    ds_write_b64 v6, v[48:49] offset:0
    buffer_load_dwordx4 v[76:79], v235, s[12:15], s24 offen sc1
    v_lshlrev_b32_e64 v8, 16, v50
    v_and_b32 v9, 0xffff0000, v50
    v_lshlrev_b32 v10, 16, v51
    v_and_b32 v11, 0xffff0000, v51
    s_add_u32 s24, s24, 131072
    s_cmp_eq_u32 s24, s25
    s_cselect_b32 s24, s0, s24
    v_pk_fma_f32 v[20:21], v[8:9], v[254:255], v[20:21]
    v_pk_fma_f32 v[22:23], v[10:11], v[254:255], v[22:23]
    buffer_load_dwordx4 v[80:83], v232, s[12:15], s24 offen sc1
    v_cvt_pk_bf16_f32 v50, v20, v21
    v_cvt_pk_bf16_f32 v51, v22, v23
    ds_write_b64 v6, v[50:51] offset:1536
    ds_read_b128 v[192:195], v7 offset:0
    buffer_load_dwordx4 v[84:87], v233, s[12:15], s24 offen sc1
    v_lshlrev_b32 v8, 16, v52
    v_and_b32 v9, 0xffff0000, v52
    v_lshlrev_b32_e64 v10, 16, v53
    v_and_b32 v11, 0xffff0000, v53
    buffer_load_dwordx4 v[88:91], v234, s[12:15], s24 offen sc1
    v_pk_fma_f32 v[24:25], v[8:9], v[254:255], v[24:25]
    v_pk_fma_f32 v[26:27], v[10:11], v[254:255], v[26:27]
    buffer_load_dwordx4 v[92:95], v235, s[12:15], s24 offen sc1
    v_cvt_pk_bf16_f32 v52, v24, v25
    v_cvt_pk_bf16_f32 v53, v26, v27
    ds_write_b64 v6, v[52:53] offset:3072
    s_add_u32 s24, s24, 131072
    s_cmp_eq_u32 s24, s25
    s_cselect_b32 s24, s0, s24
    v_lshlrev_b32 v8, 16, v54
    v_and_b32 v9, 0xffff0000, v54
    v_lshlrev_b32 v10, 16, v55
    v_and_b32 v11, 0xffff0000, v55
    buffer_load_dwordx4 v[96:99], v232, s[12:15], s24 offen sc1
    v_pk_fma_f32 v[28:29], v[8:9], v[254:255], v[28:29]
    v_pk_fma_f32 v[30:31], v[10:11], v[254:255], v[30:31]
    buffer_load_dwordx4 v[100:103], v233, s[12:15], s24 offen sc1
    v_cvt_pk_bf16_f32 v54, v28, v29
    v_cvt_pk_bf16_f32 v55, v30, v31
    ds_write_b64 v6, v[54:55] offset:4608
    ds_read_b128 v[196:199], v7 offset:3072
    s_waitcnt lgkmcnt(0)
    buffer_store_dwordx4 v[192:195], v223, s[44:47], s11 offen offset:0 sc1
    buffer_load_dwordx4 v[104:107], v234, s[12:15], s24 offen sc1
    v_lshlrev_b32 v8, 16, v56
    v_and_b32 v9, 0xffff0000, v56
    v_lshlrev_b32_e64 v10, 16, v57
    v_and_b32 v11, 0xffff0000, v57
    buffer_load_dwordx4 v[108:111], v235, s[12:15], s24 offen sc1
    v_pk_fma_f32 v[32:33], v[8:9], v[254:255], v[32:33]
    v_pk_fma_f32 v[34:35], v[10:11], v[254:255], v[34:35]
    s_add_u32 s24, s24, 131072
    s_cmp_eq_u32 s24, s25
    s_cselect_b32 s24, s0, s24
    v_cvt_pk_bf16_f32 v56, v32, v33
    v_cvt_pk_bf16_f32 v57, v34, v35
    ds_write_b64 v6, v[56:57] offset:6144
    v_lshlrev_b32 v8, 16, v58
    v_and_b32 v9, 0xffff0000, v58
    v_lshlrev_b32 v10, 16, v59
    v_and_b32 v11, 0xffff0000, v59
    v_pk_fma_f32 v[36:37], v[8:9], v[254:255], v[36:37]
    v_pk_fma_f32 v[38:39], v[10:11], v[254:255], v[38:39]
    v_cvt_pk_bf16_f32 v58, v36, v37
    v_cvt_pk_bf16_f32 v59, v38, v39
    ds_write_b64 v6, v[58:59] offset:7680
    ds_read_b128 v[200:203], v7 offset:6144
    buffer_store_dwordx4 v[196:199], v223, s[44:47], s11 offen offset:1024 sc1
    v_lshlrev_b32 v8, 16, v60
    v_and_b32 v9, 0xffff0000, v60
    v_lshlrev_b32 v10, 16, v61
    v_and_b32 v11, 0xffff0000, v61
    v_pk_fma_f32 v[40:41], v[8:9], v[254:255], v[40:41]
    v_pk_fma_f32 v[42:43], v[10:11], v[254:255], v[42:43]
    v_cvt_pk_bf16_f32 v60, v40, v41
    v_cvt_pk_bf16_f32 v61, v42, v43
    ds_write_b64 v6, v[60:61] offset:9216
    v_lshlrev_b32 v8, 16, v62
    v_and_b32 v9, 0xffff0000, v62
    v_lshlrev_b32 v10, 16, v63
    v_and_b32 v11, 0xffff0000, v63
    v_pk_fma_f32 v[44:45], v[8:9], v[254:255], v[44:45]
    v_pk_fma_f32 v[46:47], v[10:11], v[254:255], v[46:47]
    v_cvt_pk_bf16_f32 v62, v44, v45
    v_cvt_pk_bf16_f32 v63, v46, v47
    ds_write_b64 v6, v[62:63] offset:10752
    ds_read_b128 v[204:207], v7 offset:9216
    s_waitcnt lgkmcnt(0)
    buffer_store_dwordx4 v[200:203], v223, s[44:47], s11 offen offset:2048 sc1
    buffer_store_dwordx4 v[204:207], v223, s[44:47], s11 offen offset:3072 sc1
    s_branch L_gemm2
L_noconv:
    s_waitcnt lgkmcnt(0)
    v_pk_fma_f32 v[64:65], v[20:21], v[14:15], v[64:65] op_sel:[0,0,0] op_sel_hi:[1,0,1] neg_lo:[1,0,0] neg_hi:[1,0,0]
    v_pk_fma_f32 v[66:67], v[22:23], v[14:15], v[66:67] op_sel:[0,0,0] op_sel_hi:[1,0,1] neg_lo:[1,0,0] neg_hi:[1,0,0]
    v_cvt_pk_bf16_f32 v48, v64, v65
    s_nop 0
    v_cvt_pk_bf16_f32 v49, v66, v67
    v_pk_max_i16 v48, v48, 0
    v_pk_max_i16 v49, v49, 0
    v_pk_fma_f32 v[72:73], v[24:25], v[14:15], v[72:73] op_sel:[0,0,0] op_sel_hi:[1,0,1] neg_lo:[1,0,0] neg_hi:[1,0,0]
    v_pk_fma_f32 v[74:75], v[26:27], v[14:15], v[74:75] op_sel:[0,0,0] op_sel_hi:[1,0,1] neg_lo:[1,0,0] neg_hi:[1,0,0]
    v_cvt_pk_bf16_f32 v50, v72, v73
    v_cvt_pk_bf16_f32 v51, v74, v75
    v_pk_max_i16 v50, v50, 0
    v_pk_max_i16 v51, v51, 0
    buffer_store_dwordx4 v[48:51], v223, s[12:15], s7 offen offset:0 sc1
    v_pk_fma_f32 v[96:97], v[28:29], v[14:15], v[96:97] op_sel:[0,0,0] op_sel_hi:[1,0,1] neg_lo:[1,0,0] neg_hi:[1,0,0]
    v_pk_fma_f32 v[98:99], v[30:31], v[14:15], v[98:99] op_sel:[0,0,0] op_sel_hi:[1,0,1] neg_lo:[1,0,0] neg_hi:[1,0,0]
    v_cvt_pk_bf16_f32 v56, v96, v97
    v_cvt_pk_bf16_f32 v57, v98, v99
    v_pk_max_i16 v56, v56, 0
    v_pk_max_i16 v57, v57, 0
    v_pk_fma_f32 v[104:105], v[32:33], v[14:15], v[104:105] op_sel:[0,0,0] op_sel_hi:[1,0,1] neg_lo:[1,0,0] neg_hi:[1,0,0]
    v_pk_fma_f32 v[106:107], v[34:35], v[14:15], v[106:107] op_sel:[0,0,0] op_sel_hi:[1,0,1] neg_lo:[1,0,0] neg_hi:[1,0,0]
    v_cvt_pk_bf16_f32 v58, v104, v105
    v_cvt_pk_bf16_f32 v59, v106, v107
    v_pk_max_i16 v58, v58, 0
    v_pk_max_i16 v59, v59, 0
    buffer_store_dwordx4 v[56:59], v223, s[12:15], s6 offen offset:0 sc1
    v_pk_fma_f32 v[80:81], v[36:37], v[14:15], v[80:81] op_sel:[0,0,0] op_sel_hi:[1,0,1] neg_lo:[1,0,0] neg_hi:[1,0,0]
    v_pk_fma_f32 v[82:83], v[38:39], v[14:15], v[82:83] op_sel:[0,0,0] op_sel_hi:[1,0,1] neg_lo:[1,0,0] neg_hi:[1,0,0]
    v_cvt_pk_bf16_f32 v52, v80, v81
    v_cvt_pk_bf16_f32 v53, v82, v83
    v_pk_max_i16 v52, v52, 0
    v_pk_max_i16 v53, v53, 0
    v_pk_fma_f32 v[88:89], v[40:41], v[14:15], v[88:89] op_sel:[0,0,0] op_sel_hi:[1,0,1] neg_lo:[1,0,0] neg_hi:[1,0,0]
    v_pk_fma_f32 v[90:91], v[42:43], v[14:15], v[90:91] op_sel:[0,0,0] op_sel_hi:[1,0,1] neg_lo:[1,0,0] neg_hi:[1,0,0]
    v_cvt_pk_bf16_f32 v54, v88, v89
    v_cvt_pk_bf16_f32 v55, v90, v91
    v_pk_max_i16 v54, v54, 0
    v_pk_max_i16 v55, v55, 0
    buffer_store_dwordx4 v[52:55], v223, s[12:15], s5 offen offset:0 sc1
    v_pk_fma_f32 v[112:113], v[44:45], v[14:15], v[112:113] op_sel:[0,0,0] op_sel_hi:[1,0,1] neg_lo:[1,0,0] neg_hi:[1,0,0]
    v_pk_fma_f32 v[114:115], v[46:47], v[14:15], v[114:115] op_sel:[0,0,0] op_sel_hi:[1,0,1] neg_lo:[1,0,0] neg_hi:[1,0,0]
    v_cvt_pk_bf16_f32 v60, v112, v113
    v_cvt_pk_bf16_f32 v61, v114, v115
    v_pk_max_i16 v60, v60, 0
    v_pk_max_i16 v61, v61, 0
    v_pk_fma_f32 v[68:69], v[20:21], v[14:15], v[68:69] op_sel:[0,1,0] op_sel_hi:[1,1,1] neg_lo:[1,0,0] neg_hi:[1,0,0]
    v_pk_fma_f32 v[70:71], v[22:23], v[14:15], v[70:71] op_sel:[0,1,0] op_sel_hi:[1,1,1] neg_lo:[1,0,0] neg_hi:[1,0,0]
    v_cvt_pk_bf16_f32 v192, v68, v69
    v_cvt_pk_bf16_f32 v193, v70, v71
    v_pk_max_i16 v192, v192, 0
    v_pk_max_i16 v193, v193, 0
    v_pk_fma_f32 v[76:77], v[24:25], v[14:15], v[76:77] op_sel:[0,1,0] op_sel_hi:[1,1,1] neg_lo:[1,0,0] neg_hi:[1,0,0]
    v_pk_fma_f32 v[78:79], v[26:27], v[14:15], v[78:79] op_sel:[0,1,0] op_sel_hi:[1,1,1] neg_lo:[1,0,0] neg_hi:[1,0,0]
    v_cvt_pk_bf16_f32 v194, v76, v77
    v_cvt_pk_bf16_f32 v195, v78, v79
    v_pk_max_i16 v194, v194, 0
    v_pk_max_i16 v195, v195, 0
    buffer_store_dwordx4 v[192:195], v223, s[12:15], s7 offen offset:1024 sc1
    v_pk_fma_f32 v[100:101], v[28:29], v[14:15], v[100:101] op_sel:[0,1,0] op_sel_hi:[1,1,1] neg_lo:[1,0,0] neg_hi:[1,0,0]
    v_pk_fma_f32 v[102:103], v[30:31], v[14:15], v[102:103] op_sel:[0,1,0] op_sel_hi:[1,1,1] neg_lo:[1,0,0] neg_hi:[1,0,0]
    v_cvt_pk_bf16_f32 v200, v100, v101
    v_cvt_pk_bf16_f32 v201, v102, v103
    v_pk_max_i16 v200, v200, 0
    v_pk_max_i16 v201, v201, 0
    v_pk_fma_f32 v[108:109], v[32:33], v[14:15], v[108:109] op_sel:[0,1,0] op_sel_hi:[1,1,1] neg_lo:[1,0,0] neg_hi:[1,0,0]
    v_pk_fma_f32 v[110:111], v[34:35], v[14:15], v[110:111] op_sel:[0,1,0] op_sel_hi:[1,1,1] neg_lo:[1,0,0] neg_hi:[1,0,0]
    v_cvt_pk_bf16_f32 v202, v108, v109
    v_cvt_pk_bf16_f32 v203, v110, v111
    v_pk_max_i16 v202, v202, 0
    v_pk_max_i16 v203, v203, 0
    buffer_store_dwordx4 v[200:203], v223, s[12:15], s6 offen offset:1024 sc1
    v_pk_fma_f32 v[84:85], v[36:37], v[14:15], v[84:85] op_sel:[0,1,0] op_sel_hi:[1,1,1] neg_lo:[1,0,0] neg_hi:[1,0,0]
    v_pk_fma_f32 v[86:87], v[38:39], v[14:15], v[86:87] op_sel:[0,1,0] op_sel_hi:[1,1,1] neg_lo:[1,0,0] neg_hi:[1,0,0]
    v_cvt_pk_bf16_f32 v196, v84, v85
    v_cvt_pk_bf16_f32 v197, v86, v87
    v_pk_max_i16 v196, v196, 0
    v_pk_max_i16 v197, v197, 0
    v_pk_fma_f32 v[92:93], v[40:41], v[14:15], v[92:93] op_sel:[0,1,0] op_sel_hi:[1,1,1] neg_lo:[1,0,0] neg_hi:[1,0,0]
    v_pk_fma_f32 v[94:95], v[42:43], v[14:15], v[94:95] op_sel:[0,1,0] op_sel_hi:[1,1,1] neg_lo:[1,0,0] neg_hi:[1,0,0]
    v_cvt_pk_bf16_f32 v198, v92, v93
    v_cvt_pk_bf16_f32 v199, v94, v95
    v_pk_max_i16 v198, v198, 0
    v_pk_max_i16 v199, v199, 0
    buffer_store_dwordx4 v[196:199], v223, s[12:15], s5 offen offset:1024 sc1
    v_pk_fma_f32 v[116:117], v[44:45], v[14:15], v[116:117] op_sel:[0,1,0] op_sel_hi:[1,1,1] neg_lo:[1,0,0] neg_hi:[1,0,0]
    v_pk_fma_f32 v[118:119], v[46:47], v[14:15], v[118:119] op_sel:[0,1,0] op_sel_hi:[1,1,1] neg_lo:[1,0,0] neg_hi:[1,0,0]
    v_cvt_pk_bf16_f32 v62, v116, v117
    v_cvt_pk_bf16_f32 v63, v118, v119
    v_pk_max_i16 v62, v62, 0
    v_pk_max_i16 v63, v63, 0
    s_nop 1
    v_permlane16_swap_b32 v60, v62
    v_permlane16_swap_b32 v61, v63
    s_nop 0
    buffer_store_dwordx4 v[60:63], v214, s[12:15], s8 offen sc1
    s_waitcnt vmcnt(0)
    v_mov_b32 v4, 0
    v_mov_b32 v5, s58
    s_mov_b64 exec, 1
    buffer_store_dword v5, v4, s[44:47], s9 offen sc1
    s_mov_b64 exec, -1
    s_sub_u32 s60, s28, s1
    s_add_u32 s60, s60, 204800
    s_cmp_ge_u32 s60, 573440
    s_cselect_b32 s61, 573440, 0
    s_sub_u32 s60, s60, s61
    s_mul_i32 s61, s56, 5120
    s_add_u32 s62, s61, 573440
    s_add_u32 s60, s60, s61
    v_and_b32 v6, 15, v1
    v_lshlrev_b32 v6, 7, v6
    v_mov_b32_e64 v3, 1
    buffer_load_dwordx4 a[132:135], v223, s[16:19], s28 offen offset:0 sc1
    buffer_load_dwordx4 a[136:139], v223, s[16:19], s28 offen offset:1024 sc1
    buffer_load_dwordx4 a[140:143], v223, s[16:19], s28 offen offset:2048 sc1
    buffer_load_dwordx4 a[144:147], v223, s[16:19], s28 offen offset:3072 sc1
    buffer_load_dwordx4 a[148:151], v236, s[16:19], s28 offen offset:0 sc1
    s_add_u32 s28, s28, 40960
    s_cmp_eq_u32 s28, s29
    s_cselect_b32 s28, s1, s28
    s_waitcnt vmcnt(10)
    buffer_load_dwordx4 a[152:155], v223, s[16:19], s28 offen offset:0 sc1
    buffer_load_dwordx4 a[156:159], v223, s[16:19], s28 offen offset:1024 sc1
    buffer_load_dwordx4 a[160:163], v223, s[16:19], s28 offen offset:2048 sc1
    buffer_load_dwordx4 a[164:167], v223, s[16:19], s28 offen offset:3072 sc1
    buffer_load_dwordx4 a[168:171], v236, s[16:19], s28 offen offset:0 sc1
    s_add_u32 s28, s28, 40960
    s_cmp_eq_u32 s28, s29
    s_cselect_b32 s28, s1, s28
    s_waitcnt vmcnt(10)
    buffer_load_dwordx4 a[172:175], v223, s[16:19], s28 offen offset:0 sc1
    buffer_load_dwordx4 a[176:179], v223, s[16:19], s28 offen offset:1024 sc1
    buffer_load_dwordx4 a[180:183], v223, s[16:19], s28 offen offset:2048 sc1
    buffer_load_dwordx4 a[184:187], v223, s[16:19], s28 offen offset:3072 sc1
    buffer_load_dwordx4 a[188:191], v236, s[16:19], s28 offen offset:0 sc1
    s_add_u32 s28, s28, 40960
    s_cmp_eq_u32 s28, s29
    s_cselect_b32 s28, s1, s28
    s_waitcnt vmcnt(10)
    buffer_load_dwordx4 a[192:195], v223, s[16:19], s28 offen offset:0 sc1
    buffer_load_dwordx4 a[196:199], v223, s[16:19], s28 offen offset:1024 sc1
    buffer_load_dwordx4 a[200:203], v223, s[16:19], s28 offen offset:2048 sc1
    buffer_load_dwordx4 a[204:207], v223, s[16:19], s28 offen offset:3072 sc1
    buffer_load_dwordx4 a[208:211], v236, s[16:19], s28 offen offset:0 sc1
    s_add_u32 s28, s28, 40960
    s_cmp_eq_u32 s28, s29
    s_cselect_b32 s28, s1, s28
    s_waitcnt vmcnt(10)
    buffer_load_dwordx4 a[212:215], v223, s[16:19], s28 offen offset:0 sc1
    buffer_load_dwordx4 a[216:219], v223, s[16:19], s28 offen offset:1024 sc1
    buffer_load_dwordx4 a[220:223], v223, s[16:19], s28 offen offset:2048 sc1
    buffer_load_dwordx4 a[224:227], v223, s[16:19], s28 offen offset:3072 sc1
    buffer_load_dwordx4 a[228:231], v236, s[16:19], s28 offen offset:0 sc1
    s_add_u32 s28, s28, 40960
    s_cmp_eq_u32 s28, s29
    s_cselect_b32 s28, s1, s28
    s_waitcnt vmcnt(10)
    s_cmp_eq_u32 s52, 3
    s_cbranch_scc0 L_nc2
    s_cmp_eq_u32 s73, 1
    s_cbranch_scc1 L_nc3
    s_add_u32 s63, s60, 0
    s_mov_b32 m0, 81920
    s_nop 0
    buffer_load_dwordx4 v223, s[16:19], s63 offen offset:0 sc1 lds
    buffer_load_dwordx4 v223, s[16:19], s63 offen offset:1024 sc1 lds
    buffer_load_dwordx4 v223, s[16:19], s63 offen offset:2048 sc1 lds
    buffer_load_dwordx4 v223, s[16:19], s63 offen offset:3072 sc1 lds
    s_mov_b32 m0, 86016
    s_nop 0
    buffer_load_dwordx4 v236, s[16:19], s63 offen sc1 lds
    s_waitcnt vmcnt(35)
    s_add_u32 s63, s60, 573440
    s_mov_b32 m0, 87040
    s_nop 0
    buffer_load_dwordx4 v223, s[16:19], s63 offen offset:0 sc1 lds
    buffer_load_dwordx4 v223, s[16:19], s63 offen offset:1024 sc1 lds
    buffer_load_dwordx4 v223, s[16:19], s63 offen offset:2048 sc1 lds
    buffer_load_dwordx4 v223, s[16:19], s63 offen offset:3072 sc1 lds
    s_mov_b32 m0, 91136
    s_nop 0
    buffer_load_dwordx4 v236, s[16:19], s63 offen sc1 lds
    s_waitcnt vmcnt(35)
    s_add_u32 s63, s60, 1146880
    s_mov_b32 m0, 112640
    s_nop 0
    buffer_load_dwordx4 v223, s[16:19], s63 offen offset:0 sc1 lds
    buffer_load_dwordx4 v223, s[16:19], s63 offen offset:1024 sc1 lds
    buffer_load_dwordx4 v223, s[16:19], s63 offen offset:2048 sc1 lds
    buffer_load_dwordx4 v223, s[16:19], s63 offen offset:3072 sc1 lds
    s_mov_b32 m0, 116736
    s_nop 0
    buffer_load_dwordx4 v236, s[16:19], s63 offen sc1 lds
    s_waitcnt vmcnt(35)
    s_add_u32 s63, s60, 1720320
    s_mov_b32 m0, 117760
    s_nop 0
    buffer_load_dwordx4 v223, s[16:19], s63 offen offset:0 sc1 lds
    buffer_load_dwordx4 v223, s[16:19], s63 offen offset:1024 sc1 lds
    buffer_load_dwordx4 v223, s[16:19], s63 offen offset:2048 sc1 lds
    buffer_load_dwordx4 v223, s[16:19], s63 offen offset:3072 sc1 lds
    s_mov_b32 m0, 121856
    s_nop 0
    buffer_load_dwordx4 v236, s[16:19], s63 offen sc1 lds
    s_waitcnt vmcnt(35)
    s_add_u32 s60, s60, 40960
    s_cmp_eq_u32 s60, s62
    s_cselect_b32 s60, s61, s60
    s_add_u32 s63, s60, 0
    s_mov_b32 m0, 0
    s_nop 0
    buffer_load_dwordx4 v223, s[16:19], s63 offen offset:0 sc1 lds
    buffer_load_dwordx4 v223, s[16:19], s63 offen offset:1024 sc1 lds
    buffer_load_dwordx4 v223, s[16:19], s63 offen offset:2048 sc1 lds
    buffer_load_dwordx4 v223, s[16:19], s63 offen offset:3072 sc1 lds
    s_mov_b32 m0, 4096
    s_nop 0
    buffer_load_dwordx4 v236, s[16:19], s63 offen sc1 lds
    s_waitcnt vmcnt(35)
    s_add_u32 s63, s60, 573440
    s_mov_b32 m0, 5120
    s_nop 0
    buffer_load_dwordx4 v223, s[16:19], s63 offen offset:0 sc1 lds
    buffer_load_dwordx4 v223, s[16:19], s63 offen offset:1024 sc1 lds
    buffer_load_dwordx4 v223, s[16:19], s63 offen offset:2048 sc1 lds
    buffer_load_dwordx4 v223, s[16:19], s63 offen offset:3072 sc1 lds
    s_mov_b32 m0, 9216
    s_nop 0
    buffer_load_dwordx4 v236, s[16:19], s63 offen sc1 lds
    s_waitcnt vmcnt(35)
    s_add_u32 s63, s60, 1146880
    s_mov_b32 m0, 10240
    s_nop 0
    buffer_load_dwordx4 v223, s[16:19], s63 offen offset:0 sc1 lds
    buffer_load_dwordx4 v223, s[16:19], s63 offen offset:1024 sc1 lds
    buffer_load_dwordx4 v223, s[16:19], s63 offen offset:2048 sc1 lds
    buffer_load_dwordx4 v223, s[16:19], s63 offen offset:3072 sc1 lds
    s_mov_b32 m0, 14336
    s_nop 0
    buffer_load_dwordx4 v236, s[16:19], s63 offen sc1 lds
    s_waitcnt vmcnt(35)
    s_add_u32 s63, s60, 1720320
    s_mov_b32 m0, 15360
    s_nop 0
    buffer_load_dwordx4 v223, s[16:19], s63 offen offset:0 sc1 lds
    buffer_load_dwordx4 v223, s[16:19], s63 offen offset:1024 sc1 lds
    buffer_load_dwordx4 v223, s[16:19], s63 offen offset:2048 sc1 lds
    buffer_load_dwordx4 v223, s[16:19], s63 offen offset:3072 sc1 lds
    s_mov_b32 m0, 19456
    s_nop 0
    buffer_load_dwordx4 v236, s[16:19], s63 offen sc1 lds
    s_waitcnt vmcnt(35)
    s_add_u32 s60, s60, 40960
    s_cmp_eq_u32 s60, s62
    s_cselect_b32 s60, s61, s60
    s_add_u32 s63, s60, 0
    s_mov_b32 m0, 30720
    s_nop 0
    buffer_load_dwordx4 v223, s[16:19], s63 offen offset:0 sc1 lds
    buffer_load_dwordx4 v223, s[16:19], s63 offen offset:1024 sc1 lds
    buffer_load_dwordx4 v223, s[16:19], s63 offen offset:2048 sc1 lds
    buffer_load_dwordx4 v223, s[16:19], s63 offen offset:3072 sc1 lds
    s_mov_b32 m0, 34816
    s_nop 0
    buffer_load_dwordx4 v236, s[16:19], s63 offen sc1 lds
    s_waitcnt vmcnt(35)
    s_add_u32 s63, s60, 573440
    s_mov_b32 m0, 35840
    s_nop 0
    buffer_load_dwordx4 v223, s[16:19], s63 offen offset:0 sc1 lds
    buffer_load_dwordx4 v223, s[16:19], s63 offen offset:1024 sc1 lds
    buffer_load_dwordx4 v223, s[16:19], s63 offen offset:2048 sc1 lds
    buffer_load_dwordx4 v223, s[16:19], s63 offen offset:3072 sc1 lds
    s_mov_b32 m0, 39936
    s_nop 0
    buffer_load_dwordx4 v236, s[16:19], s63 offen sc1 lds
    s_waitcnt vmcnt(35)
    s_add_u32 s63, s60, 1146880
    s_mov_b32 m0, 40960
    s_nop 0
    buffer_load_dwordx4 v223, s[16:19], s63 offen offset:0 sc1 lds
    buffer_load_dwordx4 v223, s[16:19], s63 offen offset:1024 sc1 lds
    buffer_load_dwordx4 v223, s[16:19], s63 offen offset:2048 sc1 lds
    buffer_load_dwordx4 v223, s[16:19], s63 offen offset:3072 sc1 lds
    s_mov_b32 m0, 45056
    s_nop 0
    buffer_load_dwordx4 v236, s[16:19], s63 offen sc1 lds
    s_waitcnt vmcnt(35)
    s_add_u32 s63, s60, 1720320
    s_mov_b32 m0, 46080
    s_nop 0
    buffer_load_dwordx4 v223, s[16:19], s63 offen offset:0 sc1 lds
    buffer_load_dwordx4 v223, s[16:19], s63 offen offset:1024 sc1 lds
    buffer_load_dwordx4 v223, s[16:19], s63 offen offset:2048 sc1 lds
    buffer_load_dwordx4 v223, s[16:19], s63 offen offset:3072 sc1 lds
    s_mov_b32 m0, 50176
    s_nop 0
    buffer_load_dwordx4 v236, s[16:19], s63 offen sc1 lds
    s_waitcnt vmcnt(35)
    buffer_load_dwordx2 v[4:5], v6, s[44:47], s21 offen sc1
    s_add_u32 s60, s60, 40960
    s_cmp_eq_u32 s60, s62
    s_cselect_b32 s60, s61, s60
    s_add_u32 s63, s60, 0
    s_mov_b32 m0, 20480
    s_nop 0
    buffer_load_dwordx4 v223, s[16:19], s63 offen offset:0 sc1 lds
    buffer_load_dwordx4 v223, s[16:19], s63 offen offset:1024 sc1 lds
    buffer_load_dwordx4 v223, s[16:19], s63 offen offset:2048 sc1 lds
    buffer_load_dwordx4 v223, s[16:19], s63 offen offset:3072 sc1 lds
    s_mov_b32 m0, 24576
    s_nop 0
    buffer_load_dwordx4 v236, s[16:19], s63 offen sc1 lds
    s_waitcnt vmcnt(35)
    s_add_u32 s63, s60, 573440
    s_mov_b32 m0, 25600
    s_nop 0
    buffer_load_dwordx4 v223, s[16:19], s63 offen offset:0 sc1 lds
    buffer_load_dwordx4 v223, s[16:19], s63 offen offset:1024 sc1 lds
    buffer_load_dwordx4 v223, s[16:19], s63 offen offset:2048 sc1 lds
    buffer_load_dwordx4 v223, s[16:19], s63 offen offset:3072 sc1 lds
    s_mov_b32 m0, 29696
    s_nop 0
    buffer_load_dwordx4 v236, s[16:19], s63 offen sc1 lds
    s_waitcnt vmcnt(35)
    s_add_u32 s63, s60, 1146880
    s_mov_b32 m0, 51200
    s_nop 0
    buffer_load_dwordx4 v223, s[16:19], s63 offen offset:0 sc1 lds
    buffer_load_dwordx4 v223, s[16:19], s63 offen offset:1024 sc1 lds
    buffer_load_dwordx4 v223, s[16:19], s63 offen offset:2048 sc1 lds
    buffer_load_dwordx4 v223, s[16:19], s63 offen offset:3072 sc1 lds
    s_mov_b32 m0, 55296
    s_nop 0
    buffer_load_dwordx4 v236, s[16:19], s63 offen sc1 lds
    s_waitcnt vmcnt(35)
    s_add_u32 s63, s60, 1720320
    s_mov_b32 m0, 56320
    s_nop 0
    buffer_load_dwordx4 v223, s[16:19], s63 offen offset:0 sc1 lds
    buffer_load_dwordx4 v223, s[16:19], s63 offen offset:1024 sc1 lds
    buffer_load_dwordx4 v223, s[16:19], s63 offen offset:2048 sc1 lds
    buffer_load_dwordx4 v223, s[16:19], s63 offen offset:3072 sc1 lds
    s_mov_b32 m0, 60416
    s_nop 0
    buffer_load_dwordx4 v236, s[16:19], s63 offen sc1 lds
    s_waitcnt vmcnt(35)
    s_cmp_eq_u32 s27, 0
    s_cbranch_scc1 L_sk4_11
    s_waitcnt vmcnt(20)
    v_cmp_ne_u32 vcc, s58, v4
    v_cmp_ne_u32 s[66:67], s58, v5
    s_or_b64 vcc, vcc, s[66:67]
    s_cbranch_vccnz L_re4_11
    ds_write_b32 v2, v3
    s_mov_b32 s27, 0
    s_branch L_sk4_11
L_re4_11:
    buffer_load_dwordx2 v[4:5], v6, s[44:47], s21 offen sc1
L_sk4_11:
    s_add_u32 s60, s60, 40960
    s_cmp_eq_u32 s60, s62
    s_cselect_b32 s60, s61, s60
    s_add_u32 s63, s60, 0
    s_mov_b32 m0, 61440
    s_nop 0
    buffer_load_dwordx4 v223, s[16:19], s63 offen offset:0 sc1 lds
    buffer_load_dwordx4 v223, s[16:19], s63 offen offset:1024 sc1 lds
    buffer_load_dwordx4 v223, s[16:19], s63 offen offset:2048 sc1 lds
    buffer_load_dwordx4 v223, s[16:19], s63 offen offset:3072 sc1 lds
    s_mov_b32 m0, 65536
    s_nop 0
    buffer_load_dwordx4 v236, s[16:19], s63 offen sc1 lds
    s_waitcnt vmcnt(35)
    s_add_u32 s63, s60, 573440
    s_mov_b32 m0, 66560
    s_nop 0
    buffer_load_dwordx4 v223, s[16:19], s63 offen offset:0 sc1 lds
    buffer_load_dwordx4 v223, s[16:19], s63 offen offset:1024 sc1 lds
    buffer_load_dwordx4 v223, s[16:19], s63 offen offset:2048 sc1 lds
    buffer_load_dwordx4 v223, s[16:19], s63 offen offset:3072 sc1 lds
    s_mov_b32 m0, 70656
    s_nop 0
    buffer_load_dwordx4 v236, s[16:19], s63 offen sc1 lds
    s_waitcnt vmcnt(35)
    s_add_u32 s63, s60, 1146880
    s_mov_b32 m0, 71680
    s_nop 0
    buffer_load_dwordx4 v223, s[16:19], s63 offen offset:0 sc1 lds
    buffer_load_dwordx4 v223, s[16:19], s63 offen offset:1024 sc1 lds
    buffer_load_dwordx4 v223, s[16:19], s63 offen offset:2048 sc1 lds
    buffer_load_dwordx4 v223, s[16:19], s63 offen offset:3072 sc1 lds
    s_mov_b32 m0, 75776
    s_nop 0
    buffer_load_dwordx4 v236, s[16:19], s63 offen sc1 lds
    s_waitcnt vmcnt(35)
    s_add_u32 s63, s60, 1720320
    s_mov_b32 m0, 76800
    s_nop 0
    buffer_load_dwordx4 v223, s[16:19], s63 offen offset:0 sc1 lds
    buffer_load_dwordx4 v223, s[16:19], s63 offen offset:1024 sc1 lds
    buffer_load_dwordx4 v223, s[16:19], s63 offen offset:2048 sc1 lds
    buffer_load_dwordx4 v223, s[16:19], s63 offen offset:3072 sc1 lds
    s_mov_b32 m0, 80896
    s_nop 0
    buffer_load_dwordx4 v236, s[16:19], s63 offen sc1 lds
    s_waitcnt vmcnt(35)
    s_cmp_eq_u32 s27, 0
    s_cbranch_scc1 L_sk4_12
    s_waitcnt vmcnt(20)
    v_cmp_ne_u32 vcc, s58, v4
    v_cmp_ne_u32 s[66:67], s58, v5
    s_or_b64 vcc, vcc, s[66:67]
    s_cbranch_vccnz L_re4_12
    ds_write_b32 v2, v3
    s_mov_b32 s27, 0
    s_branch L_sk4_12
L_re4_12:
    buffer_load_dwordx2 v[4:5], v6, s[44:47], s21 offen sc1
L_sk4_12:
    s_add_u32 s60, s60, 40960
    s_cmp_eq_u32 s60, s62
    s_cselect_b32 s60, s61, s60
    s_add_u32 s63, s60, 0
    s_mov_b32 m0, 92160
    s_nop 0
    buffer_load_dwordx4 v223, s[16:19], s63 offen offset:0 sc1 lds
    buffer_load_dwordx4 v223, s[16:19], s63 offen offset:1024 sc1 lds
    buffer_load_dwordx4 v223, s[16:19], s63 offen offset:2048 sc1 lds
    buffer_load_dwordx4 v223, s[16:19], s63 offen offset:3072 sc1 lds
    s_mov_b32 m0, 96256
    s_nop 0
    buffer_load_dwordx4 v236, s[16:19], s63 offen sc1 lds
    s_waitcnt vmcnt(35)
    s_add_u32 s63, s60, 573440
    s_mov_b32 m0, 97280
    s_nop 0
    buffer_load_dwordx4 v223, s[16:19], s63 offen offset:0 sc1 lds
    buffer_load_dwordx4 v223, s[16:19], s63 offen offset:1024 sc1 lds
    buffer_load_dwordx4 v223, s[16:19], s63 offen offset:2048 sc1 lds
    buffer_load_dwordx4 v223, s[16:19], s63 offen offset:3072 sc1 lds
    s_mov_b32 m0, 101376
    s_nop 0
    buffer_load_dwordx4 v236, s[16:19], s63 offen sc1 lds
    s_waitcnt vmcnt(35)
    s_add_u32 s63, s60, 1146880
    s_mov_b32 m0, 102400
    s_nop 0
    buffer_load_dwordx4 v223, s[16:19], s63 offen offset:0 sc1 lds
    buffer_load_dwordx4 v223, s[16:19], s63 offen offset:1024 sc1 lds
    buffer_load_dwordx4 v223, s[16:19], s63 offen offset:2048 sc1 lds
    buffer_load_dwordx4 v223, s[16:19], s63 offen offset:3072 sc1 lds
    s_mov_b32 m0, 106496
    s_nop 0
    buffer_load_dwordx4 v236, s[16:19], s63 offen sc1 lds
    s_waitcnt vmcnt(35)
    s_add_u32 s63, s60, 1720320
    s_mov_b32 m0, 107520
    s_nop 0
    buffer_load_dwordx4 v223, s[16:19], s63 offen offset:0 sc1 lds
    buffer_load_dwordx4 v223, s[16:19], s63 offen offset:1024 sc1 lds
    buffer_load_dwordx4 v223, s[16:19], s63 offen offset:2048 sc1 lds
    buffer_load_dwordx4 v223, s[16:19], s63 offen offset:3072 sc1 lds
    s_mov_b32 m0, 111616
    s_nop 0
    buffer_load_dwordx4 v236, s[16:19], s63 offen sc1 lds
    s_waitcnt vmcnt(35)
    s_cmp_eq_u32 s27, 0
    s_cbranch_scc1 L_sk4_13
    s_waitcnt vmcnt(20)
    v_cmp_ne_u32 vcc, s58, v4
    v_cmp_ne_u32 s[66:67], s58, v5
    s_or_b64 vcc, vcc, s[66:67]
    s_cbranch_vccnz L_re4_13
    ds_write_b32 v2, v3
    s_mov_b32 s27, 0
    s_branch L_sk4_13
L_re4_13:
L_sk4_13:
L_nc4:
    s_cmp_eq_u32 s27, 0
    s_cbranch_scc1 L_haveA
L_poll2n:
    s_mov_b32 s65, 0
L_poll2n_l:
    buffer_load_dwordx2 v[4:5], v6, s[44:47], s21 offen sc1
    s_waitcnt vmcnt(0)
    v_cmp_ne_u32_e64 vcc, s58, v4
    v_cmp_ne_u32 s[66:67], s58, v5
    s_or_b64 vcc, vcc, s[66:67]
    s_cbranch_vccz L_ret2p
    s_sleep 4
    s_add_u32 s65, s65, 1
    s_cmp_lt_u32 s65, 0x200000
    s_cbranch_scc1 L_poll2n_l
    s_branch L_ret2p
L_ret2p:
    ds_write_b32 v2, v3
L_haveA:
    s_mov_b32 s27, -1
    buffer_load_dwordx4 v[64:67], v232, s[12:15], s24 offen sc1
    buffer_load_dwordx4 v[68:71], v233, s[12:15], s24 offen sc1
    buffer_load_dwordx4 v[72:75], v234, s[12:15], s24 offen sc1
    buffer_load_dwordx4 v[76:79], v235, s[12:15], s24 offen sc1
    s_add_u32 s24, s24, 131072
    s_cmp_eq_u32 s24, s25
    s_cselect_b32 s24, s0, s24
    buffer_load_dwordx4 v[80:83], v232, s[12:15], s24 offen sc1
    buffer_load_dwordx4 v[84:87], v233, s[12:15], s24 offen sc1
    buffer_load_dwordx4 v[88:91], v234, s[12:15], s24 offen sc1
    buffer_load_dwordx4 v[92:95], v235, s[12:15], s24 offen sc1
    s_add_u32 s24, s24, 131072
    s_cmp_eq_u32 s24, s25
    s_cselect_b32 s24, s0, s24
    buffer_load_dwordx4 v[96:99], v232, s[12:15], s24 offen sc1
    buffer_load_dwordx4 v[100:103], v233, s[12:15], s24 offen sc1
    buffer_load_dwordx4 v[104:107], v234, s[12:15], s24 offen sc1
    buffer_load_dwordx4 v[108:111], v235, s[12:15], s24 offen sc1
    s_add_u32 s24, s24, 131072
    s_cmp_eq_u32 s24, s25
    s_cselect_b32 s24, s0, s24
    s_waitcnt vmcnt(12)
    ds_write_b32 v2, v3 offset:8
    s_cmp_eq_u32 s73, 1
    s_cbranch_scc1 L_gemm2
    ds_write_b32 v2, v3 offset:4
L_gemm2:
    s_waitcnt lgkmcnt(0)
    s_waitcnt vmcnt(11)
    v_mfma_f32_16x16x32_bf16 v[16:19], a[72:75], v[64:67], 0
    buffer_load_dwordx4 v[112:115], v232, s[12:15], s24 offen sc1
    v_mfma_f32_16x16x32_bf16 v[20:23], a[76:79], v[64:67], 0
    v_mfma_f32_16x16x32_bf16 v[24:27], a[80:83], v[64:67], 0
    v_mfma_f32_16x16x32_bf16 v[28:31], a[84:87], v[64:67], 0
    buffer_load_dwordx4 v[116:119], v233, s[12:15], s24 offen sc1
    v_mfma_f32_16x16x32_bf16 v[32:35], a[88:91], v[64:67], 0
    s_waitcnt vmcnt(12)
    v_mfma_f32_16x16x32_bf16 a[0:3], a[72:75], v[68:71], 0
    v_mfma_f32_16x16x32_bf16 a[4:7], a[76:79], v[68:71], 0
    v_mfma_f32_16x16x32_bf16 a[8:11], a[80:83], v[68:71], 0
    buffer_load_dwordx4 v[120:123], v234, s[12:15], s24 offen sc1
    v_mfma_f32_16x16x32_bf16 a[12:15], a[84:87], v[68:71], 0
    v_mfma_f32_16x16x32_bf16 a[16:19], a[88:91], v[68:71], 0
    s_waitcnt vmcnt(12)
    v_mfma_f32_16x16x32_bf16 a[20:23], a[72:75], v[72:75], 0
    v_mfma_f32_16x16x32_bf16 a[24:27], a[76:79], v[72:75], 0
    buffer_load_dwordx4 v[124:127], v235, s[12:15], s24 offen sc1
    v_mfma_f32_16x16x32_bf16 a[28:31], a[80:83], v[72:75], 0
    v_mfma_f32_16x16x32_bf16 a[32:35], a[84:87], v[72:75], 0
    v_mfma_f32_16x16x32_bf16 a[36:39], a[88:91], v[72:75], 0
    s_waitcnt vmcnt(12)
    v_mfma_f32_16x16x32_bf16 a[40:43], a[72:75], v[76:79], 0
    s_add_u32 s24, s24, 131072
    s_cmp_eq_u32 s24, s25
    s_cselect_b32 s24, s0, s24
    v_mfma_f32_16x16x32_bf16 a[44:47], a[76:79], v[76:79], 0
    v_mfma_f32_16x16x32_bf16 a[48:51], a[80:83], v[76:79], 0
    v_mfma_f32_16x16x32_bf16 a[52:55], a[84:87], v[76:79], 0
    v_mfma_f32_16x16x32_bf16 a[56:59], a[88:91], v[76:79], 0
    s_waitcnt vmcnt(11)
    v_mfma_f32_16x16x32_bf16 v[16:19], a[92:95], v[80:83], v[16:19]
    buffer_load_dwordx4 v[128:131], v232, s[12:15], s24 offen sc1
    s_waitcnt vmcnt(11)
    v_mfma_f32_16x16x32_bf16 a[0:3], a[92:95], v[84:87], a[0:3]
    s_waitcnt vmcnt(10)
    v_mfma_f32_16x16x32_bf16 a[20:23], a[92:95], v[88:91], a[20:23]
    v_min_u32 v9, 39, v1
    s_waitcnt vmcnt(9)
    v_mfma_f32_16x16x32_bf16 a[40:43], a[92:95], v[92:95], a[40:43]
    buffer_load_dwordx4 v[132:135], v233, s[12:15], s24 offen sc1
    v_mfma_f32_16x16x32_bf16 v[20:23], a[96:99], v[80:83], v[20:23]
    v_lshlrev_b32_e64 v9, 7, v9
    v_mfma_f32_16x16x32_bf16 a[4:7], a[96:99], v[84:87], a[4:7]
    v_mfma_f32_16x16x32_bf16 a[24:27], a[96:99], v[88:91], a[24:27]
    v_lshrrev_b32_e64 v12, 3, v1
    v_mfma_f32_16x16x32_bf16 a[44:47], a[96:99], v[92:95], a[44:47]
    buffer_load_dwordx4 v[136:139], v234, s[12:15], s24 offen sc1
    v_lshlrev_b32 v12, 12, v12
    v_mfma_f32_16x16x32_bf16 v[24:27], a[100:103], v[80:83], v[24:27]
    v_mfma_f32_16x16x32_bf16 a[8:11], a[100:103], v[84:87], a[8:11]
    v_and_b32 v13, 7, v1
    v_mfma_f32_16x16x32_bf16 a[28:31], a[100:103], v[88:91], a[28:31]
    v_mfma_f32_16x16x32_bf16 a[48:51], a[100:103], v[92:95], a[48:51]
    buffer_load_dwordx4 v[140:143], v235, s[12:15], s24 offen sc1
    v_lshl_add_u32 v12, v13, 4, v12
    v_mfma_f32_16x16x32_bf16 v[28:31], a[104:107], v[80:83], v[28:31]
    v_mfma_f32_16x16x32_bf16 a[12:15], a[104:107], v[84:87], a[12:15]
    v_add_u32_e64 v48, s74, v223
    v_mfma_f32_16x16x32_bf16 a[32:35], a[104:107], v[88:91], a[32:35]
    v_mfma_f32_16x16x32_bf16 a[52:55], a[104:107], v[92:95], a[52:55]
    s_add_u32 s24, s24, 131072
    s_cmp_eq_u32 s24, s25
    s_cselect_b32 s24, s0, s24
    v_add_u32 v49, 61440, v48
    v_mfma_f32_16x16x32_bf16 v[32:35], a[108:111], v[80:83], v[32:35]
    v_mfma_f32_16x16x32_bf16 a[16:19], a[108:111], v[84:87], a[16:19]
    s_sub_u32 s60, s52, 1
    v_mfma_f32_16x16x32_bf16 a[36:39], a[108:111], v[88:91], a[36:39]
    v_mfma_f32_16x16x32_bf16 a[56:59], a[108:111], v[92:95], a[56:59]
    s_waitcnt vmcnt(8)
    v_mov_b32 v4, 0
    v_mov_b32 v5, s58
    s_mov_b64 exec, 1
    buffer_store_dword v5, v4, s[44:47], s10 offen sc1
    s_mov_b64 exec, -1
    s_and_b32 s60, s60, 3
    v_mfma_f32_16x16x32_bf16 v[16:19], a[112:115], v[96:99], v[16:19]
    buffer_load_dwordx4 v[144:147], v232, s[12:15], s24 offen sc1
    v_mfma_f32_16x16x32_bf16 a[0:3], a[112:115], v[100:103], a[0:3]
    s_nop 0
    v_mfma_f32_16x16x32_bf16 a[20:23], a[112:115], v[104:107], a[20:23]
    s_mul_i32 s60, s60, 5120
    v_mfma_f32_16x16x32_bf16 a[40:43], a[112:115], v[108:111], a[40:43]
    buffer_load_dwordx4 v[148:151], v233, s[12:15], s24 offen sc1
    v_mfma_f32_16x16x32_bf16 v[20:23], a[116:119], v[96:99], v[20:23]
    s_add_u32 s60, s60, 61440
    v_mfma_f32_16x16x32_bf16 a[4:7], a[116:119], v[100:103], a[4:7]
    v_mfma_f32_16x16x32_bf16 a[24:27], a[116:119], v[104:107], a[24:27]
    v_add_u32 v50, s60, v223
    v_mfma_f32_16x16x32_bf16 a[44:47], a[116:119], v[108:111], a[44:47]
    buffer_load_dwordx4 v[152:155], v234, s[12:15], s24 offen sc1
    s_sub_u32 s60, s52, 2
    v_mfma_f32_16x16x32_bf16 v[24:27], a[120:123], v[96:99], v[24:27]
    v_mfma_f32_16x16x32_bf16 a[8:11], a[120:123], v[100:103], a[8:11]
    s_and_b32 s60, s60, 3
    v_mfma_f32_16x16x32_bf16 a[28:31], a[120:123], v[104:107], a[28:31]
    buffer_load_dword v36, v239, s[44:47], s20 offen sc1
    s_nop 0
    v_mfma_f32_16x16x32_bf16 a[48:51], a[120:123], v[108:111], a[48:51]
    buffer_load_dwordx4 v[156:159], v235, s[12:15], s24 offen sc1
    s_mul_i32 s60, s60, 5120
    v_mfma_f32_16x16x32_bf16 v[28:31], a[124:127], v[96:99], v[28:31]
    ds_read2_b32 v[14:15], v2 offset0:1 offset1:2
    v_mfma_f32_16x16x32_bf16 a[12:15], a[124:127], v[100:103], a[12:15]
    s_add_u32 s60, s60, 92160
    v_mfma_f32_16x16x32_bf16 a[32:35], a[124:127], v[104:107], a[32:35]
    v_mfma_f32_16x16x32_bf16 a[52:55], a[124:127], v[108:111], a[52:55]
    s_add_u32 s24, s24, 131072
    s_cmp_eq_u32 s24, s25
    s_cselect_b32 s24, s0, s24
    v_add_u32_e64 v51, s60, v223
    v_mfma_f32_16x16x32_bf16 v[32:35], a[128:131], v[96:99], v[32:35]
    v_mfma_f32_16x16x32_bf16 a[16:19], a[128:131], v[100:103], a[16:19]
    s_sub_u32 s60, s52, 3
    v_mfma_f32_16x16x32_bf16 a[36:39], a[128:131], v[104:107], a[36:39]
    v_mfma_f32_16x16x32_bf16 a[56:59], a[128:131], v[108:111], a[56:59]
    s_and_b32 s60, s60, 3
    s_waitcnt vmcnt(13)
    v_mfma_f32_16x16x32_bf16 v[16:19], a[132:135], v[112:115], v[16:19]
    buffer_load_dwordx4 v[160:163], v232, s[12:15], s24 offen sc1
    s_waitcnt vmcnt(13)
    v_mfma_f32_16x16x32_bf16 a[0:3], a[132:135], v[116:119], a[0:3]
    s_waitcnt lgkmcnt(0)
    v_and_b32 v14, v14, v15
    v_cmp_ne_u32 vcc, 1, v14
    s_cbranch_vccnz L_pollB
L_retB:
    ds_read_b128 a[72:75], v221 offset:0
    s_waitcnt vmcnt(12)
    v_mfma_f32_16x16x32_bf16 a[20:23], a[132:135], v[120:123], a[20:23]
    s_mul_i32 s60, s60, 5120
    s_waitcnt vmcnt(11)
    v_mfma_f32_16x16x32_bf16 a[40:43], a[132:135], v[124:127], a[40:43]
    buffer_load_dwordx4 v[164:167], v233, s[12:15], s24 offen sc1
    v_mfma_f32_16x16x32_bf16 v[20:23], a[136:139], v[112:115], v[20:23]
    s_add_u32 s60, s60, 30720
    v_mfma_f32_16x16x32_bf16 a[4:7], a[136:139], v[116:119], a[4:7]
    ds_read_b128 a[76:79], v221 offset:1024
    v_mfma_f32_16x16x32_bf16 a[24:27], a[136:139], v[120:123], a[24:27]
    v_add_u32_e64 v52, s60, v223
    v_mfma_f32_16x16x32_bf16 a[44:47], a[136:139], v[124:127], a[44:47]
    buffer_load_dwordx4 v[168:171], v234, s[12:15], s24 offen sc1
    v_lshrrev_b32_e64 v7, 4, v1
    v_mfma_f32_16x16x32_bf16 v[24:27], a[140:143], v[112:115], v[24:27]
    v_mfma_f32_16x16x32_bf16 a[8:11], a[140:143], v[116:119], a[8:11]
    ds_read_b128 a[80:83], v221 offset:2048
    v_bfe_u32 v5, v1, 2, 2
    v_mfma_f32_16x16x32_bf16 a[28:31], a[140:143], v[120:123], a[28:31]
    v_mfma_f32_16x16x32_bf16 a[48:51], a[140:143], v[124:127], a[48:51]
    buffer_load_dwordx4 v[172:175], v235, s[12:15], s24 offen sc1
    v_and_b32_e64 v6, 3, v1
    v_mfma_f32_16x16x32_bf16 v[28:31], a[144:147], v[112:115], v[28:31]
    v_mfma_f32_16x16x32_bf16 a[12:15], a[144:147], v[116:119], a[12:15]
    ds_read_b128 a[84:87], v221 offset:3072
    v_lshlrev_b32_e64 v5, 7, v5
    v_mfma_f32_16x16x32_bf16 a[32:35], a[144:147], v[120:123], a[32:35]
    v_mfma_f32_16x16x32_bf16 a[52:55], a[144:147], v[124:127], a[52:55]
    s_add_u32 s24, s24, 131072
    s_cmp_eq_u32 s24, s25
    s_cselect_b32 s24, s0, s24
    v_lshl_add_u32 v5, v6, 3, v5
    v_mfma_f32_16x16x32_bf16 v[32:35], a[148:151], v[112:115], v[32:35]
    v_mfma_f32_16x16x32_bf16 a[16:19], a[148:151], v[116:119], a[16:19]
    ds_read_b128 a[88:91], v221 offset:4096
    s_lshl_b32 s60, s52, 5
    v_mfma_f32_16x16x32_bf16 a[36:39], a[148:151], v[120:123], a[36:39]
    v_mfma_f32_16x16x32_bf16 a[56:59], a[148:151], v[124:127], a[56:59]
    v_add_u32 v5, s60, v5
    s_waitcnt vmcnt(13)
    v_mfma_f32_16x16x32_bf16 v[16:19], a[152:155], v[128:131], v[16:19]
    buffer_load_dwordx4 v[176:179], v232, s[12:15], s24 offen sc1
    s_waitcnt vmcnt(13)
    v_mfma_f32_16x16x32_bf16 a[0:3], a[152:155], v[132:135], a[0:3]
    ds_read_b128 a[92:95], v224 offset:0
    s_waitcnt vmcnt(12)
    v_mfma_f32_16x16x32_bf16 a[20:23], a[152:155], v[136:139], a[20:23]
    v_lshl_add_u32 v4, v7, 9, v5
    s_waitcnt vmcnt(11)
    v_mfma_f32_16x16x32_bf16 a[40:43], a[152:155], v[140:143], a[40:43]
    buffer_load_dwordx4 v[180:183], v233, s[12:15], s24 offen sc1
    v_mfma_f32_16x16x32_bf16 v[20:23], a[156:159], v[128:131], v[20:23]
    v_add_u32 v53, 15360, v4
    v_mfma_f32_16x16x32_bf16 a[4:7], a[156:159], v[132:135], a[4:7]
    ds_read_b128 a[96:99], v224 offset:1024
    v_mfma_f32_16x16x32_bf16 a[24:27], a[156:159], v[136:139], a[24:27]
    v_lshl_add_u32 v4, v7, 9, v5
    v_mfma_f32_16x16x32_bf16 a[44:47], a[156:159], v[140:143], a[44:47]
    buffer_load_dwordx4 v[184:187], v234, s[12:15], s24 offen sc1
    v_add_u32 v54, 17408, v4
    v_mfma_f32_16x16x32_bf16 v[24:27], a[160:163], v[128:131], v[24:27]
    v_mfma_f32_16x16x32_bf16 a[8:11], a[160:163], v[132:135], a[8:11]
    ds_read_b128 a[100:103], v224 offset:2048
    v_lshl_add_u32 v4, v7, 9, v5
    v_mfma_f32_16x16x32_bf16 a[28:31], a[160:163], v[136:139], a[28:31]
    v_mfma_f32_16x16x32_bf16 a[48:51], a[160:163], v[140:143], a[48:51]
    buffer_load_dwordx4 v[188:191], v235, s[12:15], s24 offen sc1
    v_lshrrev_b32_e64 v6, 1, v7
    v_mfma_f32_16x16x32_bf16 v[28:31], a[164:167], v[128:131], v[28:31]
    v_mfma_f32_16x16x32_bf16 a[12:15], a[164:167], v[132:135], a[12:15]
    ds_read_b128 a[104:107], v224 offset:3072
    v_mul_u32_u24 v6, 35840, v6
    v_mfma_f32_16x16x32_bf16 a[32:35], a[164:167], v[136:139], a[32:35]
    v_mfma_f32_16x16x32_bf16 a[52:55], a[164:167], v[140:143], a[52:55]
    s_add_u32 s24, s24, 131072
    s_cmp_eq_u32 s24, s25
    s_cselect_b32 s24, s0, s24
    v_add_u32_e64 v4, v4, v6
    v_mfma_f32_16x16x32_bf16 v[32:35], a[168:171], v[128:131], v[32:35]
    v_mfma_f32_16x16x32_bf16 a[16:19], a[168:171], v[132:135], a[16:19]
    ds_read_b128 a[108:111], v224 offset:4096
    v_add_u32 v55, 19456, v4
    v_mfma_f32_16x16x32_bf16 a[36:39], a[168:171], v[136:139], a[36:39]
    v_mfma_f32_16x16x32_bf16 a[56:59], a[168:171], v[140:143], a[56:59]
    v_lshl_add_u32 v4, v7, 9, v5
    s_waitcnt vmcnt(12)
    v_mfma_f32_16x16x32_bf16 v[16:19], a[172:175], v[144:147], v[16:19]
    buffer_load_dwordx4 v[64:67], v232, s[12:15], s24 offen sc1
    s_waitcnt vmcnt(12)
    v_mfma_f32_16x16x32_bf16 a[0:3], a[172:175], v[148:151], a[0:3]
    ds_read_b128 a[112:115], v224 offset:30720
    s_waitcnt vmcnt(11)
    v_mfma_f32_16x16x32_bf16 a[20:23], a[172:175], v[152:155], a[20:23]
    v_add_u32 v56, 57344, v4
    s_waitcnt vmcnt(9)
    v_mfma_f32_16x16x32_bf16 a[40:43], a[172:175], v[156:159], a[40:43]
    buffer_load_dwordx4 v[68:71], v233, s[12:15], s24 offen sc1
    v_mfma_f32_16x16x32_bf16 v[20:23], a[176:179], v[144:147], v[20:23]
    v_lshl_add_u32 v4, v7, 9, v5
    v_mfma_f32_16x16x32_bf16 a[4:7], a[176:179], v[148:151], a[4:7]
    ds_read_b128 a[116:119], v224 offset:31744
    v_mfma_f32_16x16x32_bf16 a[24:27], a[176:179], v[152:155], a[24:27]
    v_mfma_f32_16x16x32_bf16 a[44:47], a[176:179], v[156:159], a[44:47]
    v_add_u32 v57, 59392, v4
    buffer_load_dwordx4 v[72:75], v234, s[12:15], s24 offen sc1
    v_mfma_f32_16x16x32_bf16 v[24:27], a[180:183], v[144:147], v[24:27]
    v_mfma_f32_16x16x32_bf16 a[8:11], a[180:183], v[148:151], a[8:11]
    ds_read_b128 a[120:123], v224 offset:32768
    v_and_b32_e64 v4, 15, v1
    v_mfma_f32_16x16x32_bf16 a[28:31], a[180:183], v[152:155], a[28:31]
    v_mfma_f32_16x16x32_bf16 a[48:51], a[180:183], v[156:159], a[48:51]
    buffer_load_dwordx4 v[76:79], v235, s[12:15], s24 offen sc1
    v_mfma_f32_16x16x32_bf16 v[28:31], a[184:187], v[144:147], v[28:31]
    v_mul_u32_u24 v4, 160, v4
    v_mfma_f32_16x16x32_bf16 a[12:15], a[184:187], v[148:151], a[12:15]
    ds_read_b128 a[124:127], v224 offset:33792
    v_mfma_f32_16x16x32_bf16 a[32:35], a[184:187], v[152:155], a[32:35]
    v_lshl_add_u32 v4, v7, 3, v4
    v_mfma_f32_16x16x32_bf16 a[52:55], a[184:187], v[156:159], a[52:55]
    s_add_u32 s24, s24, 131072
    s_cmp_eq_u32 s24, s25
    s_cselect_b32 s24, s0, s24
    v_mfma_f32_16x16x32_bf16 v[32:35], a[188:191], v[144:147], v[32:35]
    v_mfma_f32_16x16x32_bf16 a[16:19], a[188:191], v[148:151], a[16:19]
    ds_read_b128 a[128:131], v224 offset:34816
    v_add_u32 v58, s75, v4
    v_mfma_f32_16x16x32_bf16 a[36:39], a[188:191], v[152:155], a[36:39]
    v_mfma_f32_16x16x32_bf16 a[56:59], a[188:191], v[156:159], a[56:59]
    v_add_u32 v59, s75, v223
    s_waitcnt vmcnt(11)
    v_mfma_f32_16x16x32_bf16 v[16:19], a[192:195], v[160:163], v[16:19]
    buffer_load_dwordx4 v[80:83], v232, s[12:15], s24 offen sc1
    s_waitcnt vmcnt(11)
    v_mfma_f32_16x16x32_bf16 a[0:3], a[192:195], v[164:167], a[0:3]
    ds_read_b128 a[132:135], v226 offset:0
    s_waitcnt vmcnt(10)
    v_mfma_f32_16x16x32_bf16 a[20:23], a[192:195], v[168:171], a[20:23]
    s_waitcnt vmcnt(9)
    v_mfma_f32_16x16x32_bf16 a[40:43], a[192:195], v[172:175], a[40:43]
    buffer_load_dwordx4 v[84:87], v233, s[12:15], s24 offen sc1
    v_mfma_f32_16x16x32_bf16 v[20:23], a[196:199], v[160:163], v[20:23]
    v_mfma_f32_16x16x32_bf16 a[4:7], a[196:199], v[164:167], a[4:7]
    ds_read_b128 a[136:139], v226 offset:1024
    v_mfma_f32_16x16x32_bf16 a[24:27], a[196:199], v[168:171], a[24:27]
    v_mfma_f32_16x16x32_bf16 a[44:47], a[196:199], v[172:175], a[44:47]
    buffer_load_dwordx4 v[88:91], v234, s[12:15], s24 offen sc1
    v_mfma_f32_16x16x32_bf16 v[24:27], a[200:203], v[160:163], v[24:27]
    v_mfma_f32_16x16x32_bf16 a[8:11], a[200:203], v[164:167], a[8:11]
    ds_read_b128 a[140:143], v226 offset:2048
    v_mfma_f32_16x16x32_bf16 a[28:31], a[200:203], v[168:171], a[28:31]
    v_mfma_f32_16x16x32_bf16 a[48:51], a[200:203], v[172:175], a[48:51]
    buffer_load_dwordx4 v[92:95], v235, s[12:15], s24 offen sc1
    v_mfma_f32_16x16x32_bf16 v[28:31], a[204:207], v[160:163], v[28:31]
    v_mfma_f32_16x16x32_bf16 a[12:15], a[204:207], v[164:167], a[12:15]
    ds_read_b128 a[144:147], v226 offset:3072
    v_mfma_f32_16x16x32_bf16 a[32:35], a[204:207], v[168:171], a[32:35]
    v_mfma_f32_16x16x32_bf16 a[52:55], a[204:207], v[172:175], a[52:55]
    s_add_u32 s24, s24, 131072
    s_cmp_eq_u32 s24, s25
    s_cselect_b32 s24, s0, s24
    v_mfma_f32_16x16x32_bf16 v[32:35], a[208:211], v[160:163], v[32:35]
    v_mfma_f32_16x16x32_bf16 a[16:19], a[208:211], v[164:167], a[16:19]
    ds_read_b128 a[148:151], v226 offset:4096
    v_mfma_f32_16x16x32_bf16 a[36:39], a[208:211], v[168:171], a[36:39]
    v_mfma_f32_16x16x32_bf16 a[56:59], a[208:211], v[172:175], a[56:59]
    s_waitcnt vmcnt(11)
    v_mfma_f32_16x16x32_bf16 v[16:19], a[212:215], v[176:179], v[16:19]
    buffer_load_dwordx4 v[96:99], v232, s[12:15], s24 offen sc1
    s_waitcnt vmcnt(11)
    v_mfma_f32_16x16x32_bf16 a[0:3], a[212:215], v[180:183], a[0:3]
    ds_read_b128 a[152:155], v225 offset:0
    s_waitcnt vmcnt(10)
    v_mfma_f32_16x16x32_bf16 a[20:23], a[212:215], v[184:187], a[20:23]
    s_waitcnt lgkmcnt(1)
    s_add_u32 m0, s75, 61440
    s_nop 0
    buffer_load_dwordx4 v216, s[32:35], s79 offen lds
    s_waitcnt vmcnt(10)
    v_mfma_f32_16x16x32_bf16 a[40:43], a[212:215], v[188:191], a[40:43]
    buffer_load_dwordx4 v[100:103], v233, s[12:15], s24 offen sc1
    v_mfma_f32_16x16x32_bf16 v[20:23], a[216:219], v[176:179], v[20:23]
    v_mfma_f32_16x16x32_bf16 a[4:7], a[216:219], v[180:183], a[4:7]
    ds_read_b128 a[156:159], v225 offset:1024
    v_mfma_f32_16x16x32_bf16 a[24:27], a[216:219], v[184:187], a[24:27]
    v_mfma_f32_16x16x32_bf16 a[44:47], a[216:219], v[188:191], a[44:47]
    buffer_load_dwordx4 v[104:107], v234, s[12:15], s24 offen sc1
    v_mfma_f32_16x16x32_bf16 v[24:27], a[220:223], v[176:179], v[24:27]
    v_mfma_f32_16x16x32_bf16 a[8:11], a[220:223], v[180:183], a[8:11]
    s_add_u32 m0, s75, 62464
    s_nop 0
    buffer_load_dwordx4 v217, s[32:35], s79 offen lds
    s_nop 0
    ds_read_b128 a[160:163], v225 offset:2048
    v_mfma_f32_16x16x32_bf16 a[28:31], a[220:223], v[184:187], a[28:31]
    v_mfma_f32_16x16x32_bf16 a[48:51], a[220:223], v[188:191], a[48:51]
    buffer_load_dwordx4 v[108:111], v235, s[12:15], s24 offen sc1
    v_mfma_f32_16x16x32_bf16 v[28:31], a[224:227], v[176:179], v[28:31]
    v_mfma_f32_16x16x32_bf16 a[12:15], a[224:227], v[180:183], a[12:15]
    ds_read_b128 a[164:167], v225 offset:3072
    v_mfma_f32_16x16x32_bf16 a[32:35], a[224:227], v[184:187], a[32:35]
    v_mfma_f32_16x16x32_bf16 a[52:55], a[224:227], v[188:191], a[52:55]
    s_add_u32 s24, s24, 131072
    s_cmp_eq_u32 s24, s25
    s_cselect_b32 s24, s0, s24
    v_mfma_f32_16x16x32_bf16 v[32:35], a[228:231], v[176:179], v[32:35]
    s_add_u32 m0, s75, 63488
    s_mov_b64 exec, 0xffffffff
    buffer_load_dwordx4 v218, s[32:35], s79 offen lds
    s_mov_b64 exec, -1
    v_mfma_f32_16x16x32_bf16 a[16:19], a[228:231], v[180:183], a[16:19]
    ds_read_b128 a[168:171], v225 offset:4096
    v_mfma_f32_16x16x32_bf16 a[36:39], a[228:231], v[184:187], a[36:39]
    v_mfma_f32_16x16x32_bf16 a[56:59], a[228:231], v[188:191], a[56:59]
    s_waitcnt vmcnt(14)
    v_mfma_f32_16x16x32_bf16 v[16:19], a[72:75], v[64:67], v[16:19]
    buffer_load_dwordx4 v[112:115], v232, s[12:15], s24 offen sc1
    s_waitcnt vmcnt(14)
    v_mfma_f32_16x16x32_bf16 a[0:3], a[72:75], v[68:71], a[0:3]
    ds_read_b128 a[172:175], v225 offset:30720
    s_waitcnt vmcnt(13)
    v_mfma_f32_16x16x32_bf16 a[20:23], a[72:75], v[72:75], a[20:23]
    s_waitcnt vmcnt(12)
    v_mfma_f32_16x16x32_bf16 a[40:43], a[72:75], v[76:79], a[40:43]
    s_nop 0
    buffer_load_dwordx4 v[116:119], v233, s[12:15], s24 offen sc1
    v_mfma_f32_16x16x32_bf16 v[20:23], a[76:79], v[64:67], v[20:23]
    v_mfma_f32_16x16x32_bf16 a[4:7], a[76:79], v[68:71], a[4:7]
    ds_read_b128 a[176:179], v225 offset:31744
    v_mfma_f32_16x16x32_bf16 a[24:27], a[76:79], v[72:75], a[24:27]
    v_mfma_f32_16x16x32_bf16 a[44:47], a[76:79], v[76:79], a[44:47]
    buffer_load_dwordx4 v[120:123], v234, s[12:15], s24 offen sc1
    v_mfma_f32_16x16x32_bf16 v[24:27], a[80:83], v[64:67], v[24:27]
    v_mfma_f32_16x16x32_bf16 a[8:11], a[80:83], v[68:71], a[8:11]
    ds_read_b128 a[180:183], v225 offset:32768
    v_mfma_f32_16x16x32_bf16 a[28:31], a[80:83], v[72:75], a[28:31]
    v_mfma_f32_16x16x32_bf16 a[48:51], a[80:83], v[76:79], a[48:51]
    buffer_load_dwordx4 v[124:127], v235, s[12:15], s24 offen sc1
    v_mfma_f32_16x16x32_bf16 v[28:31], a[84:87], v[64:67], v[28:31]
    v_mfma_f32_16x16x32_bf16 a[12:15], a[84:87], v[68:71], a[12:15]
    ds_read_b128 a[184:187], v225 offset:33792
    v_mfma_f32_16x16x32_bf16 a[32:35], a[84:87], v[72:75], a[32:35]
    v_mfma_f32_16x16x32_bf16 a[52:55], a[84:87], v[76:79], a[52:55]
    s_add_u32 s24, s24, 131072
    s_cmp_eq_u32 s24, s25
    s_cselect_b32 s24, s0, s24
    v_mfma_f32_16x16x32_bf16 v[32:35], a[88:91], v[64:67], v[32:35]
    v_mfma_f32_16x16x32_bf16 a[16:19], a[88:91], v[68:71], a[16:19]
    ds_read_b128 a[188:191], v225 offset:34816
    v_mfma_f32_16x16x32_bf16 a[36:39], a[88:91], v[72:75], a[36:39]
    v_mfma_f32_16x16x32_bf16 a[56:59], a[88:91], v[76:79], a[56:59]
    s_waitcnt vmcnt(14)
    v_mfma_f32_16x16x32_bf16 v[16:19], a[92:95], v[80:83], v[16:19]
    buffer_load_dwordx4 v[128:131], v232, s[12:15], s24 offen sc1
    s_waitcnt vmcnt(14)
    v_mfma_f32_16x16x32_bf16 a[0:3], a[92:95], v[84:87], a[0:3]
    s_waitcnt vmcnt(13)
    v_mfma_f32_16x16x32_bf16 a[20:23], a[92:95], v[88:91], a[20:23]
    s_waitcnt vmcnt(12)
    v_mfma_f32_16x16x32_bf16 a[40:43], a[92:95], v[92:95], a[40:43]
    buffer_load_dwordx4 v[132:135], v233, s[12:15], s24 offen sc1
    v_mfma_f32_16x16x32_bf16 v[20:23], a[96:99], v[80:83], v[20:23]
    s_mov_b64 exec, s[26:27]
    buffer_load_dwordx2 v[10:11], v9, s[44:47], s22 offen sc1
    s_mov_b64 exec, -1
    v_mfma_f32_16x16x32_bf16 a[4:7], a[96:99], v[84:87], a[4:7]
    v_mfma_f32_16x16x32_bf16 a[24:27], a[96:99], v[88:91], a[24:27]
    v_mfma_f32_16x16x32_bf16 a[44:47], a[96:99], v[92:95], a[44:47]
    buffer_load_dwordx4 v[136:139], v234, s[12:15], s24 offen sc1
    v_mfma_f32_16x16x32_bf16 v[24:27], a[100:103], v[80:83], v[24:27]
    v_mfma_f32_16x16x32_bf16 a[8:11], a[100:103], v[84:87], a[8:11]
    v_mfma_f32_16x16x32_bf16 a[28:31], a[100:103], v[88:91], a[28:31]
    v_mfma_f32_16x16x32_bf16 a[48:51], a[100:103], v[92:95], a[48:51]
    buffer_load_dwordx4 v[140:143], v235, s[12:15], s24 offen sc1
    v_mfma_f32_16x16x32_bf16 v[28:31], a[104:107], v[80:83], v[28:31]
    v_mfma_f32_16x16x32_bf16 a[12:15], a[104:107], v[84:87], a[12:15]
    v_mfma_f32_16x16x32_bf16 a[32:35], a[104:107], v[88:91], a[32:35]
    v_mfma_f32_16x16x32_bf16 a[52:55], a[104:107], v[92:95], a[52:55]
    s_add_u32 s24, s24, 131072
    s_cmp_eq_u32 s24, s25
    s_cselect_b32 s24, s0, s24
    v_mfma_f32_16x16x32_bf16 v[32:35], a[108:111], v[80:83], v[32:35]
    v_mfma_f32_16x16x32_bf16 a[16:19], a[108:111], v[84:87], a[16:19]
    v_mfma_f32_16x16x32_bf16 a[36:39], a[108:111], v[88:91], a[36:39]
    v_mfma_f32_16x16x32_bf16 a[56:59], a[108:111], v[92:95], a[56:59]
    s_waitcnt vmcnt(14)
    v_mfma_f32_16x16x32_bf16 v[16:19], a[112:115], v[96:99], v[16:19]
    buffer_load_dwordx4 v[144:147], v232, s[12:15], s24 offen sc1
    s_waitcnt vmcnt(13)
    v_mfma_f32_16x16x32_bf16 a[0:3], a[112:115], v[100:103], a[0:3]
    s_waitcnt vmcnt(12)
    v_mfma_f32_16x16x32_bf16 a[20:23], a[112:115], v[104:107], a[20:23]
    s_waitcnt vmcnt(10)
    v_mfma_f32_16x16x32_bf16 a[40:43], a[112:115], v[108:111], a[40:43]
    v_mfma_f32_16x16x32_bf16 v[20:23], a[116:119], v[96:99], v[20:23]
    v_mfma_f32_16x16x32_bf16 a[4:7], a[116:119], v[100:103], a[4:7]
    buffer_load_dwordx4 v[148:151], v233, s[12:15], s24 offen sc1
    v_mfma_f32_16x16x32_bf16 a[24:27], a[116:119], v[104:107], a[24:27]
    v_mfma_f32_16x16x32_bf16 a[44:47], a[116:119], v[108:111], a[44:47]
    v_mfma_f32_16x16x32_bf16 v[24:27], a[120:123], v[96:99], v[24:27]
    v_mfma_f32_16x16x32_bf16 a[8:11], a[120:123], v[100:103], a[8:11]
    v_mfma_f32_16x16x32_bf16 a[28:31], a[120:123], v[104:107], a[28:31]
    buffer_load_dwordx4 v[152:155], v234, s[12:15], s24 offen sc1
    v_mfma_f32_16x16x32_bf16 a[48:51], a[120:123], v[108:111], a[48:51]
    v_mfma_f32_16x16x32_bf16 v[28:31], a[124:127], v[96:99], v[28:31]
    v_mfma_f32_16x16x32_bf16 a[12:15], a[124:127], v[100:103], a[12:15]
    v_mfma_f32_16x16x32_bf16 a[32:35], a[124:127], v[104:107], a[32:35]
    v_mfma_f32_16x16x32_bf16 a[52:55], a[124:127], v[108:111], a[52:55]
    buffer_load_dwordx4 v[156:159], v235, s[12:15], s24 offen sc1
    v_mfma_f32_16x16x32_bf16 v[32:35], a[128:131], v[96:99], v[32:35]
    v_mfma_f32_16x16x32_bf16 a[16:19], a[128:131], v[100:103], a[16:19]
    v_mfma_f32_16x16x32_bf16 a[36:39], a[128:131], v[104:107], a[36:39]
    v_mfma_f32_16x16x32_bf16 a[56:59], a[128:131], v[108:111], a[56:59]
    s_waitcnt vmcnt(11)
    v_mfma_f32_16x16x32_bf16 v[16:19], a[132:135], v[112:115], v[16:19]
    s_waitcnt vmcnt(10)
    v_mfma_f32_16x16x32_bf16 a[0:3], a[132:135], v[116:119], a[0:3]
    s_waitcnt vmcnt(9)
    v_mfma_f32_16x16x32_bf16 a[20:23], a[132:135], v[120:123], a[20:23]
    s_waitcnt vmcnt(8)
    v_mfma_f32_16x16x32_bf16 a[40:43], a[132:135], v[124:127], a[40:43]
    v_mfma_f32_16x16x32_bf16 v[20:23], a[136:139], v[112:115], v[20:23]
    v_mfma_f32_16x16x32_bf16 a[4:7], a[136:139], v[116:119], a[4:7]
    v_mfma_f32_16x16x32_bf16 a[24:27], a[136:139], v[120:123], a[24:27]
    v_mfma_f32_16x16x32_bf16 a[44:47], a[136:139], v[124:127], a[44:47]
    v_mfma_f32_16x16x32_bf16 v[24:27], a[140:143], v[112:115], v[24:27]
    v_mfma_f32_16x16x32_bf16 a[8:11], a[140:143], v[116:119], a[8:11]
    v_mfma_f32_16x16x32_bf16 a[28:31], a[140:143], v[120:123], a[28:31]
    v_mfma_f32_16x16x32_bf16 a[48:51], a[140:143], v[124:127], a[48:51]
    v_mfma_f32_16x16x32_bf16 v[28:31], a[144:147], v[112:115], v[28:31]
    v_mfma_f32_16x16x32_bf16 a[12:15], a[144:147], v[116:119], a[12:15]
    v_mfma_f32_16x16x32_bf16 a[32:35], a[144:147], v[120:123], a[32:35]
    v_mfma_f32_16x16x32_bf16 a[52:55], a[144:147], v[124:127], a[52:55]
    v_mfma_f32_16x16x32_bf16 v[32:35], a[148:151], v[112:115], v[32:35]
    v_mfma_f32_16x16x32_bf16 a[16:19], a[148:151], v[116:119], a[16:19]
    v_mfma_f32_16x16x32_bf16 a[36:39], a[148:151], v[120:123], a[36:39]
    v_mfma_f32_16x16x32_bf16 a[56:59], a[148:151], v[124:127], a[56:59]
    s_cmp_lg_u32 s26, 0
    s_cbranch_scc1 L_chk3
L_chk3r:
    s_waitcnt vmcnt(6)
    s_waitcnt lgkmcnt(0)
    v_mfma_f32_16x16x32_bf16 a[0:3], a[152:155], v[132:135], a[0:3]
    v_mfma_f32_16x16x32_bf16 a[4:7], a[156:159], v[132:135], a[4:7]
    v_mfma_f32_16x16x32_bf16 a[8:11], a[160:163], v[132:135], a[8:11]
    v_mfma_f32_16x16x32_bf16 a[12:15], a[164:167], v[132:135], a[12:15]
    v_mfma_f32_16x16x32_bf16 a[16:19], a[168:171], v[132:135], a[16:19]
    s_waitcnt vmcnt(2)
    v_mfma_f32_16x16x32_bf16 a[0:3], a[172:175], v[148:151], a[0:3]
    s_nop 0
    v_mfma_f32_16x16x32_bf16 a[4:7], a[176:179], v[148:151], a[4:7]
    v_mfma_f32_16x16x32_bf16 a[8:11], a[180:183], v[148:151], a[8:11]
    v_mfma_f32_16x16x32_bf16 a[12:15], a[184:187], v[148:151], a[12:15]
    v_mfma_f32_16x16x32_bf16 a[16:19], a[188:191], v[148:151], a[16:19]
    v_mfma_f32_16x16x32_bf16 a[20:23], a[152:155], v[136:139], a[20:23]
    v_mfma_f32_16x16x32_bf16 a[24:27], a[156:159], v[136:139], a[24:27]
    v_mfma_f32_16x16x32_bf16 a[28:31], a[160:163], v[136:139], a[28:31]
    v_mfma_f32_16x16x32_bf16 a[32:35], a[164:167], v[136:139], a[32:35]
    v_mfma_f32_16x16x32_bf16 a[36:39], a[168:171], v[136:139], a[36:39]
    s_waitcnt vmcnt(1)
    v_mfma_f32_16x16x32_bf16 a[20:23], a[172:175], v[152:155], a[20:23]
    ds_write_b128 v49, a[0:3] offset:0
    s_nop 0
    v_mfma_f32_16x16x32_bf16 a[24:27], a[176:179], v[152:155], a[24:27]
    ds_write_b128 v49, a[4:7] offset:1024
    v_mfma_f32_16x16x32_bf16 a[28:31], a[180:183], v[152:155], a[28:31]
    ds_write_b128 v49, a[8:11] offset:2048
    v_mfma_f32_16x16x32_bf16 a[32:35], a[184:187], v[152:155], a[32:35]
    ds_write_b128 v49, a[12:15] offset:3072
    v_mfma_f32_16x16x32_bf16 a[36:39], a[188:191], v[152:155], a[36:39]
    ds_write_b128 v49, a[16:19] offset:4096
    v_mfma_f32_16x16x32_bf16 a[40:43], a[152:155], v[140:143], a[40:43]
    v_mfma_f32_16x16x32_bf16 a[44:47], a[156:159], v[140:143], a[44:47]
    v_mfma_f32_16x16x32_bf16 a[48:51], a[160:163], v[140:143], a[48:51]
    v_mfma_f32_16x16x32_bf16 a[52:55], a[164:167], v[140:143], a[52:55]
    v_mfma_f32_16x16x32_bf16 a[56:59], a[168:171], v[140:143], a[56:59]
    s_waitcnt vmcnt(0)
    v_mfma_f32_16x16x32_bf16 a[40:43], a[172:175], v[156:159], a[40:43]
    ds_write_b128 v49, a[20:23] offset:30720
    s_nop 0
    v_mfma_f32_16x16x32_bf16 a[44:47], a[176:179], v[156:159], a[44:47]
    ds_write_b128 v49, a[24:27] offset:31744
    v_mfma_f32_16x16x32_bf16 a[48:51], a[180:183], v[156:159], a[48:51]
    ds_write_b128 v49, a[28:31] offset:32768
    v_mfma_f32_16x16x32_bf16 a[52:55], a[184:187], v[156:159], a[52:55]
    ds_write_b128 v49, a[32:35] offset:33792
    v_mfma_f32_16x16x32_bf16 a[56:59], a[188:191], v[156:159], a[56:59]
    ds_write_b128 v49, a[36:39] offset:34816
    v_mfma_f32_16x16x32_bf16 v[16:19], a[152:155], v[128:131], v[16:19]
    v_mfma_f32_16x16x32_bf16 v[20:23], a[156:159], v[128:131], v[20:23]
    v_mfma_f32_16x16x32_bf16 v[24:27], a[160:163], v[128:131], v[24:27]
    ds_read_b64 v[38:39], v58 offset:61440
    ds_read_b64 v[40:41], v58 offset:61472
    v_mfma_f32_16x16x32_bf16 v[28:31], a[164:167], v[128:131], v[28:31]
    ds_read_b64 v[42:43], v58 offset:61504
    v_mfma_f32_16x16x32_bf16 v[32:35], a[168:171], v[128:131], v[32:35]
    ds_read_b64 v[44:45], v58 offset:61536
    ds_read_b64 v[46:47], v58 offset:61568
    v_mfma_f32_16x16x32_bf16 v[16:19], a[172:175], v[144:147], v[16:19]
    ds_write_b128 v48, a[40:43] offset:30720
    v_mfma_f32_16x16x32_bf16 v[20:23], a[176:179], v[144:147], v[20:23]
    ds_write_b128 v48, a[44:47] offset:31744
    v_mfma_f32_16x16x32_bf16 v[24:27], a[180:183], v[144:147], v[24:27]
    ds_write_b128 v48, a[48:51] offset:32768
    v_mfma_f32_16x16x32_bf16 v[28:31], a[184:187], v[144:147], v[28:31]
    ds_write_b128 v48, a[52:55] offset:33792
    v_mfma_f32_16x16x32_bf16 v[32:35], a[188:191], v[144:147], v[32:35]
    ds_write_b128 v48, a[56:59] offset:34816
    s_waitcnt lgkmcnt(0)
    v_lshlrev_b32 v140, 16, v38
    v_and_b32 v141, 0xffff0000, v38
    v_lshlrev_b32 v142, 16, v39
    v_and_b32 v143, 0xffff0000, v39
    v_lshlrev_b32 v144, 16, v40
    v_and_b32 v145, 0xffff0000, v40
    v_lshlrev_b32 v146, 16, v41
    v_and_b32 v147, 0xffff0000, v41
    v_lshlrev_b32 v148, 16, v42
    v_and_b32 v149, 0xffff0000, v42
    v_lshlrev_b32 v150, 16, v43
    v_and_b32 v151, 0xffff0000, v43
    v_lshlrev_b32 v152, 16, v44
    v_and_b32 v153, 0xffff0000, v44
    v_lshlrev_b32_e64 v154, 16, v45
    v_and_b32 v155, 0xffff0000, v45
    v_lshlrev_b32 v156, 16, v46
    v_and_b32 v157, 0xffff0000, v46
    v_lshlrev_b32 v158, 16, v47
    v_and_b32 v159, 0xffff0000, v47
    v_mov_b32 v37, v36
    s_cmp_lg_u32 s26, 0
    s_cbranch_scc0 L_ret3b
L_poll3:
    s_mov_b32 s65, 0
L_poll3_l:
    buffer_load_dwordx2 v[10:11], v9, s[44:47], s22 offen sc1
    s_waitcnt vmcnt(0)
    v_cmp_ne_u32 vcc, s58, v10
    v_cmp_ne_u32 s[66:67], s58, v11
    s_or_b64 vcc, vcc, s[66:67]
    s_cbranch_vccz L_ret3
    s_sleep 4
    s_add_u32 s65, s65, 1
    s_cmp_lt_u32 s65, 0x200000
    s_cbranch_scc1 L_poll3_l
    s_branch L_ret3
L_ret3:
    s_mov_b32 m0, 15360
    s_nop 0
    buffer_load_dwordx4 v12, s[44:47], s23 offen sc1 lds
    s_add_u32 s23, s23, 32768
    s_mov_b32 m0, 16384
    s_nop 0
    buffer_load_dwordx4 v12, s[44:47], s23 offen sc1 lds
    s_add_u32 s23, s23, 32768
    s_mov_b32 m0, 17408
    s_nop 0
    buffer_load_dwordx4 v12, s[44:47], s23 offen sc1 lds
    s_add_u32 s23, s23, 32768
    s_mov_b32 m0, 18432
    s_nop 0
    buffer_load_dwordx4 v12, s[44:47], s23 offen sc1 lds
    s_add_u32 s23, s23, 32768
    s_mov_b32 m0, 19456
    s_nop 0
    buffer_load_dwordx4 v12, s[44:47], s23 offen sc1 lds
    s_add_u32 s23, s23, 32768
    s_mov_b32 m0, 56320
    s_nop 0
    buffer_load_dwordx4 v12, s[44:47], s23 offen sc1 lds
    s_add_u32 s23, s23, 32768
    s_mov_b32 m0, 57344
    s_nop 0
    buffer_load_dwordx4 v12, s[44:47], s23 offen sc1 lds
    s_add_u32 s23, s23, 32768
    s_mov_b32 m0, 58368
    s_nop 0
    buffer_load_dwordx4 v12, s[44:47], s23 offen sc1 lds
    s_add_u32 s23, s23, 32768
    s_mov_b32 m0, 59392
    s_nop 0
    buffer_load_dwordx4 v12, s[44:47], s23 offen sc1 lds
    s_add_u32 s23, s23, 32768
    s_mov_b32 m0, 60416
    s_nop 0
    buffer_load_dwordx4 v12, s[44:47], s23 offen sc1 lds
L_ret3b:
    s_waitcnt vmcnt(0) lgkmcnt(0)
    s_barrier
    ds_read_b64_tr_b16 v[124:125], v53
    ds_read_b64_tr_b16 v[126:127], v54
    ds_read_b64_tr_b16 v[128:129], v55
    ds_read_b64_tr_b16 v[130:131], v56
    ds_read_b64_tr_b16 v[132:133], v57
    ds_read_b128 v[64:67], v50 offset:0
    ds_read_b128 v[84:87], v51 offset:0
    ds_read_b128 v[104:107], v52 offset:0
    ds_read_b128 v[68:71], v50 offset:1024
    ds_read_b128 v[88:91], v51 offset:1024
    ds_read_b128 v[108:111], v52 offset:1024
    ds_read_b128 v[72:75], v50 offset:2048
    ds_read_b128 v[92:95], v51 offset:2048
    ds_read_b128 v[112:115], v52 offset:2048
    ds_read_b128 v[76:79], v50 offset:3072
    ds_read_b128 v[96:99], v51 offset:3072
    ds_read_b128 v[116:119], v52 offset:3072
    ds_read_b128 v[80:83], v50 offset:4096
    ds_read_b128 v[100:103], v51 offset:4096
    ds_read_b128 v[120:123], v52 offset:4096
    s_waitcnt lgkmcnt(15)
    v_lshlrev_b32 v2, 16, v124
    v_and_b32 v3, 0xffff0000, v124
    v_pk_add_f32 v[140:141], v[140:141], v[2:3]
    v_lshlrev_b32_e64 v2, 16, v125
    v_and_b32 v3, 0xffff0000, v125
    v_pk_add_f32 v[142:143], v[142:143], v[2:3]
    v_lshlrev_b32_e64 v2, 16, v126
    v_and_b32 v3, 0xffff0000, v126
    v_pk_add_f32 v[144:145], v[144:145], v[2:3]
    v_lshlrev_b32 v2, 16, v127
    v_and_b32 v3, 0xffff0000, v127
    v_pk_add_f32 v[146:147], v[146:147], v[2:3]
    v_lshlrev_b32 v2, 16, v128
    v_and_b32 v3, 0xffff0000, v128
    v_pk_add_f32 v[148:149], v[148:149], v[2:3]
    v_lshlrev_b32_e64 v2, 16, v129
    v_and_b32 v3, 0xffff0000, v129
    v_pk_add_f32 v[150:151], v[150:151], v[2:3]
    v_lshlrev_b32 v2, 16, v130
    v_and_b32 v3, 0xffff0000, v130
    v_pk_add_f32 v[152:153], v[152:153], v[2:3]
    v_lshlrev_b32 v2, 16, v131
    v_and_b32 v3, 0xffff0000, v131
    v_pk_add_f32 v[154:155], v[154:155], v[2:3]
    v_lshlrev_b32_e64 v2, 16, v132
    v_and_b32 v3, 0xffff0000, v132
    v_pk_add_f32 v[156:157], v[156:157], v[2:3]
    v_lshlrev_b32 v2, 16, v133
    v_and_b32 v3, 0xffff0000, v133
    v_pk_add_f32 v[158:159], v[158:159], v[2:3]
    s_waitcnt lgkmcnt(0)
    v_pk_add_f32 v[16:17], v[16:17], v[64:65]
    v_pk_add_f32 v[84:85], v[84:85], v[104:105]
    v_pk_add_f32 v[18:19], v[18:19], v[66:67]
    v_pk_add_f32 v[86:87], v[86:87], v[106:107]
    v_pk_add_f32 v[16:17], v[16:17], v[84:85]
    v_pk_add_f32 v[18:19], v[18:19], v[86:87]
    v_pk_fma_f32 v[16:17], v[16:17], v[36:37], v[140:141]
    v_pk_fma_f32 v[18:19], v[18:19], v[36:37], v[142:143]
    v_cvt_pk_bf16_f32 v16, v16, v17
    v_cvt_pk_bf16_f32 v17, v18, v19
    ds_write_b64 v58, v[16:17] offset:61440
    v_pk_add_f32 v[20:21], v[20:21], v[68:69]
    v_pk_add_f32 v[88:89], v[88:89], v[108:109]
    v_pk_add_f32 v[22:23], v[22:23], v[70:71]
    v_pk_add_f32 v[90:91], v[90:91], v[110:111]
    v_pk_add_f32 v[20:21], v[20:21], v[88:89]
    v_pk_add_f32 v[22:23], v[22:23], v[90:91]
    v_pk_fma_f32 v[20:21], v[20:21], v[36:37], v[144:145]
    v_pk_fma_f32 v[22:23], v[22:23], v[36:37], v[146:147]
    v_cvt_pk_bf16_f32 v20, v20, v21
    v_cvt_pk_bf16_f32 v21, v22, v23
    ds_write_b64 v58, v[20:21] offset:61472
    v_pk_add_f32 v[24:25], v[24:25], v[72:73]
    v_pk_add_f32 v[92:93], v[92:93], v[112:113]
    v_pk_add_f32 v[26:27], v[26:27], v[74:75]
    v_pk_add_f32 v[94:95], v[94:95], v[114:115]
    v_pk_add_f32 v[24:25], v[24:25], v[92:93]
    v_pk_add_f32 v[26:27], v[26:27], v[94:95]
    v_pk_fma_f32 v[24:25], v[24:25], v[36:37], v[148:149]
    v_pk_fma_f32 v[26:27], v[26:27], v[36:37], v[150:151]
    v_cvt_pk_bf16_f32 v24, v24, v25
    v_cvt_pk_bf16_f32 v25, v26, v27
    ds_write_b64 v58, v[24:25] offset:61504
    v_pk_add_f32 v[28:29], v[28:29], v[76:77]
    v_pk_add_f32 v[96:97], v[96:97], v[116:117]
    v_pk_add_f32 v[30:31], v[30:31], v[78:79]
    v_pk_add_f32 v[98:99], v[98:99], v[118:119]
    v_pk_add_f32 v[28:29], v[28:29], v[96:97]
    v_pk_add_f32 v[30:31], v[30:31], v[98:99]
    v_pk_fma_f32 v[28:29], v[28:29], v[36:37], v[152:153]
    v_pk_fma_f32 v[30:31], v[30:31], v[36:37], v[154:155]
    v_cvt_pk_bf16_f32 v28, v28, v29
    v_cvt_pk_bf16_f32 v29, v30, v31
    ds_write_b64 v58, v[28:29] offset:61536
    v_pk_add_f32 v[32:33], v[32:33], v[80:81]
    v_pk_add_f32 v[100:101], v[100:101], v[120:121]
    v_pk_add_f32 v[34:35], v[34:35], v[82:83]
    v_pk_add_f32 v[102:103], v[102:103], v[122:123]
    v_pk_add_f32 v[32:33], v[32:33], v[100:101]
    v_pk_add_f32 v[34:35], v[34:35], v[102:103]
    v_pk_fma_f32 v[32:33], v[32:33], v[36:37], v[156:157]
    v_pk_fma_f32 v[34:35], v[34:35], v[36:37], v[158:159]
    v_cvt_pk_bf16_f32 v32, v32, v33
    v_cvt_pk_bf16_f32 v33, v34, v35
    ds_write_b64 v58, v[32:33] offset:61568
    ds_read_b128 v[64:67], v59 offset:61440
    ds_read_b128 v[68:71], v59 offset:62464
    ds_read_b128 v[72:75], v59 offset:63488
    s_waitcnt lgkmcnt(2)
    buffer_store_dwordx4 v[64:67], v216, s[48:51], s79 offen
    s_waitcnt lgkmcnt(1)
    buffer_store_dwordx4 v[68:71], v217, s[48:51], s79 offen
    s_waitcnt lgkmcnt(0)
    s_mov_b64 exec, 0xffffffff
    buffer_store_dwordx4 v[72:75], v218, s[48:51], s79 offen
    s_mov_b64 exec, -1
    s_or_b32 s60, s2, s52
    s_cmp_eq_u32 s60, 0
    s_cbranch_scc0 L_noepoch
    v_mov_b32 v2, 0
    v_mov_b32 v3, s58
    s_mov_b64 exec, 1
    buffer_store_dword v3, v2, s[44:47], 0 offen sc1
    s_mov_b64 exec, -1
L_noepoch:
L_end:
    s_endpgm
L_slow1w:
    s_mov_b32 s65, 0
L_slow1w_l:
    buffer_load_dwordx2 v[12:13], v238, s[44:47], 0 offen sc1
    s_waitcnt vmcnt(0)
    v_cmp_ne_u32_e64 vcc, s58, v12
    v_cmp_ne_u32 s[66:67], s58, v13
    s_or_b64 vcc, vcc, s[66:67]
    s_cbranch_vccz L_ret1w
    s_sleep 4
    s_add_u32 s65, s65, 1
    s_cmp_lt_u32 s65, 0x200000
    s_cbranch_scc1 L_slow1w_l
    s_branch L_ret1w
L_slow1:
    s_mov_b32 s65, 0
L_slow1_l:
    buffer_load_dwordx4 v[8:11], v215, s[44:47], 0 offen sc1
    s_waitcnt vmcnt(0)
    v_cmp_ne_u32_e64 vcc, s58, v8
    v_cmp_ne_u32 s[66:67], s58, v9
    s_or_b64 vcc, vcc, s[66:67]
    v_cmp_ne_u32 s[66:67], s58, v10
    s_or_b64 vcc, vcc, s[66:67]
    v_cmp_ne_u32 s[66:67], s58, v11
    s_or_b64 vcc, vcc, s[66:67]
    s_cbranch_vccz L_ret1
    s_sleep 4
    s_add_u32 s65, s65, 1
    s_cmp_lt_u32 s65, 0x200000
    s_cbranch_scc1 L_slow1_l
    s_branch L_ret1
L_slow2:
    s_mov_b32 s65, 0
L_slow2_l:
    ds_read_b32 v3, v2 offset:0
    s_waitcnt lgkmcnt(0)
    v_cmp_ne_u32 vcc, 1, v3
    s_cbranch_vccz L_ret2
    s_sleep 1
    s_add_u32 s65, s65, 1
    s_cmp_lt_u32 s65, 0x400000
    s_cbranch_scc1 L_slow2_l
    s_branch L_ret2
L_nc3:
    s_add_u32 s63, s60, 573440
    s_mov_b32 m0, 87040
    s_nop 0
    buffer_load_dwordx4 v223, s[16:19], s63 offen offset:0 sc1 lds
    buffer_load_dwordx4 v223, s[16:19], s63 offen offset:1024 sc1 lds
    buffer_load_dwordx4 v223, s[16:19], s63 offen offset:2048 sc1 lds
    buffer_load_dwordx4 v223, s[16:19], s63 offen offset:3072 sc1 lds
    s_mov_b32 m0, 91136
    s_nop 0
    buffer_load_dwordx4 v236, s[16:19], s63 offen sc1 lds
    s_waitcnt vmcnt(20)
    s_add_u32 s63, s60, 1720320
    s_mov_b32 m0, 117760
    s_nop 0
    buffer_load_dwordx4 v223, s[16:19], s63 offen offset:0 sc1 lds
    buffer_load_dwordx4 v223, s[16:19], s63 offen offset:1024 sc1 lds
    buffer_load_dwordx4 v223, s[16:19], s63 offen offset:2048 sc1 lds
    buffer_load_dwordx4 v223, s[16:19], s63 offen offset:3072 sc1 lds
    s_mov_b32 m0, 121856
    s_nop 0
    buffer_load_dwordx4 v236, s[16:19], s63 offen sc1 lds
    s_waitcnt vmcnt(20)
    s_add_u32 s60, s60, 40960
    s_cmp_eq_u32 s60, s62
    s_cselect_b32 s60, s61, s60
    s_add_u32 s63, s60, 573440
    s_mov_b32 m0, 5120
    s_nop 0
    buffer_load_dwordx4 v223, s[16:19], s63 offen offset:0 sc1 lds
    buffer_load_dwordx4 v223, s[16:19], s63 offen offset:1024 sc1 lds
    buffer_load_dwordx4 v223, s[16:19], s63 offen offset:2048 sc1 lds
    buffer_load_dwordx4 v223, s[16:19], s63 offen offset:3072 sc1 lds
    s_mov_b32 m0, 9216
    s_nop 0
    buffer_load_dwordx4 v236, s[16:19], s63 offen sc1 lds
    s_waitcnt vmcnt(20)
    s_add_u32 s63, s60, 1720320
    s_mov_b32 m0, 15360
    s_nop 0
    buffer_load_dwordx4 v223, s[16:19], s63 offen offset:0 sc1 lds
    buffer_load_dwordx4 v223, s[16:19], s63 offen offset:1024 sc1 lds
    buffer_load_dwordx4 v223, s[16:19], s63 offen offset:2048 sc1 lds
    buffer_load_dwordx4 v223, s[16:19], s63 offen offset:3072 sc1 lds
    s_mov_b32 m0, 19456
    s_nop 0
    buffer_load_dwordx4 v236, s[16:19], s63 offen sc1 lds
    s_waitcnt vmcnt(20)
    s_add_u32 s60, s60, 40960
    s_cmp_eq_u32 s60, s62
    s_cselect_b32 s60, s61, s60
    s_add_u32 s63, s60, 573440
    s_mov_b32 m0, 35840
    s_nop 0
    buffer_load_dwordx4 v223, s[16:19], s63 offen offset:0 sc1 lds
    buffer_load_dwordx4 v223, s[16:19], s63 offen offset:1024 sc1 lds
    buffer_load_dwordx4 v223, s[16:19], s63 offen offset:2048 sc1 lds
    buffer_load_dwordx4 v223, s[16:19], s63 offen offset:3072 sc1 lds
    s_mov_b32 m0, 39936
    s_nop 0
    buffer_load_dwordx4 v236, s[16:19], s63 offen sc1 lds
    s_waitcnt vmcnt(20)
    s_add_u32 s63, s60, 1720320
    s_mov_b32 m0, 46080
    s_nop 0
    buffer_load_dwordx4 v223, s[16:19], s63 offen offset:0 sc1 lds
    buffer_load_dwordx4 v223, s[16:19], s63 offen offset:1024 sc1 lds
    buffer_load_dwordx4 v223, s[16:19], s63 offen offset:2048 sc1 lds
    buffer_load_dwordx4 v223, s[16:19], s63 offen offset:3072 sc1 lds
    s_mov_b32 m0, 50176
    s_nop 0
    buffer_load_dwordx4 v236, s[16:19], s63 offen sc1 lds
    s_waitcnt vmcnt(20)
    buffer_load_dwordx2 v[4:5], v6, s[44:47], s21 offen sc1
    s_add_u32 s60, s60, 40960
    s_cmp_eq_u32 s60, s62
    s_cselect_b32 s60, s61, s60
    s_add_u32 s63, s60, 573440
    s_mov_b32 m0, 25600
    s_nop 0
    buffer_load_dwordx4 v223, s[16:19], s63 offen offset:0 sc1 lds
    buffer_load_dwordx4 v223, s[16:19], s63 offen offset:1024 sc1 lds
    buffer_load_dwordx4 v223, s[16:19], s63 offen offset:2048 sc1 lds
    buffer_load_dwordx4 v223, s[16:19], s63 offen offset:3072 sc1 lds
    s_mov_b32 m0, 29696
    s_nop 0
    buffer_load_dwordx4 v236, s[16:19], s63 offen sc1 lds
    s_waitcnt vmcnt(20)
    s_add_u32 s63, s60, 1720320
    s_mov_b32 m0, 56320
    s_nop 0
    buffer_load_dwordx4 v223, s[16:19], s63 offen offset:0 sc1 lds
    buffer_load_dwordx4 v223, s[16:19], s63 offen offset:1024 sc1 lds
    buffer_load_dwordx4 v223, s[16:19], s63 offen offset:2048 sc1 lds
    buffer_load_dwordx4 v223, s[16:19], s63 offen offset:3072 sc1 lds
    s_mov_b32 m0, 60416
    s_nop 0
    buffer_load_dwordx4 v236, s[16:19], s63 offen sc1 lds
    s_waitcnt vmcnt(20)
    s_cmp_eq_u32 s27, 0
    s_cbranch_scc1 L_sk2_11
    s_waitcnt vmcnt(10)
    v_cmp_ne_u32 vcc, s58, v4
    v_cmp_ne_u32 s[66:67], s58, v5
    s_or_b64 vcc, vcc, s[66:67]
    s_cbranch_vccnz L_re2_11
    ds_write_b32 v2, v3
    s_mov_b32 s27, 0
    s_branch L_sk2_11
L_re2_11:
    buffer_load_dwordx2 v[4:5], v6, s[44:47], s21 offen sc1
L_sk2_11:
    s_add_u32 s60, s60, 40960
    s_cmp_eq_u32 s60, s62
    s_cselect_b32 s60, s61, s60
    s_add_u32 s63, s60, 573440
    s_mov_b32 m0, 66560
    s_nop 0
    buffer_load_dwordx4 v223, s[16:19], s63 offen offset:0 sc1 lds
    buffer_load_dwordx4 v223, s[16:19], s63 offen offset:1024 sc1 lds
    buffer_load_dwordx4 v223, s[16:19], s63 offen offset:2048 sc1 lds
    buffer_load_dwordx4 v223, s[16:19], s63 offen offset:3072 sc1 lds
    s_mov_b32 m0, 70656
    s_nop 0
    buffer_load_dwordx4 v236, s[16:19], s63 offen sc1 lds
    s_waitcnt vmcnt(20)
    s_add_u32 s63, s60, 1720320
    s_mov_b32 m0, 76800
    s_nop 0
    buffer_load_dwordx4 v223, s[16:19], s63 offen offset:0 sc1 lds
    buffer_load_dwordx4 v223, s[16:19], s63 offen offset:1024 sc1 lds
    buffer_load_dwordx4 v223, s[16:19], s63 offen offset:2048 sc1 lds
    buffer_load_dwordx4 v223, s[16:19], s63 offen offset:3072 sc1 lds
    s_mov_b32 m0, 80896
    s_nop 0
    buffer_load_dwordx4 v236, s[16:19], s63 offen sc1 lds
    s_waitcnt vmcnt(20)
    s_cmp_eq_u32 s27, 0
    s_cbranch_scc1 L_sk2_12
    s_waitcnt vmcnt(10)
    v_cmp_ne_u32 vcc, s58, v4
    v_cmp_ne_u32 s[66:67], s58, v5
    s_or_b64 vcc, vcc, s[66:67]
    s_cbranch_vccnz L_re2_12
    ds_write_b32 v2, v3
    s_mov_b32 s27, 0
    s_branch L_sk2_12
L_re2_12:
    buffer_load_dwordx2 v[4:5], v6, s[44:47], s21 offen sc1
L_sk2_12:
    s_add_u32 s60, s60, 40960
    s_cmp_eq_u32 s60, s62
    s_cselect_b32 s60, s61, s60
    s_add_u32 s63, s60, 573440
    s_mov_b32 m0, 97280
    s_nop 0
    buffer_load_dwordx4 v223, s[16:19], s63 offen offset:0 sc1 lds
    buffer_load_dwordx4 v223, s[16:19], s63 offen offset:1024 sc1 lds
    buffer_load_dwordx4 v223, s[16:19], s63 offen offset:2048 sc1 lds
    buffer_load_dwordx4 v223, s[16:19], s63 offen offset:3072 sc1 lds
    s_mov_b32 m0, 101376
    s_nop 0
    buffer_load_dwordx4 v236, s[16:19], s63 offen sc1 lds
    s_waitcnt vmcnt(20)
    s_add_u32 s63, s60, 1720320
    s_mov_b32 m0, 107520
    s_nop 0
    buffer_load_dwordx4 v223, s[16:19], s63 offen offset:0 sc1 lds
    buffer_load_dwordx4 v223, s[16:19], s63 offen offset:1024 sc1 lds
    buffer_load_dwordx4 v223, s[16:19], s63 offen offset:2048 sc1 lds
    buffer_load_dwordx4 v223, s[16:19], s63 offen offset:3072 sc1 lds
    s_mov_b32 m0, 111616
    s_nop 0
    buffer_load_dwordx4 v236, s[16:19], s63 offen sc1 lds
    s_waitcnt vmcnt(20)
    s_cmp_eq_u32 s27, 0
    s_cbranch_scc1 L_sk2_13
    s_waitcnt vmcnt(10)
    v_cmp_ne_u32 vcc, s58, v4
    v_cmp_ne_u32 s[66:67], s58, v5
    s_or_b64 vcc, vcc, s[66:67]
    s_cbranch_vccnz L_re2_13
    ds_write_b32 v2, v3
    s_mov_b32 s27, 0
    s_branch L_sk2_13
L_re2_13:
L_sk2_13:
    s_branch L_nc4
L_nc2:
    s_add_u32 s63, s60, 0
    s_mov_b32 m0, 81920
    s_nop 0
    buffer_load_dwordx4 v223, s[16:19], s63 offen offset:0 sc1 lds
    buffer_load_dwordx4 v223, s[16:19], s63 offen offset:1024 sc1 lds
    buffer_load_dwordx4 v223, s[16:19], s63 offen offset:2048 sc1 lds
    buffer_load_dwordx4 v223, s[16:19], s63 offen offset:3072 sc1 lds
    s_mov_b32 m0, 86016
    s_nop 0
    buffer_load_dwordx4 v236, s[16:19], s63 offen sc1 lds
    s_waitcnt vmcnt(20)
    s_add_u32 s63, s60, 1146880
    s_mov_b32 m0, 112640
    s_nop 0
    buffer_load_dwordx4 v223, s[16:19], s63 offen offset:0 sc1 lds
    buffer_load_dwordx4 v223, s[16:19], s63 offen offset:1024 sc1 lds
    buffer_load_dwordx4 v223, s[16:19], s63 offen offset:2048 sc1 lds
    buffer_load_dwordx4 v223, s[16:19], s63 offen offset:3072 sc1 lds
    s_mov_b32 m0, 116736
    s_nop 0
    buffer_load_dwordx4 v236, s[16:19], s63 offen sc1 lds
    s_waitcnt vmcnt(20)
    s_add_u32 s60, s60, 40960
    s_cmp_eq_u32 s60, s62
    s_cselect_b32 s60, s61, s60
    s_add_u32 s63, s60, 0
    s_mov_b32 m0, 0
    s_nop 0
    buffer_load_dwordx4 v223, s[16:19], s63 offen offset:0 sc1 lds
    buffer_load_dwordx4 v223, s[16:19], s63 offen offset:1024 sc1 lds
    buffer_load_dwordx4 v223, s[16:19], s63 offen offset:2048 sc1 lds
    buffer_load_dwordx4 v223, s[16:19], s63 offen offset:3072 sc1 lds
    s_mov_b32 m0, 4096
    s_nop 0
    buffer_load_dwordx4 v236, s[16:19], s63 offen sc1 lds
    s_waitcnt vmcnt(20)
    s_add_u32 s63, s60, 1146880
    s_mov_b32 m0, 10240
    s_nop 0
    buffer_load_dwordx4 v223, s[16:19], s63 offen offset:0 sc1 lds
    buffer_load_dwordx4 v223, s[16:19], s63 offen offset:1024 sc1 lds
    buffer_load_dwordx4 v223, s[16:19], s63 offen offset:2048 sc1 lds
    buffer_load_dwordx4 v223, s[16:19], s63 offen offset:3072 sc1 lds
    s_mov_b32 m0, 14336
    s_nop 0
    buffer_load_dwordx4 v236, s[16:19], s63 offen sc1 lds
    s_waitcnt vmcnt(20)
    s_add_u32 s60, s60, 40960
    s_cmp_eq_u32 s60, s62
    s_cselect_b32 s60, s61, s60
    s_add_u32 s63, s60, 0
    s_mov_b32 m0, 30720
    s_nop 0
    buffer_load_dwordx4 v223, s[16:19], s63 offen offset:0 sc1 lds
    buffer_load_dwordx4 v223, s[16:19], s63 offen offset:1024 sc1 lds
    buffer_load_dwordx4 v223, s[16:19], s63 offen offset:2048 sc1 lds
    buffer_load_dwordx4 v223, s[16:19], s63 offen offset:3072 sc1 lds
    s_mov_b32 m0, 34816
    s_nop 0
    buffer_load_dwordx4 v236, s[16:19], s63 offen sc1 lds
    s_waitcnt vmcnt(20)
    s_add_u32 s63, s60, 1146880
    s_mov_b32 m0, 40960
    s_nop 0
    buffer_load_dwordx4 v223, s[16:19], s63 offen offset:0 sc1 lds
    buffer_load_dwordx4 v223, s[16:19], s63 offen offset:1024 sc1 lds
    buffer_load_dwordx4 v223, s[16:19], s63 offen offset:2048 sc1 lds
    buffer_load_dwordx4 v223, s[16:19], s63 offen offset:3072 sc1 lds
    s_mov_b32 m0, 45056
    s_nop 0
    buffer_load_dwordx4 v236, s[16:19], s63 offen sc1 lds
    s_waitcnt vmcnt(20)
    s_add_u32 s60, s60, 40960
    s_cmp_eq_u32 s60, s62
    s_cselect_b32 s60, s61, s60
    s_add_u32 s63, s60, 0
    s_mov_b32 m0, 20480
    s_nop 0
    buffer_load_dwordx4 v223, s[16:19], s63 offen offset:0 sc1 lds
    buffer_load_dwordx4 v223, s[16:19], s63 offen offset:1024 sc1 lds
    buffer_load_dwordx4 v223, s[16:19], s63 offen offset:2048 sc1 lds
    buffer_load_dwordx4 v223, s[16:19], s63 offen offset:3072 sc1 lds
    s_mov_b32 m0, 24576
    s_nop 0
    buffer_load_dwordx4 v236, s[16:19], s63 offen sc1 lds
    s_waitcnt vmcnt(20)
    s_add_u32 s63, s60, 1146880
    s_mov_b32 m0, 51200
    s_nop 0
    buffer_load_dwordx4 v223, s[16:19], s63 offen offset:0 sc1 lds
    buffer_load_dwordx4 v223, s[16:19], s63 offen offset:1024 sc1 lds
    buffer_load_dwordx4 v223, s[16:19], s63 offen offset:2048 sc1 lds
    buffer_load_dwordx4 v223, s[16:19], s63 offen offset:3072 sc1 lds
    s_mov_b32 m0, 55296
    s_nop 0
    buffer_load_dwordx4 v236, s[16:19], s63 offen sc1 lds
    s_waitcnt vmcnt(20)
    s_add_u32 s60, s60, 40960
    s_cmp_eq_u32 s60, s62
    s_cselect_b32 s60, s61, s60
    s_add_u32 s63, s60, 0
    s_mov_b32 m0, 61440
    s_nop 0
    buffer_load_dwordx4 v223, s[16:19], s63 offen offset:0 sc1 lds
    buffer_load_dwordx4 v223, s[16:19], s63 offen offset:1024 sc1 lds
    buffer_load_dwordx4 v223, s[16:19], s63 offen offset:2048 sc1 lds
    buffer_load_dwordx4 v223, s[16:19], s63 offen offset:3072 sc1 lds
    s_mov_b32 m0, 65536
    s_nop 0
    buffer_load_dwordx4 v236, s[16:19], s63 offen sc1 lds
    s_waitcnt vmcnt(20)
    s_add_u32 s63, s60, 1146880
    s_mov_b32 m0, 71680
    s_nop 0
    buffer_load_dwordx4 v223, s[16:19], s63 offen offset:0 sc1 lds
    buffer_load_dwordx4 v223, s[16:19], s63 offen offset:1024 sc1 lds
    buffer_load_dwordx4 v223, s[16:19], s63 offen offset:2048 sc1 lds
    buffer_load_dwordx4 v223, s[16:19], s63 offen offset:3072 sc1 lds
    s_mov_b32 m0, 75776
    s_nop 0
    buffer_load_dwordx4 v236, s[16:19], s63 offen sc1 lds
    s_waitcnt vmcnt(20)
    s_add_u32 s60, s60, 40960
    s_cmp_eq_u32 s60, s62
    s_cselect_b32 s60, s61, s60
    s_add_u32 s63, s60, 0
    s_mov_b32 m0, 92160
    s_nop 0
    buffer_load_dwordx4 v223, s[16:19], s63 offen offset:0 sc1 lds
    buffer_load_dwordx4 v223, s[16:19], s63 offen offset:1024 sc1 lds
    buffer_load_dwordx4 v223, s[16:19], s63 offen offset:2048 sc1 lds
    buffer_load_dwordx4 v223, s[16:19], s63 offen offset:3072 sc1 lds
    s_mov_b32 m0, 96256
    s_nop 0
    buffer_load_dwordx4 v236, s[16:19], s63 offen sc1 lds
    s_waitcnt vmcnt(20)
    s_add_u32 s63, s60, 1146880
    s_mov_b32 m0, 102400
    s_nop 0
    buffer_load_dwordx4 v223, s[16:19], s63 offen offset:0 sc1 lds
    buffer_load_dwordx4 v223, s[16:19], s63 offen offset:1024 sc1 lds
    buffer_load_dwordx4 v223, s[16:19], s63 offen offset:2048 sc1 lds
    buffer_load_dwordx4 v223, s[16:19], s63 offen offset:3072 sc1 lds
    s_mov_b32 m0, 106496
    s_nop 0
    buffer_load_dwordx4 v236, s[16:19], s63 offen sc1 lds
    s_waitcnt vmcnt(20)
    s_waitcnt vmcnt(0)
    ds_write_b32 v2, v3 offset:4
L_poll2w:
    s_mov_b32 s65, 0
L_poll2w_l:
    ds_read_b32 v3, v2 offset:0
    s_waitcnt lgkmcnt(0)
    v_cmp_ne_u32 vcc, 1, v3
    s_cbranch_vccz L_ret2n
    s_sleep 1
    s_add_u32 s65, s65, 1
    s_cmp_lt_u32 s65, 0x400000
    s_cbranch_scc1 L_poll2w_l
    s_branch L_ret2n
L_ret2n:
    buffer_load_dwordx4 v[64:67], v232, s[12:15], s24 offen sc1
    buffer_load_dwordx4 v[68:71], v233, s[12:15], s24 offen sc1
    buffer_load_dwordx4 v[72:75], v234, s[12:15], s24 offen sc1
    buffer_load_dwordx4 v[76:79], v235, s[12:15], s24 offen sc1
    s_add_u32 s24, s24, 131072
    s_cmp_eq_u32 s24, s25
    s_cselect_b32 s24, s0, s24
    buffer_load_dwordx4 v[80:83], v232, s[12:15], s24 offen sc1
    buffer_load_dwordx4 v[84:87], v233, s[12:15], s24 offen sc1
    buffer_load_dwordx4 v[88:91], v234, s[12:15], s24 offen sc1
    buffer_load_dwordx4 v[92:95], v235, s[12:15], s24 offen sc1
    s_add_u32 s24, s24, 131072
    s_cmp_eq_u32 s24, s25
    s_cselect_b32 s24, s0, s24
    buffer_load_dwordx4 v[96:99], v232, s[12:15], s24 offen sc1
    buffer_load_dwordx4 v[100:103], v233, s[12:15], s24 offen sc1
    buffer_load_dwordx4 v[104:107], v234, s[12:15], s24 offen sc1
    buffer_load_dwordx4 v[108:111], v235, s[12:15], s24 offen sc1
    s_add_u32 s24, s24, 131072
    s_cmp_eq_u32 s24, s25
    s_cselect_b32 s24, s0, s24
    s_branch L_gemm2
L_pollB:
    s_mov_b32 s65, 0
L_pollB_l:
    ds_read_b32 v3, v2 offset:4
    s_waitcnt lgkmcnt(0)
    v_cmp_ne_u32 vcc, 1, v3
    s_cbranch_vccz L_pollB2
    s_sleep 1
    s_add_u32 s65, s65, 1
    s_cmp_lt_u32 s65, 0x400000
    s_cbranch_scc1 L_pollB_l
    s_branch L_pollB2
L_pollB2:
    s_mov_b32 s65, 0
L_pollB2_l:
    ds_read_b32 v3, v2 offset:8
    s_waitcnt lgkmcnt(0)
    v_cmp_ne_u32 vcc, 1, v3
    s_cbranch_vccz L_retB
    s_sleep 1
    s_add_u32 s65, s65, 1
    s_cmp_lt_u32 s65, 0x400000
    s_cbranch_scc1 L_pollB2_l
    s_branch L_retB
L_chk3:
    s_waitcnt vmcnt(6)
    v_cmp_ne_u32 vcc, s58, v10
    v_cmp_ne_u32 s[66:67], s58, v11
    s_or_b64 vcc, vcc, s[66:67]
    s_cbranch_vccnz L_chk3r
    s_mov_b32 m0, 15360
    s_nop 0
    buffer_load_dwordx4 v12, s[44:47], s23 offen sc1 lds
    s_add_u32 s23, s23, 32768
    s_mov_b32 m0, 16384
    s_nop 0
    buffer_load_dwordx4 v12, s[44:47], s23 offen sc1 lds
    s_add_u32 s23, s23, 32768
    s_mov_b32 m0, 17408
    s_nop 0
    buffer_load_dwordx4 v12, s[44:47], s23 offen sc1 lds
    s_add_u32 s23, s23, 32768
    s_mov_b32 m0, 18432
    s_nop 0
    buffer_load_dwordx4 v12, s[44:47], s23 offen sc1 lds
    s_add_u32 s23, s23, 32768
    s_mov_b32 m0, 19456
    s_nop 0
    buffer_load_dwordx4 v12, s[44:47], s23 offen sc1 lds
    s_add_u32 s23, s23, 32768
    s_mov_b32 m0, 56320
    s_nop 0
    buffer_load_dwordx4 v12, s[44:47], s23 offen sc1 lds
    s_add_u32 s23, s23, 32768
    s_mov_b32 m0, 57344
    s_nop 0
    buffer_load_dwordx4 v12, s[44:47], s23 offen sc1 lds
    s_add_u32 s23, s23, 32768
    s_mov_b32 m0, 58368
    s_nop 0
    buffer_load_dwordx4 v12, s[44:47], s23 offen sc1 lds
    s_add_u32 s23, s23, 32768
    s_mov_b32 m0, 59392
    s_nop 0
    buffer_load_dwordx4 v12, s[44:47], s23 offen sc1 lds
    s_add_u32 s23, s23, 32768
    s_mov_b32 m0, 60416
    s_nop 0
    buffer_load_dwordx4 v12, s[44:47], s23 offen sc1 lds
    s_mov_b32 s26, 0
    s_branch L_chk3r
L_code_end:
.section .rodata,"a"
.p2align 6
.amdhsa_kernel parallel_sum__ssm_conv_s4d__dense_activation_relu__prompt_kernel
  .amdhsa_next_free_vgpr 512
  .amdhsa_next_free_sgpr 102
  .amdhsa_accum_offset 256
  .amdhsa_group_segment_fixed_size 0
  .amdhsa_kernarg_size 104
  .amdhsa_user_sgpr_count 2
  .amdhsa_user_sgpr_kernarg_segment_ptr 1
  .amdhsa_system_sgpr_workgroup_id_x 1
  .amdhsa_float_denorm_mode_32 3
.end_amdhsa_kernel
```
